```python
import torch

def _softmax(x, axis=-1):
    return torch.softmax(x, dim=axis)
def _gelu(x):
    return torch.nn.functional.gelu(x, approximate="tanh")
def _silu(x):
    return torch.nn.functional.silu(x)
def _sigmoid(x):
    return torch.sigmoid(x)
def _layernorm(x, axis=-1, eps=1e-5):
    m = x.mean(dim=axis, keepdim=True)
    v = x.var(dim=axis, keepdim=True, unbiased=False)
    return (x - m) / torch.sqrt(v + eps)
def _scatter_add(tgt, idx, src, axis=0):
    return tgt.clone().index_add_(axis, idx, src)
def _segment_sum(src, seg, n):
    out = torch.zeros((n,) + src.shape[1:], dtype=src.dtype)
    return out.index_add_(0, seg, src)
def _pad(x, pw):
    flat = tuple(v for pair in reversed(pw) for v in pair)
    return torch.nn.functional.pad(x, flat)

kernel_name = 'recurrent_scan__spectral_gfnet__glu_gated_glu__prompt'

def setup_inputs():

    _w = (lambda a: (lambda t: t.to(torch.bfloat16) if t.is_floating_point() else t)(torch.as_tensor(a)))
    def _A_setup():
        B, S, D = 1, 2048, 512
        Df = D // 2 + 1
        return {
            "x": _w((lambda *s: torch.randn(*s, dtype=torch.bfloat16) * 0.05)(B, S, D)),
            "w_r": _w((lambda *s: torch.randn(*s, dtype=torch.bfloat16) * 0.05)(S, Df) * 0.02),
            "w_i": _w((lambda *s: torch.randn(*s, dtype=torch.bfloat16) * 0.05)(S, Df) * 0.02),
        }
    _A_in = _A_setup()

    def _B_setup():
        B, S, D, F = 1, 2048, 512, 1792
        return {
            "x": _w((lambda *s: torch.randn(*s, dtype=torch.bfloat16) * 0.05)(B, S, D)),
            "w_gate": _w((lambda *s: torch.randn(*s, dtype=torch.bfloat16) * 1.6)(D, F)),
            "w_up": _w((lambda *s: torch.randn(*s, dtype=torch.bfloat16) * 0.1)(D, F)),
            "w_down": _w((lambda *s: torch.randn(*s, dtype=torch.bfloat16) * 0.1)(F, D)),
        }
    _B_in = _B_setup()

    return {
        "A_x": _A_in["x"],
        "A_w_r": _A_in["w_r"],
        "A_w_i": _A_in["w_i"],
        "B_x": _B_in["x"],
        "B_w_gate": _B_in["w_gate"],
        "B_w_up": _B_in["w_up"],
        "B_w_down": _B_in["w_down"],
    }

def reference(A_x, A_w_r, A_w_i, B_x, B_w_gate, B_w_up, B_w_down):
    def _A_ref(x, w_r, w_i):
        B, S, D = x.shape
        X = (lambda x, axes=(-2,-1): torch.fft.rfft2(x.float(), dim=axes))(x, axes=(-2, -1))
        W = w_r + 1j * w_i
        X = X * W
        y = (lambda x, s, axes=(-2,-1): torch.fft.irfft2(x, s=s, dim=axes).to(torch.bfloat16))(X, (S, D), axes=(-2, -1))
        return y

    def _B_ref(x, w_gate, w_up, w_down):
        g = torch.einsum("bsd,df->bsf", x, w_gate)
        u = torch.einsum("bsd,df->bsf", x, w_up)
        h = _sigmoid(g) * u
        return torch.einsum("bsf,fd->bsd", h, w_down)

    x = A_x
    xn = _layernorm(x, axis=-1)
    s = _A_ref(xn, A_w_r, A_w_i)
    g = _silu(_B_ref(xn, B_w_gate, B_w_up, B_w_down))
    return x + s * g
```

```asm
; @launch grid=(256,1,1) block=(256,1,1) lds=163840
.amdgcn_target "amdgcn-amd-amdhsa--gfx950"
.text
.globl recurrent_scan__spectral_gfnet__glu_gated_glu__prompt_kernel
.p2align 8
.type recurrent_scan__spectral_gfnet__glu_gated_glu__prompt_kernel,@function
recurrent_scan__spectral_gfnet__glu_gated_glu__prompt_kernel:
  s_cmp_ge_u32 s2, 0x100
  s_cbranch_scc1 L_end
  s_load_dwordx16 s[36:51], s[0:1], 0
  s_load_dwordx2 s[32:33], s[0:1], 0x48
  s_lshr_b32 s52, s2, 3
  s_getpc_b64 s[54:55]
L_pc:
  s_mul_i32 s53, s52, 0x600
  v_min_u32 v1, 11, v0
  v_lshl_add_u32 v1, v1, 7, s53
  v_min_u32 v1, L_codeend-L_pc-4, v1
  v_mov_b32 v3, s55
  v_add_co_u32 v2, vcc, s54, v1
  s_nop 1
  v_addc_co_u32 v3, vcc, 0, v3, vcc
  global_load_dword v4, v[2:3], off
  s_mov_b32 s18, 0x1c0000
  s_mov_b32 s19, 0x20000
  s_mov_b64 s[22:23], s[18:19]
  s_mov_b32 s6, 0x200000
  s_mov_b32 s7, s19
  v_lshrrev_b32 v5, 6, v0
  v_and_b32 v6, 63, v0
  v_readfirstlane_b32 s56, v5
  s_and_b32 s57, s2, 7
  s_and_b32 s58, s52, 3
  s_lshr_b32 s59, s52, 2
  s_and_b32 s60, s57, 1
  s_lshr_b32 s61, s57, 1
  s_lshl2_add_u32 s62, s60, s58
  s_mul_i32 s63, s61, 7
  s_add_u32 s63, s63, s59
  s_lshl1_add_u32 s64, s58, s60
  s_add_u32 s64, s64, s63
  s_and_b32 s64, s64, 4
  s_lshl_b32 s65, s56, 13
  s_cmp_eq_u32 s59, 7
  s_cbranch_scc1 L_helper
  s_mul_i32 s52, s56, 0xe000
  s_lshl_b32 s53, s63, 7
  s_add_u32 s52, s52, s53
  v_lshrrev_b32 v1, 3, v6
  v_and_b32 v2, 7, v6
  v_bfe_u32 v3, v6, 4, 1
  v_lshlrev_b32 v3, 1, v3
  v_xor_b32 v3, v3, v2
  v_mul_u32_u24 v5, 0xe00, v1
  v_lshl_add_u32 v7, v3, 4, v5
  v_add_u32 v3, 0x6c00, v7
  v_xor_b32 v5, 64, v7
  v_xor_b32 v8, 64, v3
  s_lshl_b32 s53, s62, 18
  s_lshl_b32 s54, s56, 16
  s_add_u32 s54, s54, s53
  v_lshrrev_b32 v9, 4, v6
  v_xor_b32 v9, v9, v2
  v_lshlrev_b32 v9, 4, v9
  v_lshl_add_u32 v2, v1, 10, v9
  v_xor_b32 v1, 64, v2
  v_add_u32 v9, 0x1c00, v1
  v_add_u32 v10, 0x3800, v2
  v_add_u32 v11, 0x5400, v1
  s_add_u32 s55, s64, 0
  s_and_b32 s55, s55, 7
  s_lshl_b32 s66, s55, 7
  s_add_u32 s66, s66, s54
  s_mul_i32 s67, s55, 0x38000
  s_add_u32 s67, s67, s52
  s_add_u32 m0, s65, 0x1000
  s_waitcnt lgkmcnt(0)
  s_mov_b64 s[16:17], s[44:45]
  s_mov_b64 s[20:21], s[46:47]
  s_mov_b64 s[4:5], s[36:37]
  buffer_load_dwordx4 v7, s[16:19], s67 offen offset:0 lds
  buffer_load_dwordx4 v3, s[16:19], s67 offen offset:1024 lds
  s_add_u32 m0, s65, 0x1800
  s_nop 0
  buffer_load_dwordx4 v5, s[20:23], s67 offen offset:0 lds
  buffer_load_dwordx4 v8, s[20:23], s67 offen offset:1024 lds
  s_add_u32 m0, s65, 0
  s_nop 0
  buffer_load_dwordx4 v2, s[4:7], s66 offen offset:0 lds
  buffer_load_dwordx4 v9, s[4:7], s66 offen offset:1024 lds
  buffer_load_dwordx4 v10, s[4:7], s66 offen offset:2048 lds
  buffer_load_dwordx4 v11, s[4:7], s66 offen offset:3072 lds
  s_add_u32 s55, s64, 1
  s_and_b32 s55, s55, 7
  s_lshl_b32 s66, s55, 7
  s_add_u32 s66, s66, s54
  s_mul_i32 s67, s55, 0x38000
  s_add_u32 s67, s67, s52
  s_add_u32 m0, s65, 0x9000
  s_nop 0
  buffer_load_dwordx4 v7, s[16:19], s67 offen offset:0 lds
  buffer_load_dwordx4 v3, s[16:19], s67 offen offset:1024 lds
  s_branch L_gemm2
L_helper:
  s_lshl2_add_u32 s52, s60, s61
  s_lshl2_add_u32 s52, s52, s58
  v_lshlrev_b32 v1, 4, v6
  s_lshr_b32 s53, s52, 1
  s_and_b32 s54, s52, 1
  s_lshl_b32 s55, s53, 7
  s_lshl_b32 s60, s54, 4
  s_add_u32 s55, s55, s60
  s_lshr_b32 s60, s56, 1
  s_lshl_b32 s60, s60, 3
  s_add_u32 s55, s55, s60
  s_and_b32 s60, s56, 1
  s_lshl_b32 s60, s60, 1
  s_add_u32 s55, s55, s60
  s_lshl_b32 s61, s55, 10
  s_lshl_b32 s63, s56, 14
  s_waitcnt lgkmcnt(0)
  s_mov_b64 s[16:17], s[44:45]
  s_mov_b64 s[20:21], s[46:47]
  s_mov_b64 s[4:5], s[36:37]
  s_lshl_b32 s66, s52, 2
  s_add_u32 s66, s66, s56
  s_mul_i32 s66, s66, 0x700
  v_and_b32 v2, 15, v6
  v_min_u32 v2, 13, v2
  v_lshlrev_b32 v2, 7, v2
  v_lshrrev_b32 v3, 4, v6
  v_lshlrev_b32 v3, 3, v3
  v_mov_b32 v5, 0x6020501
  v_lshrrev_b32 v3, v3, v5
  v_and_b32 v3, 7, v3
  v_mul_u32_u24 v3, 0x38000, v3
  v_add_u32 v5, v3, v2
  buffer_load_dword v7, v5, s[20:23], s66 offen
  v_lshrrev_b32 v3, 4, v6
  v_lshlrev_b32 v3, 3, v3
  v_mov_b32 v5, 0x6020602
  v_lshrrev_b32 v3, v3, v5
  v_and_b32 v3, 7, v3
  v_mul_u32_u24 v3, 0x38000, v3
  v_add_u32 v5, v3, v2
  buffer_load_dword v2, v5, s[16:19], s66 offen
  v_xor_b32 v3, 16, v1
  s_add_u32 s66, s61, 0x7c00
  s_add_u32 m0, s63, 0
  s_nop 0
  buffer_load_dwordx4 v3, s[4:7], s66 offen offset:1024 lds
  v_xor_b32 v3, 48, v1
  s_add_u32 s66, s61, 0x17400
  buffer_load_dwordx4 v3, s[4:7], s66 offen offset:3072 lds
  v_xor_b32 v3, 0x50, v1
  s_add_u32 s66, s61, 0x8000
  s_add_u32 m0, s63, 0x1000
  s_nop 0
  buffer_load_dwordx4 v3, s[4:7], s66 offen offset:1024 lds
  v_xor_b32 v3, 0x70, v1
  s_add_u32 s66, s61, 0x17800
  buffer_load_dwordx4 v3, s[4:7], s66 offen offset:3072 lds
  v_xor_b32 v3, 0x90, v1
  s_add_u32 s66, s61, 0x8c00
  s_add_u32 m0, s63, 0x2000
  s_nop 0
  buffer_load_dwordx4 v3, s[4:7], s66 offen offset:1024 lds
  v_xor_b32 v3, 0xb0, v1
  s_add_u32 s66, s61, 0x18400
  buffer_load_dwordx4 v3, s[4:7], s66 offen offset:3072 lds
  v_xor_b32 v3, 0xd0, v1
  s_add_u32 s66, s61, 0x9000
  s_add_u32 m0, s63, 0x3000
  s_nop 0
  buffer_load_dwordx4 v3, s[4:7], s66 offen offset:1024 lds
  v_xor_b32 v3, 0xf0, v1
  s_add_u32 s66, s61, 0x18800
  buffer_load_dwordx4 v3, s[4:7], s66 offen offset:3072 lds
  v_and_b32 v3, 31, v6
  v_lshlrev_b32 v3, 10, v3
  s_and_b32 s66, s64, 7
  s_lshl_b32 s66, s66, 7
  s_lshl_b32 s60, s62, 18
  s_add_u32 s66, s66, s60
  s_lshl_b32 s60, s56, 16
  s_add_u32 s66, s66, s60
  buffer_load_dword v5, v3, s[4:7], s66 offen
  s_branch L_helper2
L_gemm2:
  s_lshl2_add_u32 s55, s60, s61
  s_lshl2_add_u32 s55, s55, s58
  v_lshlrev_b32 v1, 4, v6
  s_mov_b32 s34, 0x2000000
  s_mov_b32 s35, 0x20000
  s_mov_b32 s10, 0x101000
  s_mov_b32 s11, 0x20000
  s_mov_b64 s[14:15], s[10:11]
  s_mov_b64 s[26:27], s[18:19]
  s_mov_b64 s[30:31], s[6:7]
  s_mov_b32 s60, s2
  s_xor_b32 s61, s59, 4
  s_mov_b32 s68, 0
  s_mov_b64 s[8:9], s[38:39]
  s_mov_b64 s[12:13], s[40:41]
  s_mov_b64 s[24:25], s[48:49]
  s_mov_b64 s[28:29], s[50:51]
  s_load_dword s36, s[32:33], 0
  v_and_b32 v12, 31, v6
  v_lshrrev_b32 v13, 5, v6
  v_bfe_u32 v14, v6, 1, 3
  v_xor_b32 v14, v14, v13
  v_lshlrev_b32 v14, 4, v14
  v_lshl_add_u32 v15, v12, 7, v14
  v_xor_b32 v14, 32, v15
  v_xor_b32 v16, 64, v15
  v_xor_b32 v17, 0x60, v15
  v_add_u32 v18, 0x10000, v15
  v_add_u32 v19, 0x10000, v14
  v_add_u32 v20, 0x10000, v16
  v_add_u32 v21, 0x10000, v17
  v_lshlrev_b32 v22, 4, v12
  v_bfe_u32 v12, v6, 4, 1
  v_bfe_u32 v23, v6, 2, 2
  v_lshl_add_u32 v23, v13, 3, v23
  v_lshlrev_b32 v23, 7, v23
  v_lshl_add_u32 v23, v12, 11, v23
  v_bfe_u32 v13, v6, 3, 2
  v_xor_b32 v13, s56, v13
  v_lshl_add_u32 v23, v13, 5, v23
  v_and_b32 v13, 3, v6
  v_lshl_add_u32 v23, v13, 3, v23
  v_add_u32 v24, 0x1000, v23
  v_add_u32 v25, 0x11000, v23
  v_xor_b32 v13, v12, v6
  v_and_b32 v13, 1, v13
  v_add_u32 v13, -1, v13
  v_and_b32 v28, 0x3f803f80, v13
  v_and_b32 v29, 0x3f803f80, v13
  v_and_b32 v30, 0x3f803f80, v13
  v_and_b32 v31, 0x3f803f80, v13
  s_lshl_b32 s37, s56, 1
  s_add_u32 s37, s37, s64
  s_add_u32 s37, s37, 0
  s_and_b32 s37, s37, 7
  s_lshl_b32 s37, s37, 7
  s_add_u32 s37, s37, s53
  s_add_u32 s37, s37, 0x8000
  s_lshl_b32 s38, s56, 1
  s_add_u32 s38, s38, s64
  s_add_u32 s38, s38, 1
  s_and_b32 s38, s38, 7
  s_lshl_b32 s38, s38, 7
  s_add_u32 s38, s38, s53
  s_add_u32 s38, s38, 0x8000
  s_and_b32 s39, s59, 0
  s_add_u32 s39, s39, 0
  s_and_b32 s39, s39, 3
  s_lshl_b32 s39, s39, 16
  s_and_b32 s40, s59, 0
  s_add_u32 s40, s40, 1
  s_and_b32 s40, s40, 3
  s_lshl_b32 s40, s40, 16
  s_and_b32 s41, s59, 0
  s_add_u32 s41, s41, 2
  s_and_b32 s41, s41, 3
  s_lshl_b32 s41, s41, 16
  s_and_b32 s42, s59, 0
  s_add_u32 s42, s42, 3
  s_and_b32 s42, s42, 3
  s_lshl_b32 s42, s42, 16
  s_and_b32 s43, s56, 1
  s_lshl_b32 s43, s43, 5
  s_lshr_b32 s44, s56, 1
  s_lshl_b32 s44, s44, 4
  s_add_u32 s43, s43, s44
  v_and_b32 v12, 15, v6
  v_lshrrev_b32 v13, 4, v6
  s_lshl_b32 s44, s56, 4
  v_add_u32 v23, s44, v12
  v_cvt_f32_u32 v26, v23
  v_cvt_f32_u32 v27, v13
  v_and_b32 v23, 12, v12
  v_add_u32 v13, v12, v23
  v_cvt_f32_u32 v12, v13
  v_mul_f32 v13, 0x3c800000, v26
  v_mul_f32 v23, v13, v27
  v_mul_f32 v23, 4.0, v23
  v_cos_f32 v32, v23
  v_sin_f32 v33, v23
  v_fmamk_f32 v34, v13, 0x3f800000, v23
  v_cos_f32 v35, v34
  v_sin_f32 v36, v34
  v_cvt_pk_bf16_f32 v34, v32, v33
  v_cvt_pk_bf16_f32 v37, -v33, v32
  v_accvgpr_write_b32 a0, v34
  v_accvgpr_write_b32 a4, v37
  v_fmamk_f32 v32, v13, 0x40000000, v23
  v_cos_f32 v33, v32
  v_sin_f32 v34, v32
  v_cvt_pk_bf16_f32 v32, v35, v36
  v_cvt_pk_bf16_f32 v37, -v36, v35
  v_accvgpr_write_b32 a1, v32
  v_accvgpr_write_b32 a5, v37
  v_fmamk_f32 v32, v13, 0x40400000, v23
  v_cos_f32 v35, v32
  v_sin_f32 v36, v32
  v_cvt_pk_bf16_f32 v32, v33, v34
  v_cvt_pk_bf16_f32 v37, -v34, v33
  v_accvgpr_write_b32 a2, v32
  v_accvgpr_write_b32 a6, v37
  v_fmamk_f32 v32, v13, 0x41800000, v23
  v_cos_f32 v33, v32
  v_sin_f32 v34, v32
  v_cvt_pk_bf16_f32 v32, v35, v36
  v_cvt_pk_bf16_f32 v37, -v36, v35
  v_accvgpr_write_b32 a3, v32
  v_accvgpr_write_b32 a7, v37
  v_fmamk_f32 v32, v13, 0x41880000, v23
  v_cos_f32 v35, v32
  v_sin_f32 v36, v32
  v_cvt_pk_bf16_f32 v32, v33, v34
  v_cvt_pk_bf16_f32 v37, -v34, v33
  v_accvgpr_write_b32 a8, v32
  v_accvgpr_write_b32 a12, v37
  v_fmamk_f32 v32, v13, 0x41900000, v23
  v_cos_f32 v33, v32
  v_sin_f32 v34, v32
  v_cvt_pk_bf16_f32 v32, v35, v36
  v_cvt_pk_bf16_f32 v37, -v36, v35
  v_accvgpr_write_b32 a9, v32
  v_accvgpr_write_b32 a13, v37
  v_fmamk_f32 v32, v13, 0x41980000, v23
  v_cos_f32 v35, v32
  v_sin_f32 v36, v32
  v_cvt_pk_bf16_f32 v32, v33, v34
  v_cvt_pk_bf16_f32 v37, -v34, v33
  v_accvgpr_write_b32 a10, v32
  v_accvgpr_write_b32 a14, v37
  v_fmamk_f32 v32, v13, 0x42000000, v23
  v_cos_f32 v33, v32
  v_sin_f32 v34, v32
  v_cvt_pk_bf16_f32 v32, v35, v36
  v_cvt_pk_bf16_f32 v37, -v36, v35
  v_accvgpr_write_b32 a11, v32
  v_accvgpr_write_b32 a15, v37
  v_fmamk_f32 v32, v13, 0x42040000, v23
  v_cos_f32 v35, v32
  v_sin_f32 v36, v32
  v_cvt_pk_bf16_f32 v32, v33, v34
  v_cvt_pk_bf16_f32 v37, -v34, v33
  v_accvgpr_write_b32 a16, v32
  v_accvgpr_write_b32 a20, v37
  v_fmamk_f32 v32, v13, 0x42080000, v23
  v_cos_f32 v33, v32
  v_sin_f32 v34, v32
  v_cvt_pk_bf16_f32 v32, v35, v36
  v_cvt_pk_bf16_f32 v37, -v36, v35
  v_accvgpr_write_b32 a17, v32
  v_accvgpr_write_b32 a21, v37
  v_fmamk_f32 v32, v13, 0x420c0000, v23
  v_cos_f32 v35, v32
  v_sin_f32 v36, v32
  v_cvt_pk_bf16_f32 v32, v33, v34
  v_cvt_pk_bf16_f32 v37, -v34, v33
  v_accvgpr_write_b32 a18, v32
  v_accvgpr_write_b32 a22, v37
  v_fmamk_f32 v32, v13, 0x42400000, v23
  v_cos_f32 v33, v32
  v_sin_f32 v34, v32
  v_cvt_pk_bf16_f32 v32, v35, v36
  v_cvt_pk_bf16_f32 v37, -v36, v35
  v_accvgpr_write_b32 a19, v32
  v_accvgpr_write_b32 a23, v37
  v_fmamk_f32 v32, v13, 0x42440000, v23
  v_cos_f32 v35, v32
  v_sin_f32 v36, v32
  v_cvt_pk_bf16_f32 v32, v33, v34
  v_cvt_pk_bf16_f32 v37, -v34, v33
  v_accvgpr_write_b32 a24, v32
  v_accvgpr_write_b32 a28, v37
  v_fmamk_f32 v32, v13, 0x42480000, v23
  v_cos_f32 v33, v32
  v_sin_f32 v34, v32
  v_cvt_pk_bf16_f32 v32, v35, v36
  v_cvt_pk_bf16_f32 v37, -v36, v35
  v_accvgpr_write_b32 a25, v32
  v_accvgpr_write_b32 a29, v37
  v_fmamk_f32 v32, v13, 0x424c0000, v23
  v_cos_f32 v13, v32
  v_sin_f32 v23, v32
  v_cvt_pk_bf16_f32 v32, v33, v34
  v_cvt_pk_bf16_f32 v35, -v34, v33
  v_accvgpr_write_b32 a26, v32
  v_accvgpr_write_b32 a30, v35
  v_mul_f32 v32, 0x41000000, v27
  v_mul_f32 v33, 0x3d000000, v12
  v_mul_f32 v34, v33, v32
  v_cos_f32 v35, v34
  v_sin_f32 v36, v34
  v_cvt_pk_bf16_f32 v37, v13, v23
  v_cvt_pk_bf16_f32 v38, -v23, v13
  v_accvgpr_write_b32 a27, v37
  v_accvgpr_write_b32 a31, v38
  v_fmamk_f32 v13, v33, 0x3f800000, v34
  v_cos_f32 v23, v13
  v_sin_f32 v37, v13
  v_cvt_pk_bf16_f32 v13, v35, v36
  v_accvgpr_write_b32 a32, v13
  v_fmamk_f32 v13, v33, 0x40000000, v34
  v_cos_f32 v35, v13
  v_sin_f32 v36, v13
  v_cvt_pk_bf16_f32 v13, v23, v37
  v_accvgpr_write_b32 a33, v13
  v_fmamk_f32 v13, v33, 0x40400000, v34
  v_cos_f32 v23, v13
  v_sin_f32 v37, v13
  v_cvt_pk_bf16_f32 v13, v35, v36
  v_accvgpr_write_b32 a34, v13
  v_fmamk_f32 v13, v33, 0x40800000, v34
  v_cos_f32 v35, v13
  v_sin_f32 v36, v13
  v_cvt_pk_bf16_f32 v13, v23, v37
  v_accvgpr_write_b32 a35, v13
  v_fmamk_f32 v13, v33, 0x40a00000, v34
  v_cos_f32 v23, v13
  v_sin_f32 v37, v13
  v_cvt_pk_bf16_f32 v13, v35, v36
  v_accvgpr_write_b32 a36, v13
  v_fmamk_f32 v13, v33, 0x40c00000, v34
  v_cos_f32 v35, v13
  v_sin_f32 v36, v13
  v_cvt_pk_bf16_f32 v13, v23, v37
  v_accvgpr_write_b32 a37, v13
  v_fmamk_f32 v13, v33, 0x40e00000, v34
  v_cos_f32 v23, v13
  v_sin_f32 v33, v13
  v_cvt_pk_bf16_f32 v13, v35, v36
  v_accvgpr_write_b32 a38, v13
  v_add_f32 v13, 4.0, v12
  v_mul_f32 v34, 0x3d000000, v13
  v_mul_f32 v35, v34, v32
  v_cos_f32 v36, v35
  v_sin_f32 v37, v35
  v_cvt_pk_bf16_f32 v38, v23, v33
  v_accvgpr_write_b32 a39, v38
  v_fmamk_f32 v23, v34, 0x3f800000, v35
  v_cos_f32 v33, v23
  v_sin_f32 v38, v23
  v_cvt_pk_bf16_f32 v23, v36, v37
  v_accvgpr_write_b32 a40, v23
  v_fmamk_f32 v23, v34, 0x40000000, v35
  v_cos_f32 v36, v23
  v_sin_f32 v37, v23
  v_cvt_pk_bf16_f32 v23, v33, v38
  v_accvgpr_write_b32 a41, v23
  v_fmamk_f32 v23, v34, 0x40400000, v35
  v_cos_f32 v33, v23
  v_sin_f32 v38, v23
  v_cvt_pk_bf16_f32 v23, v36, v37
  v_accvgpr_write_b32 a42, v23
  v_fmamk_f32 v23, v34, 0x40800000, v35
  v_cos_f32 v36, v23
  v_sin_f32 v37, v23
  v_cvt_pk_bf16_f32 v23, v33, v38
  v_accvgpr_write_b32 a43, v23
  v_fmamk_f32 v23, v34, 0x40a00000, v35
  v_cos_f32 v33, v23
  v_sin_f32 v38, v23
  v_cvt_pk_bf16_f32 v23, v36, v37
  v_accvgpr_write_b32 a44, v23
  v_fmamk_f32 v23, v34, 0x40c00000, v35
  v_cos_f32 v36, v23
  v_sin_f32 v37, v23
  v_cvt_pk_bf16_f32 v23, v33, v38
  v_accvgpr_write_b32 a45, v23
  v_fmamk_f32 v23, v34, 0x40e00000, v35
  v_cos_f32 v33, v23
  s_add_u32 m0, s65, 0x9800
  s_nop 0
  buffer_load_dwordx4 v5, s[20:23], s67 offen offset:0 lds
  buffer_load_dwordx4 v8, s[20:23], s67 offen offset:1024 lds
  s_add_u32 m0, s65, 0x8000
  s_nop 0
  buffer_load_dwordx4 v2, s[4:7], s66 offen offset:0 lds
  buffer_load_dwordx4 v9, s[4:7], s66 offen offset:1024 lds
  buffer_load_dwordx4 v10, s[4:7], s66 offen offset:2048 lds
  buffer_load_dwordx4 v11, s[4:7], s66 offen offset:3072 lds
  s_lshr_b32 s44, s2, 5
  s_min_u32 s44, s44, 4
  s_lshl_b32 s44, s44, 17
  s_and_b32 s45, s2, 31
  s_lshl_b32 s45, s45, 7
  s_add_u32 s45, s45, s44
  s_add_u32 s45, s45, 0x20000
  s_lshl_b32 s46, s2, 7
  s_add_u32 s46, s46, 0x10000
  v_mov_b32 v34, s45
  v_writelane_b32 v34, s46, 1
  s_lshl_b32 s44, s56, 28
  buffer_load_dword v35, v34, s[32:35], s44 offen sc1
  s_waitcnt vmcnt(9) lgkmcnt(0)
  s_barrier
  ds_read_b64_tr_b16 a[48:49], v24 offset:0
  ds_read_b128 v[40:43], v15 offset:0
  ds_read_b64_tr_b16 a[50:51], v24 offset:512
  ds_read_b128 v[44:47], v15 offset:8192
  ds_read_b128 v[48:51], v15 offset:16384
  ds_read_b128 v[52:55], v15 offset:24576
  s_waitcnt lgkmcnt(0)
  v_mfma_f32_32x32x16_bf16 v[56:71], a[48:51], v[40:43], 0
  ds_read_b64_tr_b16 a[52:53], v24 offset:8192
  ds_read_b128 v[40:43], v14 offset:0
  ds_read_b64_tr_b16 a[54:55], v24 offset:8704
  ds_read_b128 v[72:75], v14 offset:8192
  ds_read_b128 v[76:79], v14 offset:16384
  v_mfma_f32_32x32x16_bf16 v[80:95], a[48:51], v[44:47], 0
  s_add_u32 s44, s64, 2
  s_and_b32 s44, s44, 7
  s_lshl_b32 s45, s44, 7
  s_add_u32 s45, s45, s54
  s_mul_i32 s46, s44, 0x38000
  s_add_u32 s46, s46, s52
  s_add_u32 m0, s65, 0x11000
  s_nop 0
  buffer_load_dwordx4 v7, s[16:19], s46 offen offset:0 lds
  v_mfma_f32_32x32x16_bf16 v[96:111], a[48:51], v[48:51], 0
  ds_read_b128 v[44:47], v14 offset:24576
  buffer_load_dwordx4 v3, s[16:19], s46 offen offset:1024 lds
  s_add_u32 s48, s36, 0x9e3779b9
  s_mov_b32 s49, s48
  v_mfma_f32_32x32x16_bf16 v[112:127], a[48:51], v[52:55], 0
  s_add_u32 m0, s65, 0x11800
  s_nop 0
  buffer_load_dwordx4 v5, s[20:23], s46 offen offset:0 lds
  v_mov_b32 v34, s48
  v_min_u32 v38, 1, v6
  v_lshlrev_b32 v38, 30, v38
  v_sin_f32 v39, v23
  v_mfma_f32_16x16x32_bf16 v[48:51], v[28:31], a[48:51], 0
  v_cvt_pk_bf16_f32 v23, v36, v37
  s_waitcnt lgkmcnt(0)
  v_mfma_f32_32x32x16_bf16 v[56:71], a[52:55], v[40:43], v[56:71]
  ds_read_b64_tr_b16 a[56:57], v24 offset:16384
  ds_read_b128 v[40:43], v16 offset:0
  ds_read_b64_tr_b16 a[58:59], v24 offset:16896
  ds_read_b128 v[52:55], v16 offset:8192
  ds_read_b128 v[128:131], v16 offset:16384
  v_mfma_f32_32x32x16_bf16 v[80:95], a[52:55], v[72:75], v[80:95]
  buffer_load_dwordx4 v8, s[20:23], s46 offen offset:1024 lds
  ds_read_b128 v[72:75], v16 offset:24576
  v_accvgpr_write_b32 a46, v23
  v_cvt_pk_bf16_f32 v23, v33, v39
  v_accvgpr_write_b32 a47, v23
  v_mul_f32 v23, 0x3a000000, v26
  v_mfma_f32_32x32x16_bf16 v[96:111], a[52:55], v[76:79], v[96:111]
  s_add_u32 m0, s65, 0x10000
  s_nop 0
  buffer_load_dwordx4 v2, s[4:7], s45 offen offset:0 lds
  v_mul_f32 v26, v23, v32
  v_cos_f32 v76, v26
  v_sin_f32 v132, v26
  v_mfma_f32_32x32x16_bf16 v[112:127], a[52:55], v[44:47], v[112:127]
  buffer_load_dwordx4 v9, s[4:7], s45 offen offset:1024 lds
  v_fmamk_f32 v32, v23, 0x3f800000, v26
  v_cos_f32 v77, v32
  v_sin_f32 v133, v32
  v_mfma_f32_16x16x32_bf16 v[48:51], v[28:31], a[52:55], v[48:51]
  v_fmamk_f32 v32, v23, 0x40000000, v26
  s_waitcnt lgkmcnt(0)
  v_mfma_f32_32x32x16_bf16 v[56:71], a[56:59], v[40:43], v[56:71]
  ds_read_b64_tr_b16 a[60:61], v24 offset:24576
  ds_read_b128 v[40:43], v17 offset:0
  ds_read_b64_tr_b16 a[62:63], v24 offset:25088
  ds_read_b128 v[44:47], v17 offset:8192
  ds_read_b128 v[136:139], v17 offset:16384
  v_mfma_f32_32x32x16_bf16 v[80:95], a[56:59], v[52:55], v[80:95]
  buffer_load_dwordx4 v10, s[4:7], s45 offen offset:2048 lds
  ds_read_b128 v[52:55], v17 offset:24576
  v_cos_f32 v78, v32
  v_sin_f32 v134, v32
  v_mfma_f32_32x32x16_bf16 v[96:111], a[56:59], v[128:131], v[96:111]
  buffer_load_dwordx4 v11, s[4:7], s45 offen offset:3072 lds
  v_fmamk_f32 v32, v23, 0x40400000, v26
  v_cos_f32 v79, v32
  v_sin_f32 v135, v32
  v_mfma_f32_32x32x16_bf16 v[112:127], a[56:59], v[72:75], v[112:127]
  v_fmamk_f32 v32, v23, 0x40800000, v26
  v_cos_f32 v72, v32
  v_sin_f32 v128, v32
  v_fmamk_f32 v32, v23, 0x40a00000, v26
  v_mfma_f32_16x16x32_bf16 v[48:51], v[28:31], a[56:59], v[48:51]
  v_cos_f32 v73, v32
  s_waitcnt lgkmcnt(0)
  v_mfma_f32_32x32x16_bf16 v[56:71], a[60:63], v[40:43], v[56:71]
  s_waitcnt vmcnt(9)
  s_barrier
  ds_read_b64_tr_b16 a[64:65], v24 offset:32768
  ds_read_b128 v[40:43], v15 offset:32768
  ds_read_b64_tr_b16 a[66:67], v24 offset:33280
  v_mfma_f32_32x32x16_bf16 v[80:95], a[60:63], v[44:47], v[80:95]
  ds_read_b128 v[44:47], v15 offset:40960
  s_add_u32 s36, s64, 3
  s_and_b32 s36, s36, 7
  s_lshl_b32 s44, s36, 7
  s_add_u32 s44, s44, s54
  s_mul_i32 s45, s36, 0x38000
  s_add_u32 s45, s45, s52
  s_add_u32 m0, s65, 0x19000
  s_nop 0
  buffer_load_dwordx4 v7, s[16:19], s45 offen offset:0 lds
  v_mfma_f32_32x32x16_bf16 v[96:111], a[60:63], v[136:139], v[96:111]
  ds_read_b128 v[136:139], v15 offset:49152
  ds_read_b128 v[140:143], v15 offset:57344
  buffer_load_dwordx4 v3, s[16:19], s45 offen offset:1024 lds
  v_sin_f32 v129, v32
  v_mfma_f32_32x32x16_bf16 v[112:127], a[60:63], v[52:55], v[112:127]
  v_fmamk_f32 v4, v23, 0x40c00000, v26
  v_cos_f32 v74, v4
  v_sin_f32 v130, v4
  v_mfma_f32_16x16x32_bf16 v[48:51], v[28:31], a[60:63], v[48:51]
  s_add_u32 m0, s65, 0x19800
  s_nop 0
  buffer_load_dwordx4 v5, s[20:23], s45 offen offset:0 lds
  s_waitcnt lgkmcnt(0)
  v_mfma_f32_32x32x16_bf16 v[56:71], a[64:67], v[40:43], v[56:71]
  ds_read_b64_tr_b16 a[68:69], v24 offset:40960
  ds_read_b128 v[40:43], v14 offset:32768
  ds_read_b64_tr_b16 a[70:71], v24 offset:41472
  ds_read_b128 v[52:55], v14 offset:40960
  ds_read_b128 v[144:147], v14 offset:49152
  v_mfma_f32_32x32x16_bf16 v[80:95], a[64:67], v[44:47], v[80:95]
  ds_read_b128 v[44:47], v14 offset:57344
  v_fmamk_f32 v4, v23, 0x40e00000, v26
  v_cos_f32 v75, v4
  v_sin_f32 v131, v4
  v_mfma_f32_32x32x16_bf16 v[96:111], a[64:67], v[136:139], v[96:111]
  buffer_load_dwordx4 v8, s[20:23], s45 offen offset:1024 lds
  s_lshl_b32 s36, s56, 4
  v_cvt_f32_u32 v4, s36
  v_fmamk_f32 v4, v27, 0x40800000, v4
  v_mul_f32 v23, 0x3a000000, v12
  v_mul_f32 v12, v23, v4
  v_mfma_f32_32x32x16_bf16 v[112:127], a[64:67], v[140:143], v[112:127]
  v_cos_f32 v136, v12
  v_sin_f32 v140, v12
  v_fmamk_f32 v26, v23, 0x3f800000, v12
  v_cos_f32 v137, v26
  v_mfma_f32_16x16x32_bf16 v[48:51], v[28:31], a[64:67], v[48:51]
  s_add_u32 m0, s65, 0x18000
  s_nop 0
  buffer_load_dwordx4 v2, s[4:7], s44 offen offset:0 lds
  s_waitcnt lgkmcnt(0)
  v_mfma_f32_32x32x16_bf16 v[56:71], a[68:71], v[40:43], v[56:71]
  ds_read_b64_tr_b16 a[72:73], v24 offset:49152
  ds_read_b128 v[40:43], v16 offset:32768
  ds_read_b64_tr_b16 a[74:75], v24 offset:49664
  ds_read_b128 v[148:151], v16 offset:40960
  v_mfma_f32_32x32x16_bf16 v[80:95], a[68:71], v[52:55], v[80:95]
  ds_read_b128 v[52:55], v16 offset:49152
  ds_read_b128 v[152:155], v16 offset:57344
  buffer_load_dwordx4 v9, s[4:7], s44 offen offset:1024 lds
  v_sin_f32 v141, v26
  v_fmamk_f32 v26, v23, 0x40000000, v12
  v_mfma_f32_32x32x16_bf16 v[96:111], a[68:71], v[144:147], v[96:111]
  v_cos_f32 v138, v26
  v_sin_f32 v142, v26
  v_fmamk_f32 v26, v23, 0x40400000, v12
  v_cos_f32 v139, v26
  v_mfma_f32_32x32x16_bf16 v[112:127], a[68:71], v[44:47], v[112:127]
  v_sin_f32 v143, v26
  v_mul_f32 v12, 0x3a000000, v13
  v_mul_f32 v13, v12, v4
  v_cos_f32 v44, v13
  v_mfma_f32_16x16x32_bf16 v[48:51], v[28:31], a[68:71], v[48:51]
  buffer_load_dwordx4 v10, s[4:7], s44 offen offset:2048 lds
  s_waitcnt lgkmcnt(0)
  v_mfma_f32_32x32x16_bf16 v[56:71], a[72:75], v[40:43], v[56:71]
  ds_read_b64_tr_b16 a[76:77], v24 offset:57344
  ds_read_b128 v[40:43], v17 offset:32768
  ds_read_b64_tr_b16 a[78:79], v24 offset:57856
  ds_read_b128 v[144:147], v17 offset:40960
  ds_read_b128 v[156:159], v17 offset:49152
  v_mfma_f32_32x32x16_bf16 v[80:95], a[72:75], v[148:151], v[80:95]
  ds_read_b128 v[148:151], v17 offset:57344
  buffer_load_dwordx4 v11, s[4:7], s44 offen offset:3072 lds
  v_sin_f32 v160, v13
  v_fmamk_f32 v4, v12, 0x3f800000, v13
  v_cos_f32 v45, v4
  v_mfma_f32_32x32x16_bf16 v[96:111], a[72:75], v[52:55], v[96:111]
  v_sin_f32 v161, v4
  v_fmamk_f32 v4, v12, 0x40000000, v13
  v_cos_f32 v46, v4
  v_mfma_f32_32x32x16_bf16 v[112:127], a[72:75], v[152:155], v[112:127]
  v_sin_f32 v162, v4
  v_fmamk_f32 v4, v12, 0x40400000, v13
  v_cos_f32 v47, v4
  v_sin_f32 v163, v4
  v_mfma_f32_16x16x32_bf16 v[48:51], v[28:31], a[72:75], v[48:51]
  s_and_b32 s36, s59, 7
  s_waitcnt lgkmcnt(0)
  v_mfma_f32_32x32x16_bf16 v[56:71], a[76:79], v[40:43], v[56:71]
  s_waitcnt vmcnt(8)
  s_barrier
  ds_read_b64_tr_b16 a[80:81], v25 offset:0
  ds_read_b128 v[40:43], v18 offset:0
  ds_read_b64_tr_b16 a[82:83], v25 offset:512
  v_mfma_f32_32x32x16_bf16 v[80:95], a[76:79], v[144:147], v[80:95]
  ds_read_b128 v[52:55], v18 offset:8192
  s_add_u32 s44, s64, 4
  s_and_b32 s44, s44, 7
  s_lshl_b32 s45, s44, 7
  s_add_u32 s45, s45, s54
  s_mul_i32 s46, s44, 0x38000
  s_add_u32 s46, s46, s52
  s_add_u32 m0, s65, 0x1000
  s_nop 0
  buffer_load_dwordx4 v7, s[16:19], s46 offen offset:0 lds
  v_mfma_f32_32x32x16_bf16 v[96:111], a[76:79], v[156:159], v[96:111]
  ds_read_b128 v[144:147], v18 offset:16384
  ds_read_b128 v[152:155], v18 offset:24576
  buffer_load_dwordx4 v3, s[16:19], s46 offen offset:1024 lds
  s_mul_i32 s36, s36, 7
  v_mfma_f32_32x32x16_bf16 v[112:127], a[76:79], v[148:151], v[112:127]
  s_lshr_b32 s36, s36, 2
  s_mul_i32 s44, s58, 0
  s_lshr_b32 s44, s44, 1
  s_add_u32 s36, s36, s44
  s_mul_i32 s44, s57, 7
  s_lshr_b32 s44, s44, 2
  v_mfma_f32_16x16x32_bf16 v[48:51], v[28:31], a[76:79], v[48:51]
  s_add_u32 m0, s65, 0x1800
  s_nop 0
  buffer_load_dwordx4 v5, s[20:23], s46 offen offset:0 lds
  s_waitcnt lgkmcnt(0)
  v_mfma_f32_32x32x16_bf16 v[56:71], a[80:83], v[40:43], v[56:71]
  ds_read_b64_tr_b16 a[84:85], v25 offset:8192
  ds_read_b128 v[40:43], v19 offset:0
  ds_read_b64_tr_b16 a[86:87], v25 offset:8704
  ds_read_b128 v[148:151], v19 offset:8192
  ds_read_b128 v[156:159], v19 offset:16384
  v_mfma_f32_32x32x16_bf16 v[80:95], a[80:83], v[52:55], v[80:95]
  ds_read_b128 v[52:55], v19 offset:24576
  s_add_u32 s36, s36, s44
  s_sub_u32 s44, s36, 14
  s_min_u32 s36, s36, s44
  s_sub_u32 s44, s36, 14
  s_min_u32 s36, s36, s44
  v_mfma_f32_32x32x16_bf16 v[96:111], a[80:83], v[144:147], v[96:111]
  buffer_load_dwordx4 v8, s[20:23], s46 offen offset:1024 lds
  s_mul_i32 s44, s56, 14
  s_add_u32 s46, s36, 0
  s_sub_u32 s47, s46, 14
  s_min_u32 s46, s46, s47
  s_add_u32 s46, s46, s44
  v_mfma_f32_32x32x16_bf16 v[112:127], a[80:83], v[152:155], v[112:127]
  s_lshl_b32 s46, s46, 11
  s_add_u32 s47, s36, 1
  s_sub_u32 s50, s47, 14
  s_min_u32 s47, s47, s50
  s_add_u32 s47, s47, s44
  s_lshl_b32 s47, s47, 11
  v_mfma_f32_16x16x32_bf16 v[48:51], v[28:31], a[80:83], v[48:51]
  s_add_u32 m0, s65, 0
  s_nop 0
  buffer_load_dwordx4 v2, s[4:7], s45 offen offset:0 lds
  s_waitcnt lgkmcnt(0)
  v_mfma_f32_32x32x16_bf16 v[56:71], a[84:87], v[40:43], v[56:71]
  ds_read_b64_tr_b16 a[88:89], v25 offset:16384
  ds_read_b128 v[40:43], v20 offset:0
  ds_read_b64_tr_b16 a[90:91], v25 offset:16896
  ds_read_b128 v[144:147], v20 offset:8192
  ds_read_b128 v[152:155], v20 offset:16384
  v_mfma_f32_32x32x16_bf16 v[80:95], a[84:87], v[148:151], v[80:95]
  ds_read_b128 v[148:151], v20 offset:24576
  buffer_load_dwordx4 v9, s[4:7], s45 offen offset:1024 lds
  s_add_u32 s50, s36, 2
  s_sub_u32 s51, s50, 14
  s_min_u32 s50, s50, s51
  s_add_u32 s50, s50, s44
  v_mfma_f32_32x32x16_bf16 v[96:111], a[84:87], v[156:159], v[96:111]
  s_lshl_b32 s50, s50, 11
  s_add_u32 s51, s36, 3
  s_sub_u32 s53, s51, 14
  s_min_u32 s51, s51, s53
  s_add_u32 s51, s51, s44
  s_lshl_b32 s51, s51, 11
  v_mfma_f32_32x32x16_bf16 v[112:127], a[84:87], v[52:55], v[112:127]
  s_add_u32 s53, s36, 4
  s_sub_u32 s66, s53, 14
  s_min_u32 s53, s53, s66
  s_add_u32 s53, s53, s44
  s_lshl_b32 s53, s53, 11
  s_add_u32 s66, s36, 5
  v_mfma_f32_16x16x32_bf16 v[48:51], v[28:31], a[84:87], v[48:51]
  buffer_load_dwordx4 v10, s[4:7], s45 offen offset:2048 lds
  s_sub_u32 s67, s66, 14
  s_waitcnt lgkmcnt(0)
  v_mfma_f32_32x32x16_bf16 v[56:71], a[88:91], v[40:43], v[56:71]
  ds_read_b64_tr_b16 a[92:93], v25 offset:24576
  ds_read_b128 v[40:43], v21 offset:0
  ds_read_b64_tr_b16 a[94:95], v25 offset:25088
  ds_read_b128 v[52:55], v21 offset:8192
  ds_read_b128 v[156:159], v21 offset:16384
  v_mfma_f32_32x32x16_bf16 v[80:95], a[88:91], v[144:147], v[80:95]
  ds_read_b128 v[144:147], v21 offset:24576
  buffer_load_dwordx4 v11, s[4:7], s45 offen offset:3072 lds
  s_min_u32 s66, s66, s67
  s_add_u32 s66, s66, s44
  s_lshl_b32 s66, s66, 11
  s_add_u32 s45, s36, 6
  v_mfma_f32_32x32x16_bf16 v[96:111], a[88:91], v[152:155], v[96:111]
  s_sub_u32 s67, s45, 14
  s_min_u32 s45, s45, s67
  s_add_u32 s45, s45, s44
  s_lshl_b32 s45, s45, 11
  s_add_u32 s67, s36, 7
  s_sub_u32 s69, s67, 14
  v_mfma_f32_32x32x16_bf16 v[112:127], a[88:91], v[148:151], v[112:127]
  s_min_u32 s67, s67, s69
  s_add_u32 s67, s67, s44
  s_lshl_b32 s67, s67, 11
  s_add_u32 s69, s36, 8
  s_sub_u32 s70, s69, 14
  s_min_u32 s69, s69, s70
  v_mfma_f32_16x16x32_bf16 v[48:51], v[28:31], a[88:91], v[48:51]
  s_add_u32 s69, s69, s44
  s_lshl_b32 s69, s69, 11
  s_waitcnt lgkmcnt(0)
  v_mfma_f32_32x32x16_bf16 v[56:71], a[92:95], v[40:43], v[56:71]
  s_waitcnt vmcnt(8)
  s_barrier
  ds_read_b64_tr_b16 a[96:97], v25 offset:32768
  ds_read_b128 v[40:43], v18 offset:32768
  ds_read_b64_tr_b16 a[98:99], v25 offset:33280
  v_mfma_f32_32x32x16_bf16 v[80:95], a[92:95], v[52:55], v[80:95]
  ds_read_b128 v[52:55], v18 offset:40960
  v_min_u32 v4, 11, v6
  v_lshlrev_b32 v4, 21, v4
  v_min_u32 v12, 1, v6
  s_lshl_b32 s70, s56, 28
  buffer_load_dword v13, v4, s[32:35], s70 offen offset:2048
  v_mfma_f32_32x32x16_bf16 v[96:111], a[92:95], v[156:159], v[96:111]
  ds_read_b128 v[148:151], v18 offset:49152
  ds_read_b128 v[152:155], v18 offset:57344
  v_mul_u32_u24 v4, 0x1ff7fc, v12
  buffer_load_dword v23, v4, s[28:31], s70 offen offset:2048
  v_mul_u32_u24 v4, 0x1bf7fc, v12
  buffer_load_dword v26, v4, s[24:27], s70 offen offset:2048
  v_mfma_f32_32x32x16_bf16 v[112:127], a[92:95], v[144:147], v[112:127]
  v_mul_u32_u24 v4, 0x1007fc, v12
  s_add_u32 s71, s36, 9
  s_sub_u32 s72, s71, 14
  s_min_u32 s71, s71, s72
  s_add_u32 s71, s71, s44
  s_lshl_b32 s71, s71, 11
  v_mfma_f32_16x16x32_bf16 v[48:51], v[28:31], a[92:95], v[48:51]
  buffer_load_dword v27, v4, s[8:11], s70 offen offset:2048
  v_mul_u32_u24 v4, 0x1007fc, v12
  s_waitcnt lgkmcnt(0)
  v_mfma_f32_32x32x16_bf16 v[56:71], a[96:99], v[40:43], v[56:71]
  ds_read_b64_tr_b16 a[100:101], v25 offset:40960
  ds_read_b128 v[40:43], v19 offset:32768
  ds_read_b64_tr_b16 a[102:103], v25 offset:41472
  ds_read_b128 v[144:147], v19 offset:40960
  ds_read_b128 v[156:159], v19 offset:49152
  v_mfma_f32_32x32x16_bf16 v[80:95], a[96:99], v[52:55], v[80:95]
  buffer_load_dword v12, v4, s[12:15], s70 offen offset:2048
  ds_read_b128 v[52:55], v19 offset:57344
  s_add_u32 s70, s64, 5
  s_and_b32 s70, s70, 7
  s_lshl_b32 s72, s70, 7
  s_add_u32 s72, s72, s54
  v_mfma_f32_32x32x16_bf16 v[96:111], a[96:99], v[148:151], v[96:111]
  s_mul_i32 s73, s70, 0x38000
  s_add_u32 s73, s73, s52
  s_add_u32 m0, s65, 0x9000
  s_nop 0
  buffer_load_dwordx4 v7, s[16:19], s73 offen offset:0 lds
  v_lshrrev_b32 v4, 2, v6
  v_and_b32 v32, 3, v6
  v_mfma_f32_32x32x16_bf16 v[112:127], a[96:99], v[152:155], v[112:127]
  buffer_load_dwordx4 v3, s[16:19], s73 offen offset:1024 lds
  v_lshlrev_b32 v32, 3, v32
  v_lshl_add_u32 v33, v4, 7, v32
  s_lshl_b32 s70, s56, 5
  s_add_u32 s70, s70, 0x20000
  v_add_u32 v33, s70, v33
  v_mfma_f32_16x16x32_bf16 v[48:51], v[28:31], a[96:99], v[48:51]
  s_mov_b32 s70, 0x5040100
  s_mov_b32 s74, 0x7060302
  s_waitcnt lgkmcnt(0)
  v_mfma_f32_32x32x16_bf16 v[56:71], a[100:103], v[40:43], v[56:71]
  ds_read_b64_tr_b16 a[104:105], v25 offset:49152
  ds_read_b128 v[40:43], v20 offset:32768
  ds_read_b64_tr_b16 a[106:107], v25 offset:49664
  ds_read_b128 v[148:151], v20 offset:40960
  ds_read_b128 v[152:155], v20 offset:49152
  v_mfma_f32_32x32x16_bf16 v[80:95], a[100:103], v[144:147], v[80:95]
  s_add_u32 m0, s65, 0x9800
  s_nop 0
  buffer_load_dwordx4 v5, s[20:23], s73 offen offset:0 lds
  ds_read_b128 v[144:147], v20 offset:57344
  buffer_load_dwordx4 v8, s[20:23], s73 offen offset:1024 lds
  s_lshl_b32 s73, s58, 2
  s_add_u32 s73, s73, s56
  v_mfma_f32_32x32x16_bf16 v[96:111], a[100:103], v[156:159], v[96:111]
  v_and_b32 v4, 7, v6
  v_or_b32 v32, s73, v4
  v_min_u32 v32, 1, v32
  v_xor_b32 v32, 1, v32
  v_mul_u32_u24 v4, 0x2080, v4
  v_lshrrev_b32 v35, 4, v6
  v_mfma_f32_32x32x16_bf16 v[112:127], a[100:103], v[52:55], v[112:127]
  s_add_u32 m0, s65, 0x8000
  s_nop 0
  buffer_load_dwordx4 v2, s[4:7], s72 offen offset:0 lds
  v_lshl_add_u32 v4, v35, 4, v4
  v_and_b32 v35, 8, v6
  v_lshl_add_u32 v4, v35, 3, v4
  v_lshl_add_u32 v35, v32, 30, v4
  v_mfma_f32_16x16x32_bf16 v[48:51], v[28:31], a[100:103], v[48:51]
  buffer_load_dwordx4 v9, s[4:7], s72 offen offset:1024 lds
  v_add_u32 v32, 0x10400, v4
  s_waitcnt lgkmcnt(0)
  v_mfma_f32_32x32x16_bf16 v[56:71], a[104:107], v[40:43], v[56:71]
  ds_read_b64_tr_b16 a[108:109], v25 offset:57344
  ds_read_b128 v[40:43], v21 offset:32768
  ds_read_b64_tr_b16 a[110:111], v25 offset:57856
  ds_read_b128 v[52:55], v21 offset:40960
  ds_read_b128 v[156:159], v21 offset:49152
  v_mfma_f32_32x32x16_bf16 v[80:95], a[104:107], v[148:151], v[80:95]
  ds_read_b128 v[148:151], v21 offset:57344
  buffer_load_dwordx4 v10, s[4:7], s72 offen offset:2048 lds
  s_lshl_b32 s75, s73, 3
  s_add_u32 s75, s75, s57
  s_lshl_b32 s75, s75, 3
  s_add_u32 s75, s75, s59
  v_mfma_f32_32x32x16_bf16 v[96:111], a[104:107], v[152:155], v[96:111]
  buffer_load_dwordx4 v11, s[4:7], s72 offen offset:3072 lds
  s_lshl_b32 s75, s75, 2
  s_add_u32 s75, s75, 0x20000
  s_mul_i32 s73, s73, 0x20800
  s_and_b32 s72, s59, 1
  s_lshl_b32 s72, s72, 12
  v_mfma_f32_32x32x16_bf16 v[112:127], a[104:107], v[144:147], v[112:127]
  s_add_u32 s73, s73, s72
  s_lshr_b32 s72, s57, 1
  s_lshl_b32 s72, s72, 10
  s_add_u32 s73, s73, s72
  s_lshr_b32 s72, s59, 1
  s_lshl_b32 s72, s72, 8
  v_mfma_f32_16x16x32_bf16 v[48:51], v[28:31], a[104:107], v[48:51]
  s_add_u32 s73, s73, s72
  s_and_b32 s72, s57, 1
  s_waitcnt lgkmcnt(0)
  v_mfma_f32_32x32x16_bf16 v[56:71], a[108:111], v[40:43], v[56:71]
  s_waitcnt vmcnt(13)
  s_barrier
  ds_read_b64_tr_b16 a[112:113], v24 offset:0
  ds_read_b128 v[40:43], v15 offset:0
  ds_read_b64_tr_b16 a[114:115], v24 offset:512
  v_mfma_f32_32x32x16_bf16 v[80:95], a[108:111], v[52:55], v[80:95]
  ds_read_b128 v[52:55], v15 offset:8192
  s_add_u32 s76, s64, 6
  s_and_b32 s76, s76, 7
  s_lshl_b32 s77, s76, 7
  s_add_u32 s77, s77, s54
  s_mul_i32 s78, s76, 0x38000
  s_add_u32 s78, s78, s52
  s_add_u32 m0, s65, 0x11000
  s_nop 0
  buffer_load_dwordx4 v7, s[16:19], s78 offen offset:0 lds
  v_mfma_f32_32x32x16_bf16 v[96:111], a[108:111], v[156:159], v[96:111]
  ds_read_b128 v[144:147], v15 offset:16384
  ds_read_b128 v[152:155], v15 offset:24576
  buffer_load_dwordx4 v3, s[16:19], s78 offen offset:1024 lds
  s_lshl_b32 s72, s72, 7
  v_mfma_f32_32x32x16_bf16 v[112:127], a[108:111], v[148:151], v[112:127]
  s_add_u32 s73, s73, s72
  s_add_u32 s73, s73, 0x100000
  s_add_u32 s72, s36, 10
  s_sub_u32 s76, s72, 14
  s_min_u32 s72, s72, s76
  s_add_u32 s72, s72, s44
  v_mfma_f32_16x16x32_bf16 v[48:51], v[28:31], a[108:111], v[48:51]
  s_add_u32 m0, s65, 0x11800
  s_nop 0
  buffer_load_dwordx4 v5, s[20:23], s78 offen offset:0 lds
  s_waitcnt lgkmcnt(0)
  v_mfma_f32_32x32x16_bf16 v[56:71], a[112:115], v[40:43], v[56:71]
  ds_read_b64_tr_b16 a[116:117], v24 offset:8192
  ds_read_b128 v[40:43], v14 offset:0
  ds_read_b64_tr_b16 a[118:119], v24 offset:8704
  ds_read_b128 v[148:151], v14 offset:8192
  ds_read_b128 v[156:159], v14 offset:16384
  v_mfma_f32_32x32x16_bf16 v[80:95], a[112:115], v[52:55], v[80:95]
  ds_read_b128 v[52:55], v14 offset:24576
  s_lshl_b32 s72, s72, 11
  s_add_u32 s76, s36, 11
  s_sub_u32 s79, s76, 14
  s_min_u32 s76, s76, s79
  s_add_u32 s76, s76, s44
  v_mfma_f32_32x32x16_bf16 v[96:111], a[112:115], v[144:147], v[96:111]
  buffer_load_dwordx4 v8, s[20:23], s78 offen offset:1024 lds
  s_lshl_b32 s76, s76, 11
  s_add_u32 s78, s36, 12
  s_sub_u32 s79, s78, 14
  s_min_u32 s78, s78, s79
  s_add_u32 s78, s78, s44
  v_mfma_f32_32x32x16_bf16 v[112:127], a[112:115], v[152:155], v[112:127]
  s_lshl_b32 s78, s78, 11
  s_add_u32 s79, s36, 13
  s_sub_u32 s36, s79, 14
  s_min_u32 s79, s79, s36
  s_add_u32 s79, s79, s44
  s_lshl_b32 s79, s79, 11
  v_mfma_f32_16x16x32_bf16 v[48:51], v[28:31], a[112:115], v[48:51]
  s_add_u32 m0, s65, 0x10000
  s_nop 0
  buffer_load_dwordx4 v2, s[4:7], s77 offen offset:0 lds
  s_waitcnt lgkmcnt(0)
  v_mfma_f32_32x32x16_bf16 v[56:71], a[116:119], v[40:43], v[56:71]
  ds_read_b64_tr_b16 a[120:121], v24 offset:16384
  ds_read_b128 v[40:43], v16 offset:0
  ds_read_b64_tr_b16 a[122:123], v24 offset:16896
  ds_read_b128 v[144:147], v16 offset:8192
  ds_read_b128 v[152:155], v16 offset:16384
  v_mfma_f32_32x32x16_bf16 v[80:95], a[116:119], v[148:151], v[80:95]
  ds_read_b128 v[148:151], v16 offset:24576
  buffer_load_dwordx4 v9, s[4:7], s77 offen offset:1024 lds
  s_lshl_b32 s36, s61, 7
  s_mul_i32 s44, s55, 0x38000
  s_add_u32 s44, s44, 0x1000000
  v_bfe_u32 v4, v6, 4, 1
  v_mfma_f32_32x32x16_bf16 v[96:111], a[116:119], v[156:159], v[96:111]
  v_lshlrev_b32 v4, 2, v4
  v_and_b32 v36, 7, v6
  v_xor_b32 v4, v4, v36
  v_lshlrev_b32 v37, 4, v4
  v_lshrrev_b32 v36, 3, v6
  v_lshl_add_u32 v4, v36, 10, v37
  v_mfma_f32_32x32x16_bf16 v[112:127], a[116:119], v[52:55], v[112:127]
  v_add_u32 v36, 0x1c00, v4
  v_add_u32 v39, 0x3800, v4
  v_add_u32 v52, 0x5400, v4
  v_mfma_f32_16x16x32_bf16 v[48:51], v[28:31], a[116:119], v[48:51]
  buffer_load_dwordx4 v10, s[4:7], s77 offen offset:2048 lds
  s_waitcnt lgkmcnt(0)
  v_mfma_f32_32x32x16_bf16 v[56:71], a[120:123], v[40:43], v[56:71]
  ds_read_b64_tr_b16 a[124:125], v24 offset:24576
  ds_read_b128 v[40:43], v17 offset:0
  ds_read_b64_tr_b16 a[126:127], v24 offset:25088
  ds_read_b128 v[156:159], v17 offset:8192
  ds_read_b128 v[164:167], v17 offset:16384
  v_mfma_f32_32x32x16_bf16 v[80:95], a[120:123], v[144:147], v[80:95]
  ds_read_b128 v[144:147], v17 offset:24576
  buffer_load_dwordx4 v11, s[4:7], s77 offen offset:3072 lds
  v_mfma_f32_32x32x16_bf16 v[96:111], a[120:123], v[152:155], v[96:111]
  v_mfma_f32_32x32x16_bf16 v[112:127], a[120:123], v[148:151], v[112:127]
  v_mfma_f32_16x16x32_bf16 v[48:51], v[28:31], a[120:123], v[48:51]
  s_waitcnt lgkmcnt(0)
  v_mfma_f32_32x32x16_bf16 v[56:71], a[124:127], v[40:43], v[56:71]
  s_waitcnt vmcnt(8)
  s_barrier
  ds_read_b64_tr_b16 a[128:129], v24 offset:32768
  ds_read_b128 v[40:43], v15 offset:32768
  ds_read_b64_tr_b16 a[130:131], v24 offset:33280
  v_mfma_f32_32x32x16_bf16 v[80:95], a[124:127], v[156:159], v[80:95]
  ds_read_b128 v[148:151], v15 offset:40960
  s_add_u32 s77, s64, 7
  s_and_b32 s77, s77, 7
  s_lshl_b32 s64, s77, 7
  s_add_u32 s64, s64, s54
  s_mul_i32 s54, s77, 0x38000
  s_add_u32 s54, s54, s52
  s_add_u32 m0, s65, 0x19000
  s_nop 0
  buffer_load_dwordx4 v7, s[16:19], s54 offen offset:0 lds
  v_mfma_f32_32x32x16_bf16 v[96:111], a[124:127], v[164:167], v[96:111]
  ds_read_b128 v[152:155], v15 offset:49152
  ds_read_b128 v[156:159], v15 offset:57344
  buffer_load_dwordx4 v3, s[16:19], s54 offen offset:1024 lds
  v_mfma_f32_32x32x16_bf16 v[112:127], a[124:127], v[144:147], v[112:127]
  v_mfma_f32_16x16x32_bf16 v[48:51], v[28:31], a[124:127], v[48:51]
  s_add_u32 m0, s65, 0x19800
  s_nop 0
  buffer_load_dwordx4 v5, s[20:23], s54 offen offset:0 lds
  s_waitcnt lgkmcnt(0)
  v_mfma_f32_32x32x16_bf16 v[56:71], a[128:131], v[40:43], v[56:71]
  ds_read_b64_tr_b16 a[132:133], v24 offset:40960
  ds_read_b128 v[40:43], v14 offset:32768
  ds_read_b64_tr_b16 a[134:135], v24 offset:41472
  ds_read_b128 v[144:147], v14 offset:40960
  ds_read_b128 v[164:167], v14 offset:49152
  v_mfma_f32_32x32x16_bf16 v[80:95], a[128:131], v[148:151], v[80:95]
  ds_read_b128 v[148:151], v14 offset:57344
  v_mfma_f32_32x32x16_bf16 v[96:111], a[128:131], v[152:155], v[96:111]
  buffer_load_dwordx4 v8, s[20:23], s54 offen offset:1024 lds
  v_mfma_f32_32x32x16_bf16 v[112:127], a[128:131], v[156:159], v[112:127]
  v_mfma_f32_16x16x32_bf16 v[48:51], v[28:31], a[128:131], v[48:51]
  s_add_u32 m0, s65, 0x18000
  s_nop 0
  buffer_load_dwordx4 v2, s[4:7], s64 offen offset:0 lds
  s_waitcnt lgkmcnt(0)
  v_mfma_f32_32x32x16_bf16 v[56:71], a[132:135], v[40:43], v[56:71]
  ds_read_b64_tr_b16 a[136:137], v24 offset:49152
  ds_read_b128 v[40:43], v16 offset:32768
  ds_read_b64_tr_b16 a[138:139], v24 offset:49664
  ds_read_b128 v[152:155], v16 offset:40960
  ds_read_b128 v[156:159], v16 offset:49152
  v_mfma_f32_32x32x16_bf16 v[80:95], a[132:135], v[144:147], v[80:95]
  ds_read_b128 v[144:147], v16 offset:57344
  buffer_load_dwordx4 v9, s[4:7], s64 offen offset:1024 lds
  v_mfma_f32_32x32x16_bf16 v[96:111], a[132:135], v[164:167], v[96:111]
  v_mfma_f32_32x32x16_bf16 v[112:127], a[132:135], v[148:151], v[112:127]
  v_mfma_f32_16x16x32_bf16 v[48:51], v[28:31], a[132:135], v[48:51]
  buffer_load_dwordx4 v10, s[4:7], s64 offen offset:2048 lds
  s_waitcnt lgkmcnt(0)
  v_mfma_f32_32x32x16_bf16 v[56:71], a[136:139], v[40:43], v[56:71]
  ds_read_b64_tr_b16 a[140:141], v24 offset:57344
  ds_read_b128 v[40:43], v17 offset:32768
  ds_read_b64_tr_b16 a[142:143], v24 offset:57856
  ds_read_b128 v[148:151], v17 offset:40960
  ds_read_b128 v[164:167], v17 offset:49152
  v_mfma_f32_32x32x16_bf16 v[80:95], a[136:139], v[152:155], v[80:95]
  ds_read_b128 v[152:155], v17 offset:57344
  buffer_load_dwordx4 v11, s[4:7], s64 offen offset:3072 lds
  v_mfma_f32_32x32x16_bf16 v[96:111], a[136:139], v[156:159], v[96:111]
  v_mfma_f32_32x32x16_bf16 v[112:127], a[136:139], v[144:147], v[112:127]
  v_mfma_f32_16x16x32_bf16 v[48:51], v[28:31], a[136:139], v[48:51]
  s_waitcnt lgkmcnt(0)
  v_mfma_f32_32x32x16_bf16 v[56:71], a[140:143], v[40:43], v[56:71]
  s_waitcnt vmcnt(8)
  s_barrier
  ds_read_b64_tr_b16 a[144:145], v25 offset:0
  ds_read_b128 v[40:43], v18 offset:0
  ds_read_b64_tr_b16 a[146:147], v25 offset:512
  v_mfma_f32_32x32x16_bf16 v[80:95], a[140:143], v[148:151], v[80:95]
  ds_read_b128 v[144:147], v18 offset:8192
  v_and_b32 v3, 15, v6
  v_lshlrev_b32 v3, 7, v3
  s_lshl_b32 s52, s63, 3
  s_add_u32 s52, s52, s62
  s_lshl_b32 s52, s52, 2
  s_add_u32 s52, s52, s56
  s_lshl_b32 s52, s52, 11
  buffer_load_dword v5, v3, s[24:27], s52 offen
  v_mfma_f32_32x32x16_bf16 v[96:111], a[140:143], v[164:167], v[96:111]
  ds_read_b128 v[148:151], v18 offset:16384
  ds_read_b128 v[156:159], v18 offset:24576
  s_lshl_b32 s52, s57, 3
  s_lshl_b32 s54, s59, 8
  s_add_u32 s52, s52, s54
  s_lshl_b32 s54, s56, 1
  s_add_u32 s52, s52, s54
  s_mul_i32 s52, s52, 0x202
  s_lshl_b32 s54, s58, 7
  s_add_u32 s58, s52, s54
  v_lshrrev_b32 v3, 5, v6
  v_bfe_u32 v7, v6, 3, 2
  v_lshl_add_u32 v3, v7, 6, v3
  v_mul_u32_u24 v3, 0x202, v3
  v_and_b32 v7, 7, v6
  v_lshl_add_u32 v8, v7, 4, v3
  s_lshl_b32 s52, s56, 10
  s_add_u32 m0, s52, 0x20000
  s_nop 0
  buffer_load_dwordx4 v8, s[8:11], s58 offen lds
  v_mfma_f32_32x32x16_bf16 v[112:127], a[140:143], v[152:155], v[112:127]
  s_add_u32 m0, s52, 0x21000
  s_nop 0
  buffer_load_dwordx4 v8, s[12:15], s58 offen lds
  s_add_u32 s52, s37, s39
  s_lshl_b32 s54, s62, 12
  v_mfma_f32_16x16x32_bf16 v[48:51], v[28:31], a[140:143], v[48:51]
  s_add_u32 s54, s54, 0x10000
  s_waitcnt lgkmcnt(0)
  v_mfma_f32_32x32x16_bf16 v[56:71], a[144:147], v[40:43], v[56:71]
  ds_read_b64_tr_b16 a[148:149], v25 offset:8192
  ds_read_b128 v[40:43], v19 offset:0
  ds_read_b64_tr_b16 a[150:151], v25 offset:8704
  ds_read_b128 v[152:155], v19 offset:8192
  ds_read_b128 v[164:167], v19 offset:16384
  v_mfma_f32_32x32x16_bf16 v[80:95], a[144:147], v[144:147], v[80:95]
  s_add_u32 m0, s65, 0
  s_nop 0
  buffer_load_dwordx4 v2, s[4:7], s52 offen offset:0 lds
  ds_read_b128 v[144:147], v19 offset:24576
  buffer_load_dwordx4 v9, s[4:7], s52 offen offset:1024 lds
  s_add_u32 s58, s54, 0
  buffer_load_dwordx4 v[168:171], v22, s[32:35], s58 offen sc1
  v_mfma_f32_32x32x16_bf16 v[96:111], a[144:147], v[148:151], v[96:111]
  s_add_u32 s64, s54, 0x400
  buffer_load_dwordx4 v[148:151], v22, s[32:35], s64 offen sc1
  s_add_u32 s77, s54, 0x800
  buffer_load_dwordx4 v[172:175], v22, s[32:35], s77 offen sc1
  s_add_u32 s80, s54, 0xc00
  buffer_load_dwordx4 v[176:179], v22, s[32:35], s80 offen sc1
  v_mfma_f32_32x32x16_bf16 v[112:127], a[144:147], v[156:159], v[112:127]
  buffer_load_dwordx4 v10, s[4:7], s52 offen offset:2048 lds
  s_lshr_b32 s81, s39, 6
  s_add_u32 s81, s81, s54
  s_add_u32 s81, s81, 0x200
  buffer_load_dwordx4 v[156:159], v22, s[32:35], s81 offen sc1
  v_mfma_f32_16x16x32_bf16 v[48:51], v[28:31], a[144:147], v[48:51]
  s_waitcnt lgkmcnt(0)
  v_mfma_f32_32x32x16_bf16 v[56:71], a[148:151], v[40:43], v[56:71]
  ds_read_b64_tr_b16 a[152:153], v25 offset:16384
  ds_read_b128 v[40:43], v20 offset:0
  ds_read_b64_tr_b16 a[154:155], v25 offset:16896
  ds_read_b128 v[180:183], v20 offset:8192
  ds_read_b128 v[184:187], v20 offset:16384
  v_mfma_f32_32x32x16_bf16 v[80:95], a[148:151], v[152:155], v[80:95]
  buffer_load_dwordx4 v11, s[4:7], s52 offen offset:3072 lds
  ds_read_b128 v[152:155], v20 offset:24576
  s_add_u32 s52, s38, s39
  v_mfma_f32_32x32x16_bf16 v[96:111], a[148:151], v[164:167], v[96:111]
  s_add_u32 m0, s65, 0x1000
  s_nop 0
  buffer_load_dwordx4 v2, s[4:7], s52 offen offset:0 lds
  v_mfma_f32_32x32x16_bf16 v[112:127], a[148:151], v[144:147], v[112:127]
  buffer_load_dwordx4 v9, s[4:7], s52 offen offset:1024 lds
  v_mfma_f32_16x16x32_bf16 v[48:51], v[28:31], a[148:151], v[48:51]
  s_waitcnt lgkmcnt(0)
  v_mfma_f32_32x32x16_bf16 v[56:71], a[152:155], v[40:43], v[56:71]
  ds_read_b64_tr_b16 a[156:157], v25 offset:24576
  ds_read_b128 v[40:43], v21 offset:0
  ds_read_b64_tr_b16 a[158:159], v25 offset:25088
  ds_read_b128 v[144:147], v21 offset:8192
  ds_read_b128 v[164:167], v21 offset:16384
  v_mfma_f32_32x32x16_bf16 v[80:95], a[152:155], v[180:183], v[80:95]
  buffer_load_dwordx4 v10, s[4:7], s52 offen offset:2048 lds
  ds_read_b128 v[180:183], v21 offset:24576
  v_mfma_f32_32x32x16_bf16 v[96:111], a[152:155], v[184:187], v[96:111]
  buffer_load_dwordx4 v11, s[4:7], s52 offen offset:3072 lds
  v_mfma_f32_32x32x16_bf16 v[112:127], a[152:155], v[152:155], v[112:127]
  v_mfma_f32_16x16x32_bf16 v[48:51], v[28:31], a[152:155], v[48:51]
  s_waitcnt lgkmcnt(0)
  v_mfma_f32_32x32x16_bf16 v[56:71], a[156:159], v[40:43], v[56:71]
  s_waitcnt vmcnt(16)
  s_barrier
  ds_read_b64_tr_b16 a[160:161], v25 offset:32768
  ds_read_b128 v[40:43], v18 offset:32768
  ds_read_b64_tr_b16 a[162:163], v25 offset:33280
  v_mfma_f32_32x32x16_bf16 v[80:95], a[156:159], v[144:147], v[80:95]
  ds_read_b128 v[144:147], v18 offset:40960
  s_add_u32 s52, s37, s40
  s_add_u32 m0, s65, 0x8000
  s_nop 0
  buffer_load_dwordx4 v2, s[4:7], s52 offen offset:0 lds
  ds_read_b128 v[152:155], v18 offset:49152
  ds_read_b128 v[184:187], v18 offset:57344
  v_mfma_f32_32x32x16_bf16 v[96:111], a[156:159], v[164:167], v[96:111]
  buffer_load_dwordx4 v9, s[4:7], s52 offen offset:1024 lds
  v_mfma_f32_32x32x16_bf16 v[112:127], a[156:159], v[180:183], v[112:127]
  v_mfma_f32_16x16x32_bf16 v[48:51], v[28:31], a[156:159], v[48:51]
  buffer_load_dwordx4 v10, s[4:7], s52 offen offset:2048 lds
  s_waitcnt lgkmcnt(0)
  v_mfma_f32_32x32x16_bf16 v[56:71], a[160:163], v[40:43], v[56:71]
  ds_read_b64_tr_b16 a[164:165], v25 offset:40960
  ds_read_b128 v[40:43], v19 offset:32768
  ds_read_b64_tr_b16 a[166:167], v25 offset:41472
  ds_read_b128 v[164:167], v19 offset:40960
  ds_read_b128 v[180:183], v19 offset:49152
  v_mfma_f32_32x32x16_bf16 v[80:95], a[160:163], v[144:147], v[80:95]
  ds_read_b128 v[144:147], v19 offset:57344
  v_mfma_f32_32x32x16_bf16 v[96:111], a[160:163], v[152:155], v[96:111]
  buffer_load_dwordx4 v11, s[4:7], s52 offen offset:3072 lds
  s_add_u32 s52, s38, s40
  v_mfma_f32_32x32x16_bf16 v[112:127], a[160:163], v[184:187], v[112:127]
  v_mfma_f32_16x16x32_bf16 v[48:51], v[28:31], a[160:163], v[48:51]
  s_add_u32 m0, s65, 0x9000
  s_nop 0
  buffer_load_dwordx4 v2, s[4:7], s52 offen offset:0 lds
  s_waitcnt lgkmcnt(0)
  v_mfma_f32_32x32x16_bf16 v[56:71], a[164:167], v[40:43], v[56:71]
  ds_read_b64_tr_b16 a[168:169], v25 offset:49152
  ds_read_b128 v[40:43], v20 offset:32768
  ds_read_b64_tr_b16 a[170:171], v25 offset:49664
  ds_read_b128 v[152:155], v20 offset:40960
  ds_read_b128 v[184:187], v20 offset:49152
  v_mfma_f32_32x32x16_bf16 v[80:95], a[164:167], v[164:167], v[80:95]
  ds_read_b128 v[164:167], v20 offset:57344
  buffer_load_dwordx4 v9, s[4:7], s52 offen offset:1024 lds
  v_mfma_f32_32x32x16_bf16 v[96:111], a[164:167], v[180:183], v[96:111]
  v_mfma_f32_32x32x16_bf16 v[112:127], a[164:167], v[144:147], v[112:127]
  v_mfma_f32_16x16x32_bf16 v[48:51], v[28:31], a[164:167], v[48:51]
  buffer_load_dwordx4 v10, s[4:7], s52 offen offset:2048 lds
  s_waitcnt lgkmcnt(0)
  v_mfma_f32_32x32x16_bf16 v[56:71], a[168:171], v[40:43], v[56:71]
  ds_read_b64_tr_b16 a[172:173], v25 offset:57344
  ds_read_b128 v[40:43], v21 offset:32768
  ds_read_b64_tr_b16 a[174:175], v25 offset:57856
  ds_read_b128 v[144:147], v21 offset:40960
  ds_read_b128 v[180:183], v21 offset:49152
  v_mfma_f32_32x32x16_bf16 v[80:95], a[168:171], v[152:155], v[80:95]
  ds_read_b128 v[152:155], v21 offset:57344
  buffer_load_dwordx4 v11, s[4:7], s52 offen offset:3072 lds
  v_mfma_f32_32x32x16_bf16 v[96:111], a[168:171], v[184:187], v[96:111]
  v_mfma_f32_32x32x16_bf16 v[112:127], a[168:171], v[164:167], v[112:127]
  v_mfma_f32_16x16x32_bf16 v[48:51], v[28:31], a[168:171], v[48:51]
  s_waitcnt lgkmcnt(0)
  v_mfma_f32_32x32x16_bf16 v[56:71], a[172:175], v[40:43], v[56:71]
  s_waitcnt vmcnt(8)
  s_barrier
  ds_read_b128 v[24:27], v15 offset:0
  ds_read_b128 v[40:43], v14 offset:0
  v_mfma_f32_32x32x16_bf16 v[80:95], a[172:175], v[144:147], v[80:95]
  ds_read_b128 v[144:147], v16 offset:0
  ds_read_b128 v[164:167], v17 offset:0
  v_mfma_f32_32x32x16_bf16 v[96:111], a[172:175], v[180:183], v[96:111]
  ds_read_b128 v[180:183], v15 offset:4096
  ds_read_b128 v[184:187], v14 offset:4096
  v_mfma_f32_32x32x16_bf16 v[112:127], a[172:175], v[152:155], v[112:127]
  ds_read_b128 v[152:155], v16 offset:4096
  v_mfma_f32_16x16x32_bf16 v[48:51], v[28:31], a[172:175], v[48:51]
  s_waitcnt lgkmcnt(3)
  v_mfma_f32_32x32x16_bf16 v[188:203], a[48:51], v[24:27], 0
  ds_read_b128 v[24:27], v17 offset:4096
  v_mov_b32 v29, 0
  v_mov_b32 v205, 0
  v_mov_b32 v209, 0
  v_mov_b32 v30, 0
  v_mfma_f32_32x32x16_bf16 v[188:203], a[52:55], v[40:43], v[188:203]
  ds_read_b128 v[40:43], v15 offset:8192
  s_add_u32 s52, s37, s41
  s_add_u32 m0, s65, 0x10000
  s_nop 0
  buffer_load_dwordx4 v2, s[4:7], s52 offen offset:0 lds
  ds_read_b64_tr_b16 v[12:13], v33 offset:0
  ds_read_b64_tr_b16 v[54:55], v33 offset:4096
  ds_read_b64_tr_b16 v[212:213], v33 offset:2048
  ds_read_b64_tr_b16 v[214:215], v33 offset:6144
  v_mfma_f32_32x32x16_bf16 v[188:203], a[56:59], v[144:147], v[188:203]
  ds_read_b128 v[144:147], v14 offset:8192
  v_mov_b32 v206, 0
  v_mov_b32 v210, 0
  v_mov_b32 v31, 0
  v_mfma_f32_32x32x16_bf16 v[188:203], a[60:63], v[164:167], v[188:203]
  ds_read_b128 v[164:167], v16 offset:8192
  v_mov_b32 v207, 0
  v_mov_b32 v211, 0
  s_mov_b32 s82, 0xffff0000
  s_mov_b32 s83, 0xffff0000
  s_mov_b32 s84, 0
  s_mov_b32 s85, -1
  s_waitcnt lgkmcnt(7)
  v_mfma_f32_32x32x16_bf16 v[188:203], a[64:67], v[180:183], v[188:203]
  ds_read_b128 v[180:183], v17 offset:8192
  v_cndmask_b32 v3, v48, v49, s[82:83]
  v_cvt_pk_bf16_f32 v5, v3, v3
  v_and_b32 v7, 0xffff0000, v5
  v_sub_f32 v3, v3, v7
  v_cvt_pk_bf16_f32 v3, v3, v3
  v_cndmask_b32 v28, v5, v3, s[84:85]
  buffer_load_dwordx4 v9, s[4:7], s52 offen offset:1024 lds
  v_mfma_f32_32x32x16_bf16 v[188:203], a[68:71], v[184:187], v[188:203]
  ds_read_b128 v[48:51], v15 offset:12288
  v_cmp_ne_u32 vcc, s48, v171
  s_nop 0
  s_cbranch_vccnz L_poll1
L_back1:
  v_mov_b32 v204, v168
  v_mfma_f32_32x32x16_bf16 v[188:203], a[72:75], v[152:155], v[188:203]
  ds_read_b128 v[152:155], v14 offset:12288
  s_waitcnt lgkmcnt(7)
  v_perm_b32 v184, v54, v12, s70
  v_perm_b32 v185, v54, v12, s74
  v_perm_b32 v186, v55, v13, s70
  v_perm_b32 v187, v55, v13, s74
  s_waitcnt lgkmcnt(5)
  v_perm_b32 v216, v214, v212, s70
  v_mfma_f32_32x32x16_bf16 v[56:71], v[28:31], v[204:207], v[56:71]
  v_cmp_ne_u32 vcc, s48, v151
  s_nop 0
  s_cbranch_vccnz L_poll2
L_back2:
  v_mov_b32 v208, v148
  buffer_load_dwordx4 v10, s[4:7], s52 offen offset:2048 lds
  v_perm_b32 v217, v214, v212, s74
  v_perm_b32 v218, v215, v213, s70
  v_mfma_f32_32x32x16_bf16 v[188:203], a[76:79], v[24:27], v[188:203]
  ds_read_b128 v[24:27], v16 offset:12288
  s_mul_i32 s58, s62, 0x380
  s_lshl_b32 s64, s63, 2
  s_add_u32 s58, s58, s64
  s_add_u32 s58, s58, s56
  s_lshl_b32 s58, s58, 10
  s_add_u32 s58, s58, 0x1000000
  s_waitcnt lgkmcnt(3)
  v_mfma_f32_32x32x16_bf16 v[188:203], a[80:83], v[40:43], v[188:203]
  ds_read_b128 v[40:43], v17 offset:12288
  v_perm_b32 v219, v215, v213, s74
  v_mov_b32 v212, v184
  v_mov_b32 v213, v185
  v_mfma_f32_32x32x16_bf16 v[80:95], v[28:31], v[208:211], v[80:95]
  v_cmp_ne_u32 vcc, s48, v175
  s_nop 0
  s_cbranch_vccnz L_poll3
L_back3:
  v_mov_b32 v204, v172
  buffer_load_dwordx4 v11, s[4:7], s52 offen offset:3072 lds
  v_mov_b32 v214, v186
  v_mov_b32 v215, v187
  v_mfma_f32_32x32x16_bf16 v[188:203], a[84:87], v[144:147], v[188:203]
  ds_read_b128 v[144:147], v15 offset:16384
  s_add_u32 s52, s38, s41
  v_mov_b32_dpp v184, v216 row_ror:8 row_mask:0xf bank_mask:0xc
  v_mov_b32_dpp v185, v217 row_ror:8 row_mask:0xf bank_mask:0xc
  v_mov_b32_dpp v186, v218 row_ror:8 row_mask:0xf bank_mask:0xc
  v_mov_b32_dpp v187, v219 row_ror:8 row_mask:0xf bank_mask:0xc
  v_mfma_f32_32x32x16_bf16 v[188:203], a[88:91], v[164:167], v[188:203]
  ds_read_b128 v[164:167], v14 offset:16384
  v_mov_b32_dpp v216, v212 row_ror:8 row_mask:0xf bank_mask:0x3
  v_mov_b32_dpp v217, v213 row_ror:8 row_mask:0xf bank_mask:0x3
  v_mov_b32_dpp v218, v214 row_ror:8 row_mask:0xf bank_mask:0x3
  v_mov_b32_dpp v219, v215 row_ror:8 row_mask:0xf bank_mask:0x3
  buffer_store_dwordx4 v[184:187], v35, s[32:35], s73 offen sc1
  buffer_store_dwordx4 v[216:219], v32, s[32:35], s73 offen sc1
  v_mfma_f32_32x32x16_bf16 v[96:111], v[28:31], v[204:207], v[96:111]
  v_cmp_ne_u32 vcc, s48, v179
  s_nop 0
  s_cbranch_vccnz L_poll4
L_back4:
  v_mov_b32 v208, v176
  s_lshl_b32 s63, s62, 2
  s_lshr_b32 s62, s57, 1
  v_mfma_f32_32x32x16_bf16 v[188:203], a[92:95], v[180:183], v[188:203]
  ds_read_b128 v[180:183], v16 offset:16384
  s_add_u32 m0, s65, 0x11000
  s_nop 0
  buffer_load_dwordx4 v2, s[4:7], s52 offen offset:0 lds
  s_add_u32 s63, s63, s62
  s_lshl_b32 s63, s63, 3
  s_add_u32 s63, s63, s59
  s_waitcnt lgkmcnt(3)
  v_mfma_f32_32x32x16_bf16 v[188:203], a[96:99], v[48:51], v[188:203]
  ds_read_b128 v[48:51], v17 offset:16384
  s_lshl_b32 s63, s63, 2
  s_add_u32 s63, s63, s56
  s_lshl_b32 s63, s63, 2
  s_add_u32 s63, s63, 0x60000
  v_mfma_f32_32x32x16_bf16 v[112:127], v[28:31], v[208:211], v[112:127]
  v_mul_f32 v56, v169, v56
  v_mul_f32 v57, v169, v57
  v_exp_f32 v56, v56
  v_exp_f32 v57, v57
  v_mfma_f32_32x32x16_bf16 v[188:203], a[100:103], v[152:155], v[188:203]
  ds_read_b128 v[152:155], v15 offset:20480
  buffer_load_dwordx4 v9, s[4:7], s52 offen offset:1024 lds
  v_fma_f32 v56, v56, v170, v170
  v_fma_f32 v57, v57, v170, v170
  v_rcp_f32 v56, v56
  v_mfma_f32_32x32x16_bf16 v[188:203], a[104:107], v[24:27], v[188:203]
  ds_read_b128 v[24:27], v14 offset:20480
  v_rcp_f32 v57, v57
  v_mul_f32 v64, v56, v64
  v_mul_f32 v65, v57, v65
  v_cvt_pk_bf16_f32 v184, v64, v65
  v_mfma_f32_32x32x16_bf16 v[188:203], a[108:111], v[40:43], v[188:203]
  ds_read_b128 v[40:43], v16 offset:20480
  v_mul_f32 v58, v169, v58
  v_mul_f32 v59, v169, v59
  v_exp_f32 v58, v58
  v_exp_f32 v59, v59
  s_waitcnt lgkmcnt(3)
  v_mfma_f32_32x32x16_bf16 v[188:203], a[112:115], v[144:147], v[188:203]
  ds_read_b128 v[144:147], v17 offset:20480
  v_fma_f32 v58, v58, v170, v170
  v_fma_f32 v59, v59, v170, v170
  v_rcp_f32 v58, v58
  v_mfma_f32_32x32x16_bf16 v[188:203], a[116:119], v[164:167], v[188:203]
  ds_read_b128 v[164:167], v15 offset:24576
  buffer_load_dwordx4 v10, s[4:7], s52 offen offset:2048 lds
  v_rcp_f32 v59, v59
  v_mul_f32 v66, v58, v66
  v_mfma_f32_32x32x16_bf16 v[188:203], a[120:123], v[180:183], v[188:203]
  ds_read_b128 v[180:183], v14 offset:24576
  v_mul_f32 v67, v59, v67
  v_cvt_pk_bf16_f32 v185, v66, v67
  v_mul_f32 v60, v169, v60
  v_mul_f32 v61, v169, v61
  v_exp_f32 v60, v60
  v_mfma_f32_32x32x16_bf16 v[188:203], a[124:127], v[48:51], v[188:203]
  ds_read_b128 v[48:51], v16 offset:24576
  v_exp_f32 v61, v61
  v_fma_f32 v60, v60, v170, v170
  v_fma_f32 v61, v61, v170, v170
  s_waitcnt lgkmcnt(3)
  v_mfma_f32_32x32x16_bf16 v[188:203], a[128:131], v[152:155], v[188:203]
  ds_read_b128 v[152:155], v17 offset:24576
  buffer_load_dwordx4 v11, s[4:7], s52 offen offset:3072 lds
  v_rcp_f32 v60, v60
  v_rcp_f32 v61, v61
  v_mfma_f32_32x32x16_bf16 v[188:203], a[132:135], v[24:27], v[188:203]
  ds_read_b128 v[24:27], v15 offset:28672
  v_mul_f32 v68, v60, v68
  v_mul_f32 v69, v61, v69
  v_cvt_pk_bf16_f32 v186, v68, v69
  v_mul_f32 v62, v169, v62
  v_mfma_f32_32x32x16_bf16 v[188:203], a[136:139], v[40:43], v[188:203]
  ds_read_b128 v[40:43], v14 offset:28672
  v_mul_f32 v63, v169, v63
  v_exp_f32 v62, v62
  v_exp_f32 v63, v63
  v_mfma_f32_32x32x16_bf16 v[188:203], a[140:143], v[144:147], v[188:203]
  ds_read_b128 v[144:147], v16 offset:28672
  v_fma_f32 v62, v62, v170, v170
  v_fma_f32 v63, v63, v170, v170
  v_rcp_f32 v62, v62
  v_rcp_f32 v63, v63
  s_waitcnt lgkmcnt(3)
  v_mfma_f32_32x32x16_bf16 v[188:203], a[144:147], v[164:167], v[188:203]
  ds_read_b128 v[164:167], v17 offset:28672
  v_mul_f32 v70, v62, v70
  v_mul_f32 v71, v63, v71
  v_cvt_pk_bf16_f32 v187, v70, v71
  v_mfma_f32_32x32x16_bf16 v[188:203], a[148:151], v[180:183], v[188:203]
  v_mul_f32 v80, v149, v80
  v_mul_f32 v81, v149, v81
  v_exp_f32 v80, v80
  v_exp_f32 v81, v81
  v_mfma_f32_32x32x16_bf16 v[188:203], a[152:155], v[48:51], v[188:203]
  v_fma_f32 v80, v80, v150, v150
  v_fma_f32 v81, v81, v150, v150
  v_rcp_f32 v80, v80
  v_rcp_f32 v81, v81
  v_mfma_f32_32x32x16_bf16 v[188:203], a[156:159], v[152:155], v[188:203]
  v_mul_f32 v88, v80, v88
  v_mul_f32 v89, v81, v89
  v_cvt_pk_bf16_f32 v48, v88, v89
  v_mul_f32 v82, v149, v82
  v_mul_f32 v83, v149, v83
  v_exp_f32 v82, v82
  s_waitcnt lgkmcnt(0)
  v_mfma_f32_32x32x16_bf16 v[188:203], a[160:163], v[24:27], v[188:203]
  s_waitcnt vmcnt(10)
  s_barrier
  ds_read_b128 v[24:27], v15 offset:32768
  ds_read_b128 v[56:59], v14 offset:32768
  v_mfma_f32_32x32x16_bf16 v[188:203], a[164:167], v[40:43], v[188:203]
  ds_read_b128 v[40:43], v16 offset:32768
  ds_read_b128 v[60:63], v17 offset:32768
  v_cmp_ne_u32 vcc, s48, v159
  s_nop 0
  s_cbranch_vccnz L_poll5
L_back5:
  v_mov_b32 v204, v156
  s_add_u32 s52, s37, s42
  v_mfma_f32_32x32x16_bf16 v[188:203], a[168:171], v[144:147], v[188:203]
  ds_read_b128 v[64:67], v15 offset:36864
  ds_read_b128 v[68:71], v14 offset:36864
  s_add_u32 m0, s65, 0x18000
  s_nop 0
  buffer_load_dwordx4 v2, s[4:7], s52 offen offset:0 lds
  buffer_load_dwordx4 v9, s[4:7], s52 offen offset:1024 lds
  v_exp_f32 v83, v83
  v_mfma_f32_32x32x16_bf16 v[188:203], a[172:175], v[164:167], v[188:203]
  ds_read_b128 v[144:147], v16 offset:36864
  v_fma_f32 v82, v82, v150, v150
  v_fma_f32 v83, v83, v150, v150
  v_rcp_f32 v82, v82
  v_mfma_f32_32x32x16_bf16 v[188:203], v[28:31], v[204:207], v[188:203]
  buffer_load_dwordx4 v10, s[4:7], s52 offen offset:2048 lds
  v_rcp_f32 v83, v83
  v_mul_f32 v90, v82, v90
  v_mul_f32 v91, v83, v91
  v_cvt_pk_bf16_f32 v49, v90, v91
  s_waitcnt lgkmcnt(3)
  v_mfma_f32_32x32x16_bf16 v[212:227], a[48:51], v[24:27], 0
  ds_read_b128 v[24:27], v17 offset:36864
  buffer_load_dwordx4 v11, s[4:7], s52 offen offset:3072 lds
  s_add_u32 s37, s38, s42
  v_mul_f32 v84, v149, v84
  v_mul_f32 v85, v149, v85
  v_mfma_f32_32x32x16_bf16 v[212:227], a[52:55], v[56:59], v[212:227]
  ds_read_b128 v[56:59], v15 offset:40960
  v_exp_f32 v84, v84
  v_exp_f32 v85, v85
  v_fma_f32 v84, v84, v150, v150
  v_mfma_f32_32x32x16_bf16 v[212:227], a[56:59], v[40:43], v[212:227]
  ds_read_b128 v[40:43], v14 offset:40960
  s_add_u32 m0, s65, 0x19000
  s_nop 0
  buffer_load_dwordx4 v2, s[4:7], s37 offen offset:0 lds
  v_fma_f32 v85, v85, v150, v150
  v_rcp_f32 v84, v84
  v_mfma_f32_32x32x16_bf16 v[212:227], a[60:63], v[60:63], v[212:227]
  ds_read_b128 v[60:63], v16 offset:40960
  v_rcp_f32 v85, v85
  v_mul_f32 v92, v84, v92
  v_mul_f32 v93, v85, v93
  v_cvt_pk_bf16_f32 v50, v92, v93
  v_mul_f32 v86, v149, v86
  v_mul_f32 v87, v149, v87
  v_exp_f32 v86, v86
  v_exp_f32 v87, v87
  v_fma_f32 v86, v86, v150, v150
  v_fma_f32 v87, v87, v150, v150
  v_rcp_f32 v86, v86
  v_rcp_f32 v87, v87
  v_mul_f32 v94, v86, v94
  v_mul_f32 v95, v87, v95
  v_cvt_pk_bf16_f32 v51, v94, v95
  s_waitcnt lgkmcnt(3)
  v_mfma_f32_32x32x16_bf16 v[212:227], a[64:67], v[64:67], v[212:227]
  ds_read_b128 v[64:67], v17 offset:40960
  buffer_load_dwordx4 v9, s[4:7], s37 offen offset:1024 lds
  v_mul_f32 v96, v173, v96
  v_mfma_f32_32x32x16_bf16 v[212:227], a[68:71], v[68:71], v[212:227]
  ds_read_b128 v[68:71], v15 offset:45056
  buffer_load_dwordx4 v10, s[4:7], s37 offen offset:2048 lds
  v_mul_f32 v97, v173, v97
  v_exp_f32 v96, v96
  v_exp_f32 v97, v97
  v_mfma_f32_32x32x16_bf16 v[212:227], a[72:75], v[144:147], v[212:227]
  ds_read_b128 v[80:83], v14 offset:45056
  v_fma_f32 v96, v96, v174, v174
  v_fma_f32 v97, v97, v174, v174
  v_rcp_f32 v96, v96
  v_mfma_f32_32x32x16_bf16 v[212:227], a[76:79], v[24:27], v[212:227]
  ds_read_b128 v[24:27], v16 offset:45056
  s_waitcnt vmcnt(11)
  buffer_store_dword v34, v38, s[32:35], s75 offen sc1
  buffer_load_dwordx4 v11, s[4:7], s37 offen offset:3072 lds
  s_lshl_b32 s37, s46, 4
  s_add_u32 s37, s37, s36
  s_waitcnt lgkmcnt(3)
  v_mfma_f32_32x32x16_bf16 v[212:227], a[80:83], v[56:59], v[212:227]
  ds_read_b128 v[8:11], v17 offset:45056
  v_rcp_f32 v97, v97
  v_mul_f32 v104, v96, v104
  v_mul_f32 v105, v97, v105
  v_mfma_f32_32x32x16_bf16 v[212:227], a[84:87], v[40:43], v[212:227]
  ds_read_b128 v[40:43], v15 offset:49152
  s_add_u32 m0, s65, 0x20000
  s_nop 0
  buffer_load_dwordx4 v4, s[24:27], s37 offen offset:0 lds
  v_cvt_pk_bf16_f32 v56, v104, v105
  v_mul_f32 v98, v173, v98
  v_mul_f32 v99, v173, v99
  v_mfma_f32_32x32x16_bf16 v[212:227], a[88:91], v[60:63], v[212:227]
  ds_read_b128 v[60:63], v14 offset:49152
  buffer_load_dwordx4 v36, s[24:27], s37 offen offset:1024 lds
  v_exp_f32 v98, v98
  v_exp_f32 v99, v99
  v_mfma_f32_32x32x16_bf16 v[212:227], a[92:95], v[64:67], v[212:227]
  ds_read_b128 v[64:67], v16 offset:49152
  v_fma_f32 v98, v98, v174, v174
  v_fma_f32 v99, v99, v174, v174
  v_rcp_f32 v98, v98
  v_rcp_f32 v99, v99
  s_waitcnt lgkmcnt(3)
  v_mfma_f32_32x32x16_bf16 v[212:227], a[96:99], v[68:71], v[212:227]
  ds_read_b128 v[68:71], v17 offset:49152
  buffer_load_dwordx4 v39, s[24:27], s37 offen offset:2048 lds
  v_mul_f32 v106, v98, v106
  v_mul_f32 v107, v99, v107
  v_mfma_f32_32x32x16_bf16 v[212:227], a[100:103], v[80:83], v[212:227]
  ds_read_b128 v[80:83], v15 offset:53248
  v_cvt_pk_bf16_f32 v57, v106, v107
  v_mul_f32 v100, v173, v100
  v_mul_f32 v101, v173, v101
  v_exp_f32 v100, v100
  v_mfma_f32_32x32x16_bf16 v[212:227], a[104:107], v[24:27], v[212:227]
  ds_read_b128 v[24:27], v14 offset:53248
  v_exp_f32 v101, v101
  v_fma_f32 v100, v100, v174, v174
  v_fma_f32 v101, v101, v174, v174
  v_rcp_f32 v100, v100
  v_rcp_f32 v101, v101
  v_mul_f32 v108, v100, v108
  v_mul_f32 v109, v101, v109
  v_cvt_pk_bf16_f32 v58, v108, v109
  v_mul_f32 v102, v173, v102
  v_mul_f32 v103, v173, v103
  v_exp_f32 v102, v102
  v_exp_f32 v103, v103
  v_fma_f32 v102, v102, v174, v174
  v_fma_f32 v103, v103, v174, v174
  v_rcp_f32 v102, v102
  v_rcp_f32 v103, v103
  v_mul_f32 v110, v102, v110
  v_mul_f32 v111, v103, v111
  v_cvt_pk_bf16_f32 v59, v110, v111
  v_mfma_f32_32x32x16_bf16 v[212:227], a[108:111], v[8:11], v[212:227]
  ds_read_b128 v[8:11], v16 offset:53248
  buffer_load_dwordx4 v52, s[24:27], s37 offen offset:3072 lds
  s_lshl_b32 s37, s47, 4
  s_add_u32 s37, s37, s36
  s_waitcnt lgkmcnt(3)
  v_mfma_f32_32x32x16_bf16 v[212:227], a[112:115], v[40:43], v[212:227]
  ds_read_b128 v[40:43], v17 offset:53248
  s_add_u32 m0, s65, 0x21000
  s_nop 0
  buffer_load_dwordx4 v4, s[24:27], s37 offen offset:0 lds
  v_mul_f32 v112, v177, v112
  v_mul_f32 v113, v177, v113
  v_mfma_f32_32x32x16_bf16 v[212:227], a[116:119], v[60:63], v[212:227]
  ds_read_b128 v[60:63], v15 offset:57344
  buffer_load_dwordx4 v36, s[24:27], s37 offen offset:1024 lds
  v_exp_f32 v112, v112
  v_exp_f32 v113, v113
  v_mfma_f32_32x32x16_bf16 v[212:227], a[120:123], v[64:67], v[212:227]
  ds_read_b128 v[64:67], v14 offset:57344
  v_fma_f32 v112, v112, v178, v178
  v_fma_f32 v113, v113, v178, v178
  v_rcp_f32 v112, v112
  v_rcp_f32 v113, v113
  v_mfma_f32_32x32x16_bf16 v[212:227], a[124:127], v[68:71], v[212:227]
  ds_read_b128 v[68:71], v16 offset:57344
  buffer_load_dwordx4 v39, s[24:27], s37 offen offset:2048 lds
  v_mul_f32 v120, v112, v120
  v_mul_f32 v121, v113, v121
  v_cvt_pk_bf16_f32 v84, v120, v121
  s_waitcnt lgkmcnt(3)
  v_mfma_f32_32x32x16_bf16 v[212:227], a[128:131], v[80:83], v[212:227]
  ds_read_b128 v[80:83], v17 offset:57344
  buffer_load_dwordx4 v52, s[24:27], s37 offen offset:3072 lds
  s_lshl_b32 s37, s50, 4
  s_add_u32 s37, s37, s36
  v_mul_f32 v114, v177, v114
  v_mfma_f32_32x32x16_bf16 v[212:227], a[132:135], v[24:27], v[212:227]
  ds_read_b128 v[24:27], v15 offset:61440
  v_mul_f32 v115, v177, v115
  v_exp_f32 v114, v114
  v_exp_f32 v115, v115
  v_mfma_f32_32x32x16_bf16 v[212:227], a[136:139], v[8:11], v[212:227]
  ds_read_b128 v[8:11], v14 offset:61440
  s_add_u32 m0, s65, 0
  s_nop 0
  buffer_load_dwordx4 v4, s[24:27], s37 offen offset:0 lds
  v_fma_f32 v114, v114, v178, v178
  v_fma_f32 v115, v115, v178, v178
  v_rcp_f32 v114, v114
  v_mfma_f32_32x32x16_bf16 v[212:227], a[140:143], v[40:43], v[212:227]
  ds_read_b128 v[12:15], v16 offset:61440
  v_rcp_f32 v115, v115
  v_mul_f32 v122, v114, v122
  v_mul_f32 v123, v115, v123
  s_waitcnt lgkmcnt(3)
  v_mfma_f32_32x32x16_bf16 v[212:227], a[144:147], v[60:63], v[212:227]
  ds_read_b128 v[40:43], v17 offset:61440
  v_cvt_pk_bf16_f32 v85, v122, v123
  v_mul_f32 v116, v177, v116
  v_mul_f32 v117, v177, v117
  v_exp_f32 v116, v116
  v_exp_f32 v117, v117
  v_fma_f32 v116, v116, v178, v178
  v_fma_f32 v117, v117, v178, v178
  v_rcp_f32 v116, v116
  v_rcp_f32 v117, v117
  v_mul_f32 v124, v116, v124
  v_mul_f32 v125, v117, v125
  v_cvt_pk_bf16_f32 v86, v124, v125
  v_mul_f32 v118, v177, v118
  v_mul_f32 v119, v177, v119
  v_exp_f32 v118, v118
  v_exp_f32 v119, v119
  v_fma_f32 v118, v118, v178, v178
  v_fma_f32 v119, v119, v178, v178
  v_rcp_f32 v118, v118
  v_rcp_f32 v119, v119
  v_mul_f32 v126, v118, v126
  v_mul_f32 v127, v119, v127
  v_cvt_pk_bf16_f32 v87, v126, v127
  v_mfma_f32_32x32x16_bf16 v[212:227], a[148:151], v[64:67], v[212:227]
  buffer_load_dwordx4 v36, s[24:27], s37 offen offset:1024 lds
  buffer_load_dwordx4 v39, s[24:27], s37 offen offset:2048 lds
  s_lshr_b32 s38, s40, 6
  s_add_u32 s38, s38, s54
  v_mfma_f32_32x32x16_bf16 v[212:227], a[152:155], v[68:71], v[212:227]
  s_add_u32 s38, s38, 0x200
  buffer_load_dwordx4 v[60:63], v22, s[32:35], s38 offen sc1
  s_lshr_b32 s52, s41, 6
  s_add_u32 s52, s52, s54
  s_add_u32 s52, s52, 0x200
  buffer_load_dwordx4 v[64:67], v22, s[32:35], s52 offen sc1
  v_mfma_f32_32x32x16_bf16 v[212:227], a[156:159], v[80:83], v[212:227]
  s_lshr_b32 s57, s42, 6
  s_add_u32 s57, s57, s54
  s_add_u32 s57, s57, 0x200
  buffer_load_dwordx4 v[68:71], v22, s[32:35], s57 offen sc1
  s_add_u32 s54, s58, 0
  buffer_store_dwordx4 v[184:187], v1, s[32:35], s54 offen sc1
  s_add_u32 s54, s58, 0x38000
  buffer_store_dwordx4 v[48:51], v1, s[32:35], s54 offen sc1
  s_add_u32 s54, s58, 0x70000
  buffer_store_dwordx4 v[56:59], v1, s[32:35], s54 offen sc1
  s_add_u32 s54, s58, 0xa8000
  buffer_store_dwordx4 v[84:87], v1, s[32:35], s54 offen sc1
  s_waitcnt lgkmcnt(0)
  v_mfma_f32_32x32x16_bf16 v[212:227], a[160:163], v[24:27], v[212:227]
  s_waitcnt vmcnt(27)
  s_barrier
  ds_read_b128 v[24:27], v18 offset:0
  ds_read_b128 v[48:51], v19 offset:0
  buffer_load_dwordx4 v52, s[24:27], s37 offen offset:3072 lds
  v_mfma_f32_32x32x16_bf16 v[212:227], a[164:167], v[8:11], v[212:227]
  ds_read_b128 v[8:11], v20 offset:0
  ds_read_b128 v[56:59], v21 offset:0
  s_waitcnt vmcnt(7)
  v_cmp_ne_u32 vcc, s48, v63
  s_nop 0
  s_cbranch_vccnz L_poll6
L_back6:
  v_mfma_f32_32x32x16_bf16 v[212:227], a[168:171], v[12:15], v[212:227]
  ds_read_b128 v[12:15], v18 offset:4096
  ds_read_b128 v[80:83], v19 offset:4096
  v_mov_b32 v208, v60
  s_lshl_b32 s37, s51, 4
  s_add_u32 s37, s37, s36
  s_add_u32 m0, s65, 0x1000
  s_nop 0
  buffer_load_dwordx4 v4, s[24:27], s37 offen offset:0 lds
  v_mfma_f32_32x32x16_bf16 v[212:227], a[172:175], v[40:43], v[212:227]
  ds_read_b128 v[40:43], v20 offset:4096
  buffer_load_dwordx4 v36, s[24:27], s37 offen offset:1024 lds
  v_mul_f32 v188, v157, v188
  v_mul_f32 v189, v157, v189
  v_exp_f32 v188, v188
  v_mfma_f32_32x32x16_bf16 v[212:227], v[28:31], v[208:211], v[212:227]
  v_exp_f32 v189, v189
  v_fma_f32 v188, v188, v158, v158
  v_fma_f32 v189, v189, v158, v158
  v_rcp_f32 v188, v188
  s_waitcnt lgkmcnt(3)
  v_mfma_f32_32x32x16_bf16 v[84:99], a[48:51], v[24:27], 0
  ds_read_b128 v[24:27], v21 offset:4096
  v_rcp_f32 v189, v189
  v_mul_f32 v196, v188, v196
  v_mfma_f32_32x32x16_bf16 v[84:99], a[52:55], v[48:51], v[84:99]
  ds_read_b128 v[48:51], v18 offset:8192
  buffer_load_dwordx4 v39, s[24:27], s37 offen offset:2048 lds
  v_mul_f32 v197, v189, v197
  v_cvt_pk_bf16_f32 v100, v196, v197
  v_mul_f32 v190, v157, v190
  v_mul_f32 v191, v157, v191
  v_mfma_f32_32x32x16_bf16 v[84:99], a[56:59], v[8:11], v[84:99]
  ds_read_b128 v[8:11], v19 offset:8192
  v_exp_f32 v190, v190
  v_exp_f32 v191, v191
  v_fma_f32 v190, v190, v158, v158
  v_mfma_f32_32x32x16_bf16 v[84:99], a[60:63], v[56:59], v[84:99]
  ds_read_b128 v[56:59], v20 offset:8192
  v_fma_f32 v191, v191, v158, v158
  v_rcp_f32 v190, v190
  v_rcp_f32 v191, v191
  s_waitcnt lgkmcnt(3)
  v_mfma_f32_32x32x16_bf16 v[84:99], a[64:67], v[12:15], v[84:99]
  ds_read_b128 v[12:15], v21 offset:8192
  buffer_load_dwordx4 v52, s[24:27], s37 offen offset:3072 lds
  s_lshl_b32 s37, s53, 4
  s_add_u32 s37, s37, s36
  v_mul_f32 v198, v190, v198
  v_mfma_f32_32x32x16_bf16 v[84:99], a[68:71], v[80:83], v[84:99]
  ds_read_b128 v[80:83], v18 offset:12288
  v_mul_f32 v199, v191, v199
  v_cvt_pk_bf16_f32 v101, v198, v199
  v_mul_f32 v192, v157, v192
  v_mul_f32 v193, v157, v193
  v_exp_f32 v192, v192
  v_mfma_f32_32x32x16_bf16 v[84:99], a[72:75], v[40:43], v[84:99]
  ds_read_b128 v[40:43], v19 offset:12288
  v_exp_f32 v193, v193
  v_fma_f32 v192, v192, v158, v158
  v_fma_f32 v193, v193, v158, v158
  v_mfma_f32_32x32x16_bf16 v[84:99], a[76:79], v[24:27], v[84:99]
  ds_read_b128 v[24:27], v20 offset:12288
  s_add_u32 m0, s65, 0x8000
  s_nop 0
  buffer_load_dwordx4 v4, s[24:27], s37 offen offset:0 lds
  v_rcp_f32 v192, v192
  v_rcp_f32 v193, v193
  s_waitcnt lgkmcnt(3)
  v_mfma_f32_32x32x16_bf16 v[84:99], a[80:83], v[48:51], v[84:99]
  ds_read_b128 v[48:51], v21 offset:12288
  v_mul_f32 v200, v192, v200
  v_mul_f32 v201, v193, v201
  v_cvt_pk_bf16_f32 v102, v200, v201
  v_mfma_f32_32x32x16_bf16 v[84:99], a[84:87], v[8:11], v[84:99]
  ds_read_b128 v[8:11], v18 offset:16384
  buffer_load_dwordx4 v36, s[24:27], s37 offen offset:1024 lds
  v_mul_f32 v194, v157, v194
  v_mul_f32 v195, v157, v195
  v_exp_f32 v194, v194
  v_mfma_f32_32x32x16_bf16 v[84:99], a[88:91], v[56:59], v[84:99]
  ds_read_b128 v[56:59], v19 offset:16384
  v_exp_f32 v195, v195
  v_fma_f32 v194, v194, v158, v158
  v_fma_f32 v195, v195, v158, v158
  v_rcp_f32 v194, v194
  v_mfma_f32_32x32x16_bf16 v[84:99], a[92:95], v[12:15], v[84:99]
  ds_read_b128 v[12:15], v20 offset:16384
  v_rcp_f32 v195, v195
  v_mul_f32 v202, v194, v202
  v_mul_f32 v203, v195, v203
  s_waitcnt lgkmcnt(3)
  v_mfma_f32_32x32x16_bf16 v[84:99], a[96:99], v[80:83], v[84:99]
  ds_read_b128 v[80:83], v21 offset:16384
  buffer_load_dwordx4 v39, s[24:27], s37 offen offset:2048 lds
  v_cvt_pk_bf16_f32 v103, v202, v203
  v_mul_f32 v212, v61, v212
  v_mul_f32 v213, v61, v213
  v_mfma_f32_32x32x16_bf16 v[84:99], a[100:103], v[40:43], v[84:99]
  ds_read_b128 v[40:43], v18 offset:20480
  v_exp_f32 v212, v212
  v_exp_f32 v213, v213
  v_fma_f32 v212, v212, v62, v62
  v_mfma_f32_32x32x16_bf16 v[84:99], a[104:107], v[24:27], v[84:99]
  ds_read_b128 v[24:27], v19 offset:20480
  v_fma_f32 v213, v213, v62, v62
  v_rcp_f32 v212, v212
  v_rcp_f32 v213, v213
  v_mfma_f32_32x32x16_bf16 v[84:99], a[108:111], v[48:51], v[84:99]
  ds_read_b128 v[48:51], v20 offset:20480
  buffer_load_dwordx4 v52, s[24:27], s37 offen offset:3072 lds
  s_lshl_b32 s37, s66, 4
  s_add_u32 s37, s37, s36
  v_mul_f32 v220, v212, v220
  v_mul_f32 v221, v213, v221
  s_waitcnt lgkmcnt(3)
  v_mfma_f32_32x32x16_bf16 v[84:99], a[112:115], v[8:11], v[84:99]
  ds_read_b128 v[8:11], v21 offset:20480
  v_cvt_pk_bf16_f32 v104, v220, v221
  v_mul_f32 v214, v61, v214
  v_mul_f32 v215, v61, v215
  v_exp_f32 v214, v214
  v_mfma_f32_32x32x16_bf16 v[84:99], a[116:119], v[56:59], v[84:99]
  ds_read_b128 v[56:59], v18 offset:24576
  v_exp_f32 v215, v215
  v_fma_f32 v214, v214, v62, v62
  v_fma_f32 v215, v215, v62, v62
  v_mfma_f32_32x32x16_bf16 v[84:99], a[120:123], v[12:15], v[84:99]
  ds_read_b128 v[12:15], v19 offset:24576
  s_add_u32 m0, s65, 0x9000
  s_nop 0
  buffer_load_dwordx4 v4, s[24:27], s37 offen offset:0 lds
  v_rcp_f32 v214, v214
  v_rcp_f32 v215, v215
  v_mfma_f32_32x32x16_bf16 v[84:99], a[124:127], v[80:83], v[84:99]
  ds_read_b128 v[80:83], v20 offset:24576
  v_mul_f32 v222, v214, v222
  v_mul_f32 v223, v215, v223
  v_cvt_pk_bf16_f32 v105, v222, v223
  v_mul_f32 v216, v61, v216
  s_waitcnt lgkmcnt(3)
  v_mfma_f32_32x32x16_bf16 v[84:99], a[128:131], v[40:43], v[84:99]
  ds_read_b128 v[40:43], v21 offset:24576
  buffer_load_dwordx4 v36, s[24:27], s37 offen offset:1024 lds
  v_mul_f32 v217, v61, v217
  v_exp_f32 v216, v216
  v_mfma_f32_32x32x16_bf16 v[84:99], a[132:135], v[24:27], v[84:99]
  ds_read_b128 v[24:27], v18 offset:28672
  v_exp_f32 v217, v217
  v_fma_f32 v216, v216, v62, v62
  v_fma_f32 v217, v217, v62, v62
  v_rcp_f32 v216, v216
  v_mfma_f32_32x32x16_bf16 v[84:99], a[136:139], v[48:51], v[84:99]
  ds_read_b128 v[48:51], v19 offset:28672
  s_waitcnt vmcnt(11)
  buffer_store_dword v34, v38, s[32:35], s63 offen sc1
  v_rcp_f32 v217, v217
  v_mfma_f32_32x32x16_bf16 v[84:99], a[140:143], v[8:11], v[84:99]
  ds_read_b128 v[8:11], v20 offset:28672
  buffer_load_dwordx4 v39, s[24:27], s37 offen offset:2048 lds
  s_lshr_b32 s38, s39, 5
  s_mul_i32 s38, s38, 0x70
  s_add_u32 s38, s38, s58
  s_add_u32 s38, s38, 0x1c000
  s_waitcnt lgkmcnt(3)
  v_mfma_f32_32x32x16_bf16 v[84:99], a[144:147], v[56:59], v[84:99]
  ds_read_b128 v[56:59], v21 offset:28672
  buffer_store_dwordx4 v[100:103], v1, s[32:35], s38 offen sc1
  v_mul_f32 v224, v216, v224
  v_mul_f32 v225, v217, v225
  v_cvt_pk_bf16_f32 v106, v224, v225
  v_mfma_f32_32x32x16_bf16 v[84:99], a[148:151], v[12:15], v[84:99]
  v_mul_f32 v218, v61, v218
  v_mul_f32 v219, v61, v219
  v_exp_f32 v218, v218
  v_exp_f32 v219, v219
  v_mfma_f32_32x32x16_bf16 v[84:99], a[152:155], v[80:83], v[84:99]
  buffer_load_dwordx4 v52, s[24:27], s37 offen offset:3072 lds
  v_fma_f32 v218, v218, v62, v62
  v_fma_f32 v219, v219, v62, v62
  v_rcp_f32 v218, v218
  v_rcp_f32 v219, v219
  v_mfma_f32_32x32x16_bf16 v[84:99], a[156:159], v[40:43], v[84:99]
  v_mul_f32 v226, v218, v226
  v_mul_f32 v227, v219, v227
  v_cvt_pk_bf16_f32 v107, v226, v227
  v_lshrrev_b32 v2, 5, v6
  v_bfe_u32 v3, v6, 2, 2
  s_waitcnt lgkmcnt(0)
  v_mfma_f32_32x32x16_bf16 v[84:99], a[160:163], v[24:27], v[84:99]
  s_barrier
  ds_read_b128 v[12:15], v18 offset:32768
  ds_read_b128 v[24:27], v19 offset:32768
  v_lshl_add_u32 v2, v2, 2, v3
  v_lshlrev_b32 v2, 7, v2
  v_bfe_u32 v3, v6, 4, 1
  v_lshlrev_b32 v3, 5, v3
  v_and_b32 v5, 3, v6
  v_lshl_add_u32 v3, v5, 3, v3
  v_bfe_u32 v5, v6, 3, 1
  v_lshlrev_b32 v5, 6, v5
  v_xor_b32 v3, v3, v5
  s_lshl_b32 s37, s43, 1
  v_xor_b32 v3, s37, v3
  v_add3_u32 v5, v2, v3, s65
  v_xor_b32 v2, 64, v5
  v_add_u32 v3, 0x10000, v5
  v_add_u32 v7, 0x10000, v2
  v_add_u32 v16, 0x20000, v5
  v_add_u32 v17, 0x20000, v2
  v_mfma_f32_32x32x16_bf16 v[84:99], a[164:167], v[48:51], v[84:99]
  ds_read_b128 v[40:43], v20 offset:32768
  ds_read_b128 v[48:51], v21 offset:32768
  v_cmp_ne_u32 vcc, s48, v67
  s_nop 0
  s_cbranch_vccnz L_poll7
L_back7:
  v_mfma_f32_32x32x16_bf16 v[84:99], a[168:171], v[8:11], v[84:99]
  ds_read_b128 v[8:11], v18 offset:36864
  ds_read_b128 v[60:63], v19 offset:36864
  v_mov_b32 v204, v64
  s_lshl_b32 s37, s45, 4
  s_add_u32 s37, s37, s36
  s_add_u32 m0, s65, 0x10000
  s_nop 0
  buffer_load_dwordx4 v4, s[24:27], s37 offen offset:0 lds
  ds_read_b64_tr_b16 a[176:177], v16 offset:0
  ds_read_b64_tr_b16 a[178:179], v16 offset:1024
  ds_read_b64_tr_b16 a[180:181], v17 offset:0
  ds_read_b64_tr_b16 a[182:183], v17 offset:1024
  v_mfma_f32_32x32x16_bf16 v[84:99], a[172:175], v[56:59], v[84:99]
  ds_read_b128 v[56:59], v20 offset:36864
  v_lshlrev_b32 v23, 2, v6
  v_and_b32 v32, 0x7f, v23
  s_lshr_b32 s38, s60, 6
  v_mfma_f32_32x32x16_bf16 v[84:99], v[28:31], v[204:207], v[84:99]
  buffer_load_dwordx4 v36, s[24:27], s37 offen offset:1024 lds
  ds_read_b64_tr_b16 a[184:185], v16 offset:2048
  ds_read_b64_tr_b16 a[186:187], v16 offset:3072
  ds_read_b64_tr_b16 a[188:189], v17 offset:2048
  ds_read_b64_tr_b16 a[190:191], v17 offset:3072
  s_lshl_b32 s38, s38, 7
  s_waitcnt lgkmcnt(11)
  v_mfma_f32_32x32x16_bf16 v[108:123], a[48:51], v[12:15], 0
  ds_read_b128 v[12:15], v21 offset:36864
  s_add_u32 s38, s38, 0x40000
  s_lshr_b32 s39, s60, 4
  s_lshl_b32 s39, s39, 8
  s_add_u32 s39, s39, 0x20000
  v_mfma_f32_32x32x16_bf16 v[108:123], a[52:55], v[24:27], v[108:123]
  ds_read_b128 v[24:27], v18 offset:40960
  buffer_load_dword v33, v23, s[32:35], s39 offen sc1
  buffer_load_dword v35, v32, s[32:35], s38 offen sc1
  v_mfma_f32_32x32x16_bf16 v[108:123], a[56:59], v[40:43], v[108:123]
  ds_read_b128 v[40:43], v19 offset:40960
  buffer_load_dwordx4 v39, s[24:27], s37 offen offset:2048 lds
  v_mul_f32 v84, v65, v84
  v_mul_f32 v85, v65, v85
  v_exp_f32 v84, v84
  v_mfma_f32_32x32x16_bf16 v[108:123], a[60:63], v[48:51], v[108:123]
  ds_read_b128 v[48:51], v20 offset:40960
  v_exp_f32 v85, v85
  v_fma_f32 v84, v84, v66, v66
  v_fma_f32 v85, v85, v66, v66
  v_rcp_f32 v84, v84
  s_waitcnt lgkmcnt(3)
  v_mfma_f32_32x32x16_bf16 v[108:123], a[64:67], v[8:11], v[108:123]
  ds_read_b128 v[8:11], v21 offset:40960
  v_rcp_f32 v85, v85
  v_mul_f32 v92, v84, v92
  v_mfma_f32_32x32x16_bf16 v[108:123], a[68:71], v[60:63], v[108:123]
  ds_read_b128 v[60:63], v18 offset:45056
  buffer_load_dwordx4 v52, s[24:27], s37 offen offset:3072 lds
  v_mul_f32 v93, v85, v93
  v_cvt_pk_bf16_f32 v80, v92, v93
  v_mul_f32 v86, v65, v86
  v_mul_f32 v87, v65, v87
  v_mfma_f32_32x32x16_bf16 v[108:123], a[72:75], v[56:59], v[108:123]
  ds_read_b128 v[56:59], v19 offset:45056
  v_exp_f32 v86, v86
  v_exp_f32 v87, v87
  v_fma_f32 v86, v86, v66, v66
  v_mfma_f32_32x32x16_bf16 v[108:123], a[76:79], v[12:15], v[108:123]
  ds_read_b128 v[12:15], v20 offset:45056
  v_fma_f32 v87, v87, v66, v66
  v_rcp_f32 v86, v86
  v_rcp_f32 v87, v87
  s_waitcnt lgkmcnt(3)
  v_mfma_f32_32x32x16_bf16 v[108:123], a[80:83], v[24:27], v[108:123]
  ds_read_b128 v[24:27], v21 offset:45056
  v_mul_f32 v94, v86, v94
  v_mul_f32 v95, v87, v95
  v_cvt_pk_bf16_f32 v81, v94, v95
  v_mul_f32 v88, v65, v88
  v_mfma_f32_32x32x16_bf16 v[108:123], a[84:87], v[40:43], v[108:123]
  ds_read_b128 v[40:43], v18 offset:49152
  v_mul_f32 v89, v65, v89
  v_exp_f32 v88, v88
  v_exp_f32 v89, v89
  v_mfma_f32_32x32x16_bf16 v[108:123], a[88:91], v[48:51], v[108:123]
  ds_read_b128 v[48:51], v19 offset:49152
  v_fma_f32 v88, v88, v66, v66
  v_fma_f32 v89, v89, v66, v66
  v_rcp_f32 v88, v88
  v_rcp_f32 v89, v89
  v_mfma_f32_32x32x16_bf16 v[108:123], a[92:95], v[8:11], v[108:123]
  ds_read_b128 v[8:11], v20 offset:49152
  s_lshl_b32 s37, s71, 4
  s_add_u32 s37, s37, s36
  s_add_u32 m0, s65, 0x20000
  s_nop 0
  buffer_load_dwordx4 v4, s[24:27], s37 offen offset:0 lds
  s_waitcnt lgkmcnt(3)
  v_mfma_f32_32x32x16_bf16 v[108:123], a[96:99], v[60:63], v[108:123]
  ds_read_b128 v[60:63], v21 offset:49152
  v_mul_f32 v96, v88, v96
  v_mul_f32 v97, v89, v97
  v_cvt_pk_bf16_f32 v82, v96, v97
  v_mfma_f32_32x32x16_bf16 v[108:123], a[100:103], v[56:59], v[108:123]
  ds_read_b128 v[56:59], v18 offset:53248
  buffer_load_dwordx4 v36, s[24:27], s37 offen offset:1024 lds
  v_mul_f32 v90, v65, v90
  v_mul_f32 v91, v65, v91
  v_exp_f32 v90, v90
  v_mfma_f32_32x32x16_bf16 v[108:123], a[104:107], v[12:15], v[108:123]
  ds_read_b128 v[12:15], v19 offset:53248
  s_lshr_b32 s52, s40, 5
  s_mul_i32 s52, s52, 0x70
  s_add_u32 s52, s52, s58
  s_add_u32 s52, s52, 0x1c000
  buffer_store_dwordx4 v[104:107], v1, s[32:35], s52 offen sc1
  v_mfma_f32_32x32x16_bf16 v[108:123], a[108:111], v[24:27], v[108:123]
  ds_read_b128 v[24:27], v20 offset:53248
  buffer_load_dwordx4 v39, s[24:27], s37 offen offset:2048 lds
  v_exp_f32 v91, v91
  v_fma_f32 v90, v90, v66, v66
  v_fma_f32 v91, v91, v66, v66
  s_waitcnt lgkmcnt(3)
  v_mfma_f32_32x32x16_bf16 v[108:123], a[112:115], v[40:43], v[108:123]
  ds_read_b128 v[40:43], v21 offset:53248
  v_rcp_f32 v90, v90
  v_rcp_f32 v91, v91
  v_mfma_f32_32x32x16_bf16 v[108:123], a[116:119], v[48:51], v[108:123]
  ds_read_b128 v[48:51], v18 offset:57344
  buffer_load_dwordx4 v52, s[24:27], s37 offen offset:3072 lds
  v_mul_f32 v98, v90, v98
  v_mul_f32 v99, v91, v99
  v_cvt_pk_bf16_f32 v83, v98, v99
  v_mfma_f32_32x32x16_bf16 v[108:123], a[120:123], v[8:11], v[108:123]
  ds_read_b128 v[8:11], v19 offset:57344
  v_mfma_f32_32x32x16_bf16 v[108:123], a[124:127], v[60:63], v[108:123]
  ds_read_b128 v[60:63], v20 offset:57344
  s_waitcnt lgkmcnt(3)
  v_mfma_f32_32x32x16_bf16 v[108:123], a[128:131], v[56:59], v[108:123]
  ds_read_b128 v[56:59], v21 offset:57344
  v_mfma_f32_32x32x16_bf16 v[108:123], a[132:135], v[12:15], v[108:123]
  ds_read_b128 v[12:15], v18 offset:61440
  v_mfma_f32_32x32x16_bf16 v[108:123], a[136:139], v[24:27], v[108:123]
  ds_read_b128 v[24:27], v19 offset:61440
  s_mul_i32 s37, s60, 0x2080
  s_lshl_b32 s40, s56, 11
  s_add_u32 s40, s40, s37
  s_add_u32 s40, s40, 0x400000
  s_waitcnt vmcnt(8)
  v_cmp_ne_u32 vcc, s48, v33
  s_nop 0
  s_cbranch_vccnz L_poll9
L_back9:
  v_mfma_f32_32x32x16_bf16 v[108:123], a[140:143], v[40:43], v[108:123]
  ds_read_b128 v[40:43], v20 offset:61440
  s_waitcnt vmcnt(7)
  v_cmp_ne_u32 vcc, s48, v35
  s_nop 0
  s_cbranch_vccnz L_poll10
L_back10:
  s_add_u32 m0, s65, 0x11000
  s_nop 0
  buffer_load_dwordx4 v1, s[32:35], s40 offen offset:0 sc1 lds
  buffer_load_dwordx4 v1, s[32:35], s40 offen offset:1024 sc1 lds
  s_waitcnt lgkmcnt(3)
  v_mfma_f32_32x32x16_bf16 v[108:123], a[144:147], v[48:51], v[108:123]
  ds_read_b128 v[48:51], v21 offset:61440
  s_lshl_b32 s38, s56, 10
  s_add_u32 s38, s38, s37
  s_add_u32 s37, s38, 0x100000
  v_mfma_f32_32x32x16_bf16 v[108:123], a[148:151], v[8:11], v[108:123]
  buffer_load_dwordx4 v[8:11], v1, s[32:35], s37 offen sc1
  s_add_u32 s37, s38, 0x101000
  buffer_load_dwordx4 v[64:67], v1, s[32:35], s37 offen sc1
  v_min_u32 v18, 27, v6
  v_lshlrev_b32 v18, 2, v18
  s_and_b32 s37, s55, 28
  v_mfma_f32_32x32x16_bf16 v[108:123], a[152:155], v[60:63], v[108:123]
  s_add_u32 s37, s37, s56
  s_lshl_b32 s37, s37, 7
  s_add_u32 s37, s37, 0x60000
  buffer_load_dword v19, v18, s[32:35], s37 offen sc1
  v_mfma_f32_32x32x16_bf16 v[108:123], a[156:159], v[56:59], v[108:123]
  s_waitcnt lgkmcnt(0)
  v_mfma_f32_32x32x16_bf16 v[108:123], a[160:163], v[12:15], v[108:123]
  v_mfma_f32_32x32x16_bf16 v[108:123], a[164:167], v[24:27], v[108:123]
  v_cmp_ne_u32 vcc, s48, v71
  s_nop 0
  s_cbranch_vccnz L_poll8
L_back8:
  v_mov_b32 v208, v68
  v_mfma_f32_32x32x16_bf16 v[108:123], a[168:171], v[40:43], v[108:123]
  v_mfma_f32_32x32x16_bf16 v[108:123], a[172:175], v[48:51], v[108:123]
  v_mfma_f32_32x32x16_bf16 v[108:123], v[28:31], v[208:211], v[108:123]
  s_waitcnt vmcnt(3)
  s_barrier
  s_lshl_b32 s38, s69, 4
  s_nop 8
  v_pk_mul_f32 v[108:109], v[108:109], v[68:69] op_sel:[0,1] op_sel_hi:[1,1]
  v_pk_mul_f32 v[110:111], v[110:111], v[68:69] op_sel:[0,1] op_sel_hi:[1,1]
  v_pk_mul_f32 v[112:113], v[112:113], v[68:69] op_sel:[0,1] op_sel_hi:[1,1]
  v_pk_mul_f32 v[114:115], v[114:115], v[68:69] op_sel:[0,1] op_sel_hi:[1,1]
  s_add_u32 s38, s38, s36
  v_exp_f32 v108, v108
  v_exp_f32 v109, v109
  v_exp_f32 v110, v110
  v_exp_f32 v111, v111
  v_exp_f32 v112, v112
  v_exp_f32 v113, v113
  v_exp_f32 v114, v114
  v_exp_f32 v115, v115
  s_add_u32 m0, s65, 0x18000
  s_nop 0
  buffer_load_dwordx4 v4, s[24:27], s38 offen offset:0 lds
  buffer_load_dwordx4 v36, s[24:27], s38 offen offset:1024 lds
  v_pk_fma_f32 v[108:109], v[108:109], v[70:71], v[70:71] op_sel_hi:[1,0,0]
  v_pk_fma_f32 v[110:111], v[110:111], v[70:71], v[70:71] op_sel_hi:[1,0,0]
  v_pk_fma_f32 v[112:113], v[112:113], v[70:71], v[70:71] op_sel_hi:[1,0,0]
  v_pk_fma_f32 v[114:115], v[114:115], v[70:71], v[70:71] op_sel_hi:[1,0,0]
  v_rcp_f32 v108, v108
  v_rcp_f32 v109, v109
  v_rcp_f32 v110, v110
  v_rcp_f32 v111, v111
  buffer_load_dwordx4 v39, s[24:27], s38 offen offset:2048 lds
  v_rcp_f32 v112, v112
  v_rcp_f32 v113, v113
  v_rcp_f32 v114, v114
  v_rcp_f32 v115, v115
  s_lshr_b32 s39, s41, 5
  s_mul_i32 s39, s39, 0x70
  s_lshr_b32 s40, s42, 5
  s_add_u32 s39, s39, s58
  s_mul_i32 s40, s40, 0x70
  v_pk_mul_f32 v[116:117], v[116:117], v[108:109]
  v_pk_mul_f32 v[118:119], v[118:119], v[110:111]
  v_pk_mul_f32 v[120:121], v[120:121], v[112:113]
  v_pk_mul_f32 v[122:123], v[122:123], v[114:115]
  buffer_load_dwordx4 v52, s[24:27], s38 offen offset:3072 lds
  s_add_u32 s39, s39, 0x1c000
  s_add_u32 s40, s40, s58
  v_cvt_pk_bf16_f32 v12, v116, v117
  v_cvt_pk_bf16_f32 v13, v118, v119
  v_cvt_pk_bf16_f32 v14, v120, v121
  v_cvt_pk_bf16_f32 v15, v122, v123
  s_add_u32 s40, s40, 0x1c000
  s_waitcnt vmcnt(4)
  v_cmp_ne_u32 vcc, s48, v19
  s_nop 0
  s_cbranch_vccnz L_poll11
L_back11:
  v_add_u32 v19, 0x11000, v1
  ds_read_b128 a[48:51], v19 offset:0
  ds_read_b128 a[52:55], v19 offset:8192
  ds_read_b128 a[56:59], v19 offset:1024
  ds_read_b128 a[60:63], v19 offset:16384
  ds_read_b128 a[64:67], v19 offset:9216
  ds_read_b128 a[68:71], v19 offset:24576
  ds_read_b128 a[72:75], v19 offset:17408
  s_add_u32 s37, s46, s44
  buffer_load_dwordx4 a[76:79], v1, s[32:35], s37 offen offset:0 sc1
  ds_read_b128 a[80:83], v19 offset:25600
  v_lshlrev_b32 v24, 16, v8
  v_lshlrev_b32 v25, 16, v9
  v_lshlrev_b32 v26, 16, v10
  v_lshlrev_b32 v27, 16, v11
  v_and_b32 v8, 0xffff0000, v8
  v_and_b32 v9, 0xffff0000, v9
  v_and_b32 v10, 0xffff0000, v10
  v_and_b32 v11, 0xffff0000, v11
  v_lshlrev_b32 v28, 16, v64
  v_lshlrev_b32 v29, 16, v65
  v_lshlrev_b32 v30, 16, v66
  v_lshlrev_b32 v31, 16, v67
  v_and_b32 v64, 0xffff0000, v64
  v_and_b32 v65, 0xffff0000, v65
  v_and_b32 v66, 0xffff0000, v66
  v_and_b32 v67, 0xffff0000, v67
  buffer_load_dwordx4 a[84:87], v1, s[32:35], s37 offen offset:1024 sc1
  buffer_store_dwordx4 v[80:83], v1, s[32:35], s39 offen sc1
  buffer_store_dwordx4 v[12:15], v1, s[32:35], s40 offen sc1
  s_waitcnt lgkmcnt(7)
  s_nop 0
  v_mfma_f32_16x16x32_bf16 v[12:15], a[48:51], a[0:3], 0
  s_add_u32 s37, s65, 0x19000
  v_add_u32 v19, s37, v1
  v_mfma_f32_16x16x32_bf16 v[40:43], a[48:51], a[4:7], 0
  s_lshl_b32 s37, s67, 4
  s_add_u32 s37, s37, s36
  s_waitcnt lgkmcnt(6)
  v_mfma_f32_16x16x32_bf16 v[12:15], a[52:55], a[8:11], v[12:15]
  v_add_u32 v20, 0x19000, v1
  v_lshrrev_b32 v21, 4, v6
  v_mfma_f32_16x16x32_bf16 v[40:43], a[52:55], a[12:15], v[40:43]
  s_lshl_b32 s38, s56, 10
  s_mul_i32 s39, s60, 0x2100
  s_waitcnt lgkmcnt(5)
  v_mfma_f32_16x16x32_bf16 v[48:51], a[56:59], a[0:3], 0
  s_add_u32 s40, s47, s44
  buffer_load_dwordx4 a[48:51], v1, s[32:35], s40 offen offset:0 sc1
  v_mfma_f32_16x16x32_bf16 v[56:59], a[56:59], a[4:7], 0
  v_and_b32 v22, 15, v6
  v_lshlrev_b32 v21, 4, v21
  s_waitcnt lgkmcnt(4)
  v_mfma_f32_16x16x32_bf16 v[12:15], a[60:63], a[16:19], v[12:15]
  s_add_u32 s39, s39, s38
  v_lshl_add_u32 v32, v22, 6, v21
  v_mfma_f32_16x16x32_bf16 v[40:43], a[60:63], a[20:23], v[40:43]
  s_add_u32 s38, s39, 0x800000
  s_add_u32 s41, s39, 0x801080
  s_waitcnt lgkmcnt(3)
  v_mfma_f32_16x16x32_bf16 v[48:51], a[64:67], a[8:11], v[48:51]
  buffer_load_dwordx4 a[52:55], v1, s[32:35], s40 offen offset:1024 sc1
  v_mfma_f32_16x16x32_bf16 v[56:59], a[64:67], a[12:15], v[56:59]
  s_waitcnt lgkmcnt(2)
  v_mfma_f32_16x16x32_bf16 v[12:15], a[68:71], a[24:27], v[12:15]
  v_mfma_f32_16x16x32_bf16 v[40:43], a[68:71], a[28:31], v[40:43]
  s_waitcnt lgkmcnt(1)
  v_mfma_f32_16x16x32_bf16 v[48:51], a[72:75], a[16:19], v[48:51]
  v_mfma_f32_16x16x32_bf16 v[56:59], a[72:75], a[20:23], v[56:59]
  s_add_u32 s39, s50, s44
  buffer_load_dwordx4 a[56:59], v1, s[32:35], s39 offen offset:0 sc1
  s_waitcnt lgkmcnt(0)
  v_mfma_f32_16x16x32_bf16 v[48:51], a[80:83], a[24:27], v[48:51]
  v_mfma_f32_16x16x32_bf16 v[56:59], a[80:83], a[28:31], v[56:59]
  v_pk_mul_f32 v[60:61], v[12:13], v[76:77]
  v_pk_mul_f32 v[68:69], v[40:41], v[76:77]
  v_pk_mul_f32 v[62:63], v[14:15], v[78:79]
  v_pk_mul_f32 v[70:71], v[42:43], v[78:79]
  v_pk_fma_f32 v[60:61], v[40:41], v[132:133], v[60:61]
  v_pk_fma_f32 v[68:69], v[12:13], v[132:133], v[68:69] neg_lo:[1,0,0] neg_hi:[1,0,0]
  v_pk_fma_f32 v[62:63], v[42:43], v[134:135], v[62:63]
  v_pk_fma_f32 v[70:71], v[14:15], v[134:135], v[70:71] neg_lo:[1,0,0] neg_hi:[1,0,0]
  v_cvt_pk_bf16_f32 v12, v60, v68
  v_cvt_pk_bf16_f32 v40, v68, -v60
  v_cvt_pk_bf16_f32 v13, v61, v69
  v_cvt_pk_bf16_f32 v41, v69, -v61
  v_cvt_pk_bf16_f32 v14, v62, v70
  v_cvt_pk_bf16_f32 v42, v70, -v62
  v_cvt_pk_bf16_f32 v15, v63, v71
  v_cvt_pk_bf16_f32 v43, v71, -v63
  v_pk_mul_f32 v[60:61], v[48:49], v[72:73]
  v_pk_mul_f32 v[68:69], v[56:57], v[72:73]
  v_pk_mul_f32 v[62:63], v[50:51], v[74:75]
  v_pk_mul_f32 v[70:71], v[58:59], v[74:75]
  v_pk_fma_f32 v[60:61], v[56:57], v[128:129], v[60:61]
  v_pk_fma_f32 v[68:69], v[48:49], v[128:129], v[68:69] neg_lo:[1,0,0] neg_hi:[1,0,0]
  v_pk_fma_f32 v[62:63], v[58:59], v[130:131], v[62:63]
  v_pk_fma_f32 v[70:71], v[50:51], v[130:131], v[70:71] neg_lo:[1,0,0] neg_hi:[1,0,0]
  v_mfma_f32_16x16x32_bf16 v[48:51], a[32:35], v[12:15], 0
  v_cvt_pk_bf16_f32 v56, v60, v68
  v_cvt_pk_bf16_f32 v72, v68, -v60
  v_mfma_f32_16x16x32_bf16 v[76:79], a[32:35], v[40:43], 0
  v_cvt_pk_bf16_f32 v57, v61, v69
  v_cvt_pk_bf16_f32 v73, v69, -v61
  v_cvt_pk_bf16_f32 v58, v62, v70
  v_cvt_pk_bf16_f32 v74, v70, -v62
  v_cvt_pk_bf16_f32 v59, v63, v71
  v_cvt_pk_bf16_f32 v75, v71, -v63
  v_mfma_f32_16x16x32_bf16 v[60:63], a[40:43], v[12:15], 0
  buffer_load_dwordx4 a[60:63], v1, s[32:35], s39 offen offset:1024 sc1
  s_add_u32 s39, s51, s44
  buffer_load_dwordx4 a[64:67], v1, s[32:35], s39 offen offset:0 sc1
  v_mfma_f32_16x16x32_bf16 v[12:15], a[40:43], v[40:43], 0
  buffer_load_dwordx4 a[68:71], v1, s[32:35], s39 offen offset:1024 sc1
  v_mfma_f32_16x16x32_bf16 v[48:51], a[36:39], v[56:59], v[48:51]
  v_mfma_f32_16x16x32_bf16 v[76:79], a[36:39], v[72:75], v[76:79]
  v_mfma_f32_16x16x32_bf16 v[60:63], a[44:47], v[56:59], v[60:63]
  v_mfma_f32_16x16x32_bf16 v[12:15], a[44:47], v[72:75], v[12:15]
  s_add_u32 s39, s53, s44
  buffer_load_dwordx4 a[72:75], v1, s[32:35], s39 offen offset:0 sc1
  s_nop 2
  v_pk_mul_f32 v[40:41], v[48:49], v[24:25]
  v_pk_mul_f32 v[56:57], v[76:77], v[24:25]
  v_pk_mul_f32 v[42:43], v[50:51], v[26:27]
  v_pk_mul_f32 v[58:59], v[78:79], v[26:27]
  v_pk_fma_f32 v[40:41], v[76:77], v[8:9], v[40:41] neg_lo:[1,0,0] neg_hi:[1,0,0]
  v_pk_fma_f32 v[56:57], v[48:49], v[8:9], v[56:57]
  v_pk_fma_f32 v[42:43], v[78:79], v[10:11], v[42:43] neg_lo:[1,0,0] neg_hi:[1,0,0]
  v_pk_fma_f32 v[58:59], v[50:51], v[10:11], v[58:59]
  v_cvt_pk_bf16_f32 v8, v40, -v56
  v_cvt_pk_bf16_f32 v24, v56, v40
  v_cvt_pk_bf16_f32 v9, v41, -v57
  v_cvt_pk_bf16_f32 v25, v57, v41
  v_cvt_pk_bf16_f32 v10, v42, -v58
  v_cvt_pk_bf16_f32 v26, v58, v42
  v_cvt_pk_bf16_f32 v11, v43, -v59
  v_cvt_pk_bf16_f32 v27, v59, v43
  v_pk_mul_f32 v[40:41], v[60:61], v[28:29]
  v_pk_mul_f32 v[48:49], v[12:13], v[28:29]
  v_pk_mul_f32 v[42:43], v[62:63], v[30:31]
  v_pk_mul_f32 v[50:51], v[14:15], v[30:31]
  v_pk_fma_f32 v[40:41], v[12:13], v[64:65], v[40:41] neg_lo:[1,0,0] neg_hi:[1,0,0]
  v_pk_fma_f32 v[48:49], v[60:61], v[64:65], v[48:49]
  v_pk_fma_f32 v[42:43], v[14:15], v[66:67], v[42:43] neg_lo:[1,0,0] neg_hi:[1,0,0]
  v_pk_fma_f32 v[50:51], v[62:63], v[66:67], v[50:51]
  v_mfma_f32_16x16x32_bf16 v[12:15], v[8:11], a[32:35], 0
  v_cvt_pk_bf16_f32 v28, v40, -v48
  v_cvt_pk_bf16_f32 v56, v48, v40
  v_mfma_f32_16x16x32_bf16 v[60:63], v[24:27], a[32:35], 0
  v_cvt_pk_bf16_f32 v29, v41, -v49
  v_cvt_pk_bf16_f32 v57, v49, v41
  v_cvt_pk_bf16_f32 v30, v42, -v50
  v_cvt_pk_bf16_f32 v58, v50, v42
  v_cvt_pk_bf16_f32 v31, v43, -v51
  v_cvt_pk_bf16_f32 v59, v51, v43
  v_mfma_f32_16x16x32_bf16 v[40:43], v[8:11], a[40:43], 0
  buffer_load_dwordx4 a[32:35], v1, s[32:35], s39 offen offset:1024 sc1
  s_add_u32 s39, s66, s44
  buffer_load_dwordx4 a[80:83], v1, s[32:35], s39 offen offset:0 sc1
  s_add_u32 s40, s63, 0x20000
  s_waitcnt vmcnt(9)
  buffer_store_dword v34, v38, s[32:35], s40 offen sc1
  v_mfma_f32_16x16x32_bf16 v[8:11], v[24:27], a[40:43], 0
  v_mfma_f32_16x16x32_bf16 v[12:15], v[28:31], a[36:39], v[12:15]
  v_mfma_f32_16x16x32_bf16 v[60:63], v[56:59], a[36:39], v[60:63]
  v_mfma_f32_16x16x32_bf16 v[40:43], v[28:31], a[44:47], v[40:43]
  buffer_load_dwordx4 a[36:39], v1, s[32:35], s39 offen offset:1024 sc1
  v_mfma_f32_16x16x32_bf16 v[8:11], v[56:59], a[44:47], v[8:11]
  s_nop 3
  v_pk_mul_f32 v[24:25], v[12:13], v[136:137]
  v_pk_mul_f32 v[28:29], v[60:61], v[136:137]
  v_pk_mul_f32 v[26:27], v[14:15], v[138:139]
  v_pk_mul_f32 v[30:31], v[62:63], v[138:139]
  v_pk_fma_f32 v[24:25], v[60:61], v[140:141], v[24:25] neg_lo:[1,0,0] neg_hi:[1,0,0]
  v_pk_fma_f32 v[28:29], v[12:13], v[140:141], v[28:29]
  v_pk_fma_f32 v[26:27], v[62:63], v[142:143], v[26:27] neg_lo:[1,0,0] neg_hi:[1,0,0]
  v_pk_fma_f32 v[30:31], v[14:15], v[142:143], v[30:31]
  v_pk_mul_f32 v[12:13], v[40:41], v[44:45]
  v_pk_mul_f32 v[48:49], v[8:9], v[44:45]
  v_pk_mul_f32 v[14:15], v[42:43], v[46:47]
  v_pk_mul_f32 v[50:51], v[10:11], v[46:47]
  v_cvt_pk_bf16_f32 v44, v24, -v28
  v_cvt_pk_bf16_f32 v45, v25, -v29
  v_cvt_pk_bf16_f32 v46, v26, -v30
  v_cvt_pk_bf16_f32 v47, v27, -v31
  v_pk_fma_f32 v[12:13], v[8:9], v[160:161], v[12:13] neg_lo:[1,0,0] neg_hi:[1,0,0]
  v_pk_fma_f32 v[48:49], v[40:41], v[160:161], v[48:49]
  v_pk_fma_f32 v[14:15], v[10:11], v[162:163], v[14:15] neg_lo:[1,0,0] neg_hi:[1,0,0]
  v_pk_fma_f32 v[50:51], v[42:43], v[162:163], v[50:51]
  ds_write_b128 v19, v[44:47] offset:0
  v_cvt_pk_bf16_f32 v8, v12, -v48
  v_cvt_pk_bf16_f32 v9, v13, -v49
  v_cvt_pk_bf16_f32 v10, v14, -v50
  v_cvt_pk_bf16_f32 v11, v15, -v51
  ds_write_b128 v19, v[8:11] offset:1024
  s_add_u32 s39, s45, s44
  buffer_load_dwordx4 a[40:43], v1, s[32:35], s39 offen offset:0 sc1
  buffer_load_dwordx4 a[44:47], v1, s[32:35], s39 offen offset:1024 sc1
  s_waitcnt lgkmcnt(0)
  s_barrier
  s_add_u32 m0, s65, 0x11000
  s_nop 0
  buffer_load_dwordx4 v4, s[24:27], s37 offen offset:0 lds
  buffer_load_dwordx4 v36, s[24:27], s37 offen offset:1024 lds
  buffer_load_dwordx4 v39, s[24:27], s37 offen offset:2048 lds
  buffer_load_dwordx4 v52, s[24:27], s37 offen offset:3072 lds
  ds_read_b128 v[8:11], v20 offset:0
  ds_read_b128 v[12:15], v20 offset:1024
  ds_read_b128 v[24:27], v20 offset:8192
  ds_read_b128 v[28:31], v20 offset:9216
  ds_read_b128 v[40:43], v20 offset:16384
  ds_read_b128 v[44:47], v20 offset:17408
  ds_read_b128 v[48:51], v20 offset:24576
  ds_read_b128 v[56:59], v20 offset:25600
  s_waitcnt lgkmcnt(7)
  v_mfma_f32_16x16x32_bf16 v[60:63], v[8:11], a[0:3], 0
  s_waitcnt lgkmcnt(6)
  v_mfma_f32_16x16x32_bf16 v[64:67], v[12:15], a[0:3], 0
  v_mfma_f32_16x16x32_bf16 v[68:71], v[8:11], a[4:7], 0
  v_mfma_f32_16x16x32_bf16 v[8:11], v[12:15], a[4:7], 0
  s_waitcnt lgkmcnt(5)
  v_mfma_f32_16x16x32_bf16 v[60:63], v[24:27], a[8:11], v[60:63]
  s_waitcnt lgkmcnt(4)
  v_mfma_f32_16x16x32_bf16 v[64:67], v[28:31], a[8:11], v[64:67]
  v_mfma_f32_16x16x32_bf16 v[68:71], v[24:27], a[12:15], v[68:71]
  v_mfma_f32_16x16x32_bf16 v[8:11], v[28:31], a[12:15], v[8:11]
  s_waitcnt lgkmcnt(3)
  v_mfma_f32_16x16x32_bf16 v[60:63], v[40:43], a[16:19], v[60:63]
  s_waitcnt lgkmcnt(2)
  v_mfma_f32_16x16x32_bf16 v[64:67], v[44:47], a[16:19], v[64:67]
  v_mfma_f32_16x16x32_bf16 v[68:71], v[40:43], a[20:23], v[68:71]
  v_mfma_f32_16x16x32_bf16 v[8:11], v[44:47], a[20:23], v[8:11]
  s_waitcnt lgkmcnt(1)
  v_mfma_f32_16x16x32_bf16 v[60:63], v[48:51], a[24:27], v[60:63]
  s_waitcnt lgkmcnt(0)
  v_mfma_f32_16x16x32_bf16 v[64:67], v[56:59], a[24:27], v[64:67]
  v_mfma_f32_16x16x32_bf16 v[68:71], v[48:51], a[28:31], v[68:71]
  s_nop 4
  v_cvt_pk_bf16_f32 v12, v60, v61
  v_cvt_pk_bf16_f32 v13, v62, v63
  v_mfma_f32_16x16x32_bf16 v[8:11], v[56:59], a[28:31], v[8:11]
  v_cvt_pk_bf16_f32 v14, v64, v65
  v_cvt_pk_bf16_f32 v15, v66, v67
  buffer_store_dwordx4 v[12:15], v32, s[32:35], s38 offen sc1
  s_nop 1
  v_cvt_pk_bf16_f32 v12, v68, v69
  v_cvt_pk_bf16_f32 v13, v70, v71
  s_nop 0
  v_cvt_pk_bf16_f32 v14, v8, v9
  v_cvt_pk_bf16_f32 v15, v10, v11
  buffer_store_dwordx4 v[12:15], v32, s[32:35], s41 offen sc1
  v_mfma_f32_32x32x16_bf16 v[56:71], a[176:179], a[76:79], 0
  ds_read_b64_tr_b16 a[0:1], v16 offset:4096
  ds_read_b64_tr_b16 a[2:3], v16 offset:5120
  s_add_u32 s37, s67, s44
  buffer_load_dwordx4 a[4:7], v1, s[32:35], s37 offen offset:0 sc1
  ds_read_b64_tr_b16 a[8:9], v17 offset:4096
  ds_read_b64_tr_b16 a[10:11], v17 offset:5120
  v_mfma_f32_32x32x16_bf16 a[12:27], a[180:183], a[76:79], 0
  buffer_load_dwordx4 a[28:31], v1, s[32:35], s37 offen offset:1024 sc1
  s_lshl_b32 s37, s56, 8
  s_add_u32 s37, s37, s60
  s_lshl_b32 s37, s37, 2
  s_add_u32 s37, s37, 0xa0000
  s_add_u32 s38, s44, 0x1c000
  v_and_b32 v8, 31, v6
  v_mfma_f32_32x32x16_bf16 v[56:71], a[184:187], a[84:87], v[56:71]
  ds_read_b64_tr_b16 a[76:77], v16 offset:6144
  ds_read_b64_tr_b16 a[78:79], v16 offset:7168
  ds_read_b64_tr_b16 a[88:89], v17 offset:6144
  ds_read_b64_tr_b16 a[90:91], v17 offset:7168
  v_xor_b32 v8, s43, v8
  s_lshl_b32 s39, s61, 6
  v_add_u32 v8, s39, v8
  v_mfma_f32_32x32x16_bf16 a[12:27], a[188:191], a[84:87], a[12:27]
  s_add_u32 s39, s69, s44
  buffer_load_dwordx4 a[84:87], v1, s[32:35], s39 offen offset:0 sc1
  v_lshrrev_b32 v9, 5, v6
  v_lshlrev_b32 v9, 1, v9
  s_lshl_b32 s40, s56, 5
  v_add_u32 v9, s40, v9
  v_cvt_f32_u32 v10, v9
  s_waitcnt vmcnt(21) lgkmcnt(6)
  v_mfma_f32_32x32x16_bf16 v[56:71], a[0:3], a[48:51], v[56:71]
  ds_read_b64_tr_b16 a[92:93], v5 offset:0
  ds_read_b64_tr_b16 a[94:95], v5 offset:1024
  ds_read_b64_tr_b16 a[96:97], v2 offset:0
  ds_read_b64_tr_b16 a[98:99], v2 offset:1024
  v_cmp_eq_u32 s[40:41], 0, v9
  v_and_b32 v9, 1, v8
  s_waitcnt lgkmcnt(8)
  v_mfma_f32_32x32x16_bf16 a[12:27], a[8:11], a[48:51], a[12:27]
  buffer_load_dwordx4 a[48:51], v1, s[32:35], s39 offen offset:1024 sc1
  v_mul_u32_u24 v11, 0x202, v9
  v_lshl_or_b32 v11, v11, 16, v11
  v_xor_b32 v11, 0x3020100, v11
  v_add_u32 v12, 1, v8
  v_and_b32 v12, 2, v12
  v_lshlrev_b32 v13, 14, v12
  s_waitcnt vmcnt(21) lgkmcnt(6)
  v_mfma_f32_32x32x16_bf16 v[56:71], a[76:79], a[52:55], v[56:71]
  ds_read_b64_tr_b16 a[100:101], v5 offset:2048
  ds_read_b64_tr_b16 a[102:103], v5 offset:3072
  ds_read_b64_tr_b16 a[104:105], v2 offset:2048
  ds_read_b64_tr_b16 a[106:107], v2 offset:3072
  v_and_b32 v12, 2, v8
  v_lshl_or_b32 v13, v12, 30, v13
  v_lshlrev_b32 v9, 15, v9
  s_waitcnt lgkmcnt(8)
  v_mfma_f32_32x32x16_bf16 a[12:27], a[88:91], a[52:55], a[12:27]
  s_add_u32 s39, s71, s44
  buffer_load_dwordx4 a[52:55], v1, s[32:35], s39 offen offset:0 sc1
  v_or_b32 v9, 0x3f00, v9
  v_cvt_f32_u32 v12, v8
  v_mul_f32 v12, 0x3b000000, v12
  v_mul_f32 v14, v12, v10
  v_cos_f32 v15, v14
  s_waitcnt vmcnt(21) lgkmcnt(6)
  v_mfma_f32_32x32x16_bf16 v[56:71], a[92:95], a[56:59], v[56:71]
  ds_read_b64_tr_b16 a[108:109], v5 offset:4096
  ds_read_b64_tr_b16 a[110:111], v5 offset:5120
  ds_read_b64_tr_b16 a[112:113], v2 offset:4096
  ds_read_b64_tr_b16 a[114:115], v2 offset:5120
  v_sin_f32 v19, v14
  s_waitcnt lgkmcnt(8)
  v_mfma_f32_32x32x16_bf16 a[12:27], a[96:99], a[56:59], a[12:27]
  s_lshl_b32 s42, s72, 4
  s_add_u32 s42, s42, s36
  s_add_u32 m0, s65, 0x21000
  s_nop 0
  buffer_load_dwordx4 v4, s[24:27], s42 offen offset:0 lds
  v_fmamk_f32 v20, v12, 0x3f800000, v14
  s_waitcnt vmcnt(21) lgkmcnt(6)
  v_mfma_f32_32x32x16_bf16 v[56:71], a[100:103], a[60:63], v[56:71]
  ds_read_b64_tr_b16 a[56:57], v5 offset:6144
  ds_read_b64_tr_b16 a[58:59], v5 offset:7168
  ds_read_b64_tr_b16 a[116:117], v2 offset:6144
  ds_read_b64_tr_b16 a[118:119], v2 offset:7168
  v_cos_f32 v21, v20
  v_sin_f32 v22, v20
  s_waitcnt lgkmcnt(8)
  v_mfma_f32_32x32x16_bf16 a[12:27], a[104:107], a[60:63], a[12:27]
  buffer_load_dwordx4 v36, s[24:27], s42 offen offset:1024 lds
  v_cvt_pk_bf16_f32 v24, v15, v19
  v_perm_b32 v28, v24, v24, v11
  v_xor_b32 v28, v28, v13
  v_cndmask_b32 v24, v24, v9, s[40:41]
  v_fmamk_f32 v15, v12, 0x40800000, v14
  s_waitcnt vmcnt(21) lgkmcnt(6)
  v_mfma_f32_32x32x16_bf16 v[56:71], a[108:111], a[64:67], v[56:71]
  ds_read_b64_tr_b16 a[60:61], v5 offset:32768
  ds_read_b64_tr_b16 a[62:63], v5 offset:33792
  ds_read_b64_tr_b16 a[120:121], v2 offset:32768
  ds_read_b64_tr_b16 a[122:123], v2 offset:33792
  v_cos_f32 v19, v15
  s_waitcnt lgkmcnt(8)
  v_mfma_f32_32x32x16_bf16 a[12:27], a[112:115], a[64:67], a[12:27]
  buffer_load_dwordx4 v39, s[24:27], s42 offen offset:2048 lds
  v_sin_f32 v20, v15
  v_cvt_pk_bf16_f32 v25, v21, v22
  v_perm_b32 v29, v25, v25, v11
  v_xor_b32 v29, v29, v13
  v_fmamk_f32 v15, v12, 0x40a00000, v14
  s_waitcnt vmcnt(21) lgkmcnt(6)
  v_mfma_f32_32x32x16_bf16 v[56:71], a[56:59], a[68:71], v[56:71]
  ds_read_b64_tr_b16 a[64:65], v5 offset:34816
  ds_read_b64_tr_b16 a[66:67], v5 offset:35840
  ds_read_b64_tr_b16 a[124:125], v2 offset:34816
  ds_read_b64_tr_b16 a[126:127], v2 offset:35840
  v_cos_f32 v21, v15
  v_sin_f32 v22, v15
  s_waitcnt lgkmcnt(8)
  v_mfma_f32_32x32x16_bf16 a[12:27], a[116:119], a[68:71], a[12:27]
  buffer_load_dwordx4 v52, s[24:27], s42 offen offset:3072 lds
  v_cvt_pk_bf16_f32 v26, v19, v20
  v_perm_b32 v30, v26, v26, v11
  v_xor_b32 v30, v30, v13
  v_fmamk_f32 v15, v12, 0x41000000, v14
  v_cos_f32 v19, v15
  s_waitcnt vmcnt(21) lgkmcnt(6)
  v_mfma_f32_32x32x16_bf16 v[56:71], a[60:63], a[72:75], v[56:71]
  ds_read_b64_tr_b16 a[68:69], v5 offset:36864
  ds_read_b64_tr_b16 a[70:71], v5 offset:37888
  ds_read_b64_tr_b16 a[128:129], v2 offset:36864
  ds_read_b64_tr_b16 a[130:131], v2 offset:37888
  v_sin_f32 v20, v15
  s_waitcnt lgkmcnt(8)
  v_mfma_f32_32x32x16_bf16 a[12:27], a[120:123], a[72:75], a[12:27]
  v_cvt_pk_bf16_f32 v27, v21, v22
  v_perm_b32 v31, v27, v27, v11
  v_xor_b32 v31, v31, v13
  v_fmamk_f32 v15, v12, 0x41100000, v14
  v_cos_f32 v21, v15
  s_waitcnt vmcnt(20) lgkmcnt(6)
  v_mfma_f32_32x32x16_bf16 v[56:71], a[64:67], a[32:35], v[56:71]
  ds_read_b64_tr_b16 a[72:73], v5 offset:38912
  ds_read_b64_tr_b16 a[74:75], v5 offset:39936
  ds_read_b64_tr_b16 a[132:133], v2 offset:38912
  s_and_b32 s42, s55, 28
  s_add_u32 s42, s42, s56
  s_lshl_b32 s42, s42, 7
  s_add_u32 s42, s42, 0x80000
  s_waitcnt lgkmcnt(7)
  v_mfma_f32_32x32x16_bf16 a[12:27], a[124:127], a[32:35], a[12:27]
  buffer_load_dword v22, v18, s[32:35], s42 offen sc1
  ds_read_b64_tr_b16 a[134:135], v2 offset:39936
  buffer_load_dwordx4 a[32:35], v1, s[32:35], s39 offen offset:1024 sc1
  v_sin_f32 v32, v15
  v_cvt_pk_bf16_f32 v40, v19, v20
  v_perm_b32 v44, v40, v40, v11
  s_waitcnt vmcnt(21) lgkmcnt(6)
  v_mfma_f32_32x32x16_bf16 v[56:71], a[68:71], a[80:83], v[56:71]
  ds_read_b64_tr_b16 a[136:137], v3 offset:0
  ds_read_b64_tr_b16 a[138:139], v3 offset:1024
  ds_read_b64_tr_b16 a[140:141], v7 offset:0
  ds_read_b64_tr_b16 a[142:143], v7 offset:1024
  v_xor_b32 v44, v44, v13
  v_fmamk_f32 v15, v12, 0x41400000, v14
  s_waitcnt lgkmcnt(8)
  v_mfma_f32_32x32x16_bf16 a[12:27], a[128:131], a[80:83], a[12:27]
  v_cos_f32 v19, v15
  v_sin_f32 v20, v15
  v_cvt_pk_bf16_f32 v41, v21, v32
  v_perm_b32 v45, v41, v41, v11
  v_xor_b32 v45, v45, v13
  s_waitcnt vmcnt(19) lgkmcnt(6)
  v_mfma_f32_32x32x16_bf16 v[56:71], a[72:75], a[36:39], v[56:71]
  ds_read_b64_tr_b16 a[80:81], v3 offset:2048
  ds_read_b64_tr_b16 a[82:83], v3 offset:3072
  ds_read_b64_tr_b16 a[144:145], v7 offset:2048
  s_waitcnt vmcnt(11)
  buffer_store_dword v34, v38, s[32:35], s37 offen sc1
  ds_read_b64_tr_b16 a[146:147], v7 offset:3072
  v_fmamk_f32 v15, v12, 0x41500000, v14
  s_waitcnt lgkmcnt(8)
  v_mfma_f32_32x32x16_bf16 a[12:27], a[132:135], a[36:39], a[12:27]
  s_add_u32 s37, s72, s44
  buffer_load_dwordx4 a[36:39], v1, s[32:35], s37 offen offset:0 sc1
  v_cos_f32 v21, v15
  v_sin_f32 v32, v15
  v_cvt_pk_bf16_f32 v42, v19, v20
  s_waitcnt lgkmcnt(6)
  v_mfma_f32_32x32x16_bf16 v[56:71], a[136:139], a[40:43], v[56:71]
  ds_read_b64_tr_b16 a[148:149], v3 offset:4096
  ds_read_b64_tr_b16 a[150:151], v3 offset:5120
  s_lshl_b32 s39, s76, 4
  s_add_u32 s39, s39, s36
  s_add_u32 m0, s65, 0
  s_nop 0
  buffer_load_dwordx4 v4, s[24:27], s39 offen offset:0 lds
  s_waitcnt lgkmcnt(6)
  v_mfma_f32_32x32x16_bf16 a[12:27], a[140:143], a[40:43], a[12:27]
  buffer_load_dwordx4 v36, s[24:27], s39 offen offset:1024 lds
  buffer_load_dwordx4 v39, s[24:27], s39 offen offset:2048 lds
  buffer_load_dwordx4 v52, s[24:27], s39 offen offset:3072 lds
  ds_read_b64_tr_b16 a[40:41], v7 offset:4096
  ds_read_b64_tr_b16 a[42:43], v7 offset:5120
  buffer_load_dwordx4 a[152:155], v1, s[32:35], s37 offen offset:1024 sc1
  s_waitcnt lgkmcnt(6)
  v_mfma_f32_32x32x16_bf16 v[56:71], a[80:83], a[44:47], v[56:71]
  ds_read_b64_tr_b16 a[156:157], v3 offset:6144
  ds_read_b64_tr_b16 a[158:159], v3 offset:7168
  ds_read_b64_tr_b16 a[160:161], v7 offset:6144
  ds_read_b64_tr_b16 a[162:163], v7 offset:7168
  v_perm_b32 v46, v42, v42, v11
  v_xor_b32 v46, v46, v13
  v_fmamk_f32 v15, v12, 0x41800000, v14
  s_waitcnt lgkmcnt(8)
  v_mfma_f32_32x32x16_bf16 a[12:27], a[144:147], a[44:47], a[12:27]
  s_add_u32 s37, s76, s44
  buffer_load_dwordx4 a[44:47], v1, s[32:35], s37 offen offset:0 sc1
  v_cos_f32 v19, v15
  v_sin_f32 v20, v15
  v_cvt_pk_bf16_f32 v43, v21, v32
  s_waitcnt vmcnt(18) lgkmcnt(6)
  v_mfma_f32_32x32x16_bf16 v[56:71], a[148:151], a[4:7], v[56:71]
  ds_read_b64_tr_b16 a[164:165], v3 offset:32768
  ds_read_b64_tr_b16 a[166:167], v3 offset:33792
  s_lshl_b32 s39, s78, 4
  s_add_u32 s39, s39, s36
  s_add_u32 m0, s65, 0x1000
  s_nop 0
  buffer_load_dwordx4 v4, s[24:27], s39 offen offset:0 lds
  s_waitcnt lgkmcnt(6)
  v_mfma_f32_32x32x16_bf16 a[12:27], a[40:43], a[4:7], a[12:27]
  buffer_load_dwordx4 v36, s[24:27], s39 offen offset:1024 lds
  buffer_load_dwordx4 v39, s[24:27], s39 offen offset:2048 lds
  buffer_load_dwordx4 v52, s[24:27], s39 offen offset:3072 lds
  ds_read_b64_tr_b16 a[4:5], v7 offset:32768
  ds_read_b64_tr_b16 a[6:7], v7 offset:33792
  buffer_load_dwordx4 a[168:171], v1, s[32:35], s37 offen offset:1024 sc1
  s_waitcnt vmcnt(22) lgkmcnt(6)
  v_mfma_f32_32x32x16_bf16 v[56:71], a[156:159], a[28:31], v[56:71]
  ds_read_b64_tr_b16 a[172:173], v3 offset:34816
  ds_read_b64_tr_b16 a[174:175], v3 offset:35840
  ds_read_b64_tr_b16 a[192:193], v7 offset:34816
  ds_read_b64_tr_b16 a[194:195], v7 offset:35840
  v_perm_b32 v47, v43, v43, v11
  v_xor_b32 v47, v47, v13
  v_fmamk_f32 v3, v12, 0x41880000, v14
  s_waitcnt lgkmcnt(8)
  v_mfma_f32_32x32x16_bf16 a[12:27], a[160:163], a[28:31], a[12:27]
  s_add_u32 s37, s78, s44
  buffer_load_dwordx4 a[28:31], v1, s[32:35], s37 offen offset:0 sc1
  v_cos_f32 v7, v3
  v_sin_f32 v15, v3
  v_cvt_pk_bf16_f32 v48, v19, v20
  s_waitcnt vmcnt(22) lgkmcnt(6)
  v_mfma_f32_32x32x16_bf16 v[56:71], a[164:167], a[84:87], v[56:71]
  ds_read_b64_tr_b16 a[196:197], v16 offset:0
  ds_read_b64_tr_b16 a[198:199], v16 offset:1024
  s_lshl_b32 s39, s79, 4
  s_add_u32 s39, s39, s36
  s_add_u32 m0, s65, 0x8000
  s_nop 0
  buffer_load_dwordx4 v4, s[24:27], s39 offen offset:0 lds
  s_waitcnt lgkmcnt(6)
  v_mfma_f32_32x32x16_bf16 a[12:27], a[4:7], a[84:87], a[12:27]
  buffer_load_dwordx4 v36, s[24:27], s39 offen offset:1024 lds
  buffer_load_dwordx4 v39, s[24:27], s39 offen offset:2048 lds
  buffer_load_dwordx4 v52, s[24:27], s39 offen offset:3072 lds
  ds_read_b64_tr_b16 a[84:85], v17 offset:0
  ds_read_b64_tr_b16 a[86:87], v17 offset:1024
  buffer_load_dwordx4 a[200:203], v1, s[32:35], s37 offen offset:1024 sc1
  s_waitcnt vmcnt(26) lgkmcnt(6)
  v_mfma_f32_32x32x16_bf16 v[56:71], a[172:175], a[48:51], v[56:71]
  ds_read_b64_tr_b16 a[204:205], v16 offset:2048
  ds_read_b64_tr_b16 a[206:207], v16 offset:3072
  ds_read_b64_tr_b16 a[208:209], v17 offset:2048
  ds_read_b64_tr_b16 a[210:211], v17 offset:3072
  v_perm_b32 v52, v48, v48, v11
  v_xor_b32 v52, v52, v13
  v_fmamk_f32 v3, v12, 0x41a00000, v14
  s_waitcnt lgkmcnt(8)
  v_mfma_f32_32x32x16_bf16 a[12:27], a[192:195], a[48:51], a[12:27]
  s_add_u32 s37, s79, s44
  buffer_load_dwordx4 a[48:51], v1, s[32:35], s37 offen offset:0 sc1
  v_cos_f32 v4, v3
  v_sin_f32 v19, v3
  v_cvt_pk_bf16_f32 v49, v7, v15
  s_waitcnt vmcnt(26) lgkmcnt(6)
  v_mfma_f32_32x32x16_bf16 v[56:71], a[196:199], a[52:55], v[56:71]
  s_waitcnt vmcnt(22)
  ds_read_b64_tr_b16 a[212:213], v16 offset:4096
  ds_read_b64_tr_b16 a[214:215], v16 offset:5120
  ds_read_b64_tr_b16 a[216:217], v17 offset:4096
  ds_read_b64_tr_b16 a[218:219], v17 offset:5120
  v_perm_b32 v53, v49, v49, v11
  v_xor_b32 v53, v53, v13
  s_waitcnt lgkmcnt(8)
  v_mfma_f32_32x32x16_bf16 a[12:27], a[84:87], a[52:55], a[12:27]
  buffer_load_dwordx4 a[52:55], v1, s[32:35], s37 offen offset:1024 sc1
  v_fmamk_f32 v3, v12, 0x41a80000, v14
  v_cos_f32 v7, v3
  v_sin_f32 v15, v3
  v_cvt_pk_bf16_f32 v50, v4, v19
  s_waitcnt vmcnt(21) lgkmcnt(6)
  v_mfma_f32_32x32x16_bf16 v[56:71], a[204:207], a[32:35], v[56:71]
  ds_read_b64_tr_b16 a[220:221], v16 offset:6144
  ds_read_b64_tr_b16 a[222:223], v16 offset:7168
  ds_read_b64_tr_b16 a[224:225], v17 offset:6144
  ds_read_b64_tr_b16 a[226:227], v17 offset:7168
  v_perm_b32 v54, v50, v50, v11
  v_xor_b32 v54, v54, v13
  v_fmamk_f32 v3, v12, 0x41c00000, v14
  s_waitcnt lgkmcnt(8)
  v_mfma_f32_32x32x16_bf16 a[12:27], a[208:211], a[32:35], a[12:27]
  v_cos_f32 v4, v3
  v_sin_f32 v16, v3
  v_cvt_pk_bf16_f32 v51, v7, v15
  v_perm_b32 v55, v51, v51, v11
  v_xor_b32 v55, v55, v13
  s_waitcnt vmcnt(19) lgkmcnt(6)
  v_mfma_f32_32x32x16_bf16 v[56:71], a[212:215], a[36:39], v[56:71]
  s_waitcnt vmcnt(15)
  ds_read_b64_tr_b16 a[32:33], v5 offset:0
  ds_read_b64_tr_b16 a[34:35], v5 offset:1024
  v_cmp_ne_u32 vcc, s48, v22
  s_nop 0
  s_cbranch_vccnz L_poll12
L_back12:
  s_add_u32 s37, s46, s38
  buffer_load_dwordx4 a[228:231], v1, s[32:35], s37 offen offset:0 sc1
  s_waitcnt lgkmcnt(6)
  v_mfma_f32_32x32x16_bf16 a[12:27], a[216:219], a[36:39], a[12:27]
  ds_read_b64_tr_b16 a[36:37], v2 offset:0
  ds_read_b64_tr_b16 a[38:39], v2 offset:1024
  buffer_load_dwordx4 a[232:235], v1, s[32:35], s37 offen offset:1024 sc1
  v_add_u32 v3, s65, v1
  v_add_u32 v3, 0x10000, v3
  v_add_u32 v7, 0x10000, v3
  v_xor_b32 v15, 0x2000, v3
  s_waitcnt vmcnt(16) lgkmcnt(6)
  v_mfma_f32_32x32x16_bf16 v[56:71], a[220:223], a[152:155], v[56:71]
  ds_read_b64_tr_b16 a[236:237], v5 offset:2048
  ds_read_b64_tr_b16 a[238:239], v5 offset:3072
  ds_read_b64_tr_b16 a[240:241], v2 offset:2048
  ds_read_b64_tr_b16 a[242:243], v2 offset:3072
  v_xor_b32 v17, 0x4000, v3
  v_xor_b32 v18, 0x6000, v3
  v_xor_b32 v19, 0x2000, v7
  s_waitcnt lgkmcnt(8)
  v_mfma_f32_32x32x16_bf16 a[12:27], a[224:227], a[152:155], a[12:27]
  s_add_u32 s37, s47, s38
  buffer_load_dwordx4 a[152:155], v1, s[32:35], s37 offen offset:0 sc1
  v_xor_b32 v20, 0x4000, v7
  v_xor_b32 v21, 0x6000, v7
  s_mov_b32 s39, 0x49000000
  v_fmamk_f32 v22, v12, 0x41c80000, v14
  v_cos_f32 v32, v22
  s_waitcnt vmcnt(16) lgkmcnt(6)
  v_mfma_f32_32x32x16_bf16 v[56:71], a[32:35], a[44:47], v[56:71]
  s_waitcnt vmcnt(12)
  ds_read_b64_tr_b16 a[244:245], v5 offset:4096
  ds_read_b64_tr_b16 a[246:247], v5 offset:5120
  ds_read_b64_tr_b16 a[248:249], v2 offset:4096
  ds_read_b64_tr_b16 a[250:251], v2 offset:5120
  v_bfe_u32 v33, v6, 4, 1
  s_waitcnt lgkmcnt(8)
  v_mfma_f32_32x32x16_bf16 a[12:27], a[36:39], a[44:47], a[12:27]
  buffer_load_dwordx4 a[44:47], v1, s[32:35], s37 offen offset:1024 sc1
  v_lshlrev_b32 v33, 13, v33
  v_and_b32 v35, 15, v6
  v_lshl_add_u32 v33, v35, 7, v33
  s_lshr_b32 s37, s43, 3
  v_and_b32 v35, 7, v6
  v_xor_b32 v35, s37, v35
  s_waitcnt vmcnt(12) lgkmcnt(6)
  v_mfma_f32_32x32x16_bf16 v[56:71], a[236:239], a[168:171], v[56:71]
  ds_read_b64_tr_b16 a[252:253], v5 offset:6144
  ds_read_b64_tr_b16 a[254:255], v5 offset:7168
  ds_read_b64_tr_b16 v[72:73], v2 offset:6144
  ds_read_b64_tr_b16 v[74:75], v2 offset:7168
  v_lshl_add_u32 v33, v35, 4, v33
  v_lshrrev_b32 v35, 5, v6
  v_lshl_add_u32 v33, v35, 3, v33
  s_waitcnt lgkmcnt(8)
  v_mfma_f32_32x32x16_bf16 a[12:27], a[240:243], a[168:171], a[12:27]
  s_add_u32 s37, s50, s38
  buffer_load_dwordx4 a[168:171], v1, s[32:35], s37 offen offset:0 sc1
  v_add_u32 v35, 0x19800, v33
  v_xor_b32 v33, 16, v35
  v_sin_f32 v36, v22
  v_cvt_pk_bf16_f32 v76, v4, v16
  s_waitcnt vmcnt(12) lgkmcnt(6)
  v_mfma_f32_32x32x16_bf16 v[56:71], a[244:247], a[28:31], v[56:71]
  s_waitcnt vmcnt(8)
  ds_read_b64_tr_b16 v[80:81], v5 offset:32768
  ds_read_b64_tr_b16 v[82:83], v5 offset:33792
  ds_read_b64_tr_b16 v[84:85], v2 offset:32768
  ds_read_b64_tr_b16 v[86:87], v2 offset:33792
  v_lshrrev_b32 v4, 3, v6
  v_mul_u32_u24 v4, 0x1080, v4
  s_waitcnt lgkmcnt(8)
  v_mfma_f32_32x32x16_bf16 a[12:27], a[248:251], a[28:31], a[12:27]
  buffer_load_dwordx4 a[28:31], v1, s[32:35], s37 offen offset:1024 sc1
  v_add_u32 v16, v4, v37
  v_add_u32 v4, 0x8000, v16
  v_add_u32 v22, 0x10000, v16
  v_add_u32 v37, 0x18000, v16
  s_mul_i32 s37, s56, 0x42000
  s_lshl_b32 s42, s55, 7
  s_waitcnt vmcnt(8) lgkmcnt(6)
  v_mfma_f32_32x32x16_bf16 v[56:71], a[252:255], a[200:203], v[56:71]
  ds_read_b64_tr_b16 v[88:89], v5 offset:34816
  ds_read_b64_tr_b16 v[90:91], v5 offset:35840
  ds_read_b64_tr_b16 v[92:93], v2 offset:34816
  v_lshrrev_b32 v5, 3, v6
  v_xor_b32 v39, v5, v6
  v_and_b32 v39, 7, v39
  v_lshlrev_b32 v39, 4, v39
  s_waitcnt lgkmcnt(7)
  v_mfma_f32_32x32x16_bf16 a[12:27], v[72:75], a[200:203], a[12:27]
  v_lshl_add_u32 v96, v5, 10, v39
  v_add_u32 v5, 0x1c00, v96
  s_lshl_b32 s44, s55, 16
  s_add_u32 s44, s44, s36
  s_lshl_b32 s36, s56, 14
  s_add_u32 s36, s36, s44
  s_add_u32 m0, s65, 0x19800
  s_nop 0
  buffer_load_dwordx4 v96, s[4:7], s36 offen offset:0 lds
  buffer_load_dwordx4 v5, s[4:7], s36 offen offset:1024 lds
  ds_read_b64_tr_b16 v[94:95], v2 offset:35840
  s_waitcnt vmcnt(9) lgkmcnt(6)
  v_mfma_f32_32x32x16_bf16 v[56:71], v[80:83], a[48:51], v[56:71]
  s_add_u32 s36, s51, s38
  buffer_load_dwordx4 a[200:203], v1, s[32:35], s36 offen offset:0 sc1
  s_add_u32 s37, s37, s42
  v_lshrrev_b32 v2, 5, v6
  v_bfe_u32 v5, v6, 2, 2
  s_waitcnt lgkmcnt(4)
  v_mfma_f32_32x32x16_bf16 a[12:27], v[84:87], a[48:51], a[12:27]
  buffer_load_dwordx4 a[48:51], v1, s[32:35], s36 offen offset:1024 sc1
  v_lshl_add_u32 v2, v2, 2, v5
  v_lshlrev_b32 v2, 7, v2
  v_bfe_u32 v5, v6, 4, 1
  v_lshlrev_b32 v5, 5, v5
  v_and_b32 v39, 3, v6
  v_lshl_add_u32 v5, v39, 3, v5
  s_waitcnt vmcnt(10) lgkmcnt(2)
  v_mfma_f32_32x32x16_bf16 v[56:71], v[88:91], a[52:55], v[56:71]
  v_bfe_u32 v39, v6, 3, 1
  v_lshlrev_b32 v39, 6, v39
  v_xor_b32 v5, v5, v39
  v_add3_u32 v39, v2, v5, s65
  v_xor_b32 v2, 64, v39
  v_and_b32 v5, 31, v6
  v_lshrrev_b32 v96, 5, v6
  s_waitcnt lgkmcnt(0)
  v_mfma_f32_32x32x16_bf16 a[12:27], v[92:95], a[52:55], a[12:27]
  s_add_u32 s36, s53, s38
  buffer_load_dwordx4 a[52:55], v1, s[32:35], s36 offen offset:0 sc1
  v_lshlrev_b32 v96, 4, v96
  v_lshl_add_u32 v6, v5, 10, v96
  s_lshl_b32 s42, s43, 1
  s_add_u32 s42, s42, s44
  s_add_u32 s43, s42, 0x8000
  s_waitcnt vmcnt(10)
  v_mfma_f32_32x32x16_bf16 v[96:111], a[176:179], a[228:231], 0
  v_perm_b32 v112, v76, v76, v11
  v_xor_b32 v112, v112, v13
  v_fmamk_f32 v5, v12, 0x41e00000, v14
  v_cos_f32 v116, v5
  v_sin_f32 v117, v5
  v_mfma_f32_32x32x16_bf16 v[120:135], a[180:183], a[228:231], 0
  buffer_load_dwordx4 a[176:179], v1, s[32:35], s36 offen offset:1024 sc1
  v_cvt_pk_bf16_f32 v77, v32, v36
  v_perm_b32 v113, v77, v77, v11
  v_xor_b32 v113, v113, v13
  v_fmamk_f32 v5, v12, 0x41e80000, v14
  s_waitcnt vmcnt(10)
  v_mfma_f32_32x32x16_bf16 v[96:111], a[184:187], a[232:235], v[96:111]
  v_cos_f32 v12, v5
  v_sin_f32 v14, v5
  v_cvt_pk_bf16_f32 v78, v116, v117
  v_perm_b32 v114, v78, v78, v11
  v_mfma_f32_32x32x16_bf16 v[120:135], a[188:191], a[232:235], v[120:135]
  s_add_u32 s36, s66, s38
  buffer_load_dwordx4 a[180:183], v1, s[32:35], s36 offen offset:0 sc1
  ds_write_b128 v3, a[12:15] offset:0
  v_xor_b32 v114, v114, v13
  v_xor_b32 v5, 32, v8
  v_cvt_f32_u32 v8, v5
  s_waitcnt vmcnt(10)
  v_mfma_f32_32x32x16_bf16 v[96:111], a[0:3], a[152:155], v[96:111]
  s_lshr_b32 s44, s55, 3
  s_lshl_b32 s44, s44, 3
  s_add_u32 s44, s44, s56
  s_lshl_b32 s44, s44, 7
  s_add_u32 s44, s44, 0xa0000
  v_and_b32 v5, 0x80, v23
  v_mfma_f32_32x32x16_bf16 v[120:135], a[8:11], a[152:155], v[120:135]
  v_mul_u32_u24 v5, 3, v5
  v_add_u32 v5, v5, v23
  buffer_load_dword v23, v5, s[32:35], s44 offen sc1
  buffer_load_dwordx4 a[0:3], v1, s[32:35], s36 offen offset:1024 sc1
  ds_write_b128 v3, a[16:19] offset:1024
  v_mul_f32 v8, 0x3b000000, v8
  s_waitcnt vmcnt(11)
  v_mfma_f32_32x32x16_bf16 v[96:111], a[76:79], a[44:47], v[96:111]
  v_mul_f32 v32, v8, v10
  v_cos_f32 v10, v32
  v_sin_f32 v36, v32
  v_cvt_pk_bf16_f32 v79, v12, v14
  v_mfma_f32_32x32x16_bf16 v[120:135], a[88:91], a[44:47], v[120:135]
  s_add_u32 s36, s45, s38
  buffer_load_dwordx4 a[8:11], v1, s[32:35], s36 offen offset:0 sc1
  ds_write_b128 v3, v[64:67] offset:2048
  v_perm_b32 v115, v79, v79, v11
  v_xor_b32 v115, v115, v13
  v_fmamk_f32 v12, v8, 0x3f800000, v32
  s_waitcnt vmcnt(11)
  v_mfma_f32_32x32x16_bf16 v[96:111], a[92:95], a[168:171], v[96:111]
  v_cos_f32 v14, v12
  v_sin_f32 v116, v12
  v_cvt_pk_bf16_f32 v136, v10, v36
  v_perm_b32 v140, v136, v136, v11
  v_mfma_f32_32x32x16_bf16 v[120:135], a[96:99], a[168:171], v[120:135]
  buffer_load_dwordx4 a[44:47], v1, s[32:35], s36 offen offset:1024 sc1
  ds_write_b128 v3, v[68:71] offset:3072
  v_xor_b32 v140, v140, v13
  v_cndmask_b32 v136, v136, v9, s[40:41]
  v_fmamk_f32 v9, v8, 0x40800000, v32
  v_cos_f32 v10, v9
  s_waitcnt vmcnt(11)
  v_mfma_f32_32x32x16_bf16 v[96:111], a[100:103], a[28:31], v[96:111]
  v_sin_f32 v12, v9
  v_cvt_pk_bf16_f32 v137, v14, v116
  v_perm_b32 v141, v137, v137, v11
  v_xor_b32 v141, v141, v13
  v_mfma_f32_32x32x16_bf16 v[120:135], a[104:107], a[28:31], v[120:135]
  s_add_u32 s36, s67, s38
  buffer_load_dwordx4 a[28:31], v1, s[32:35], s36 offen offset:0 sc1
  ds_write_b128 v3, a[20:23] offset:4096
  v_fmamk_f32 v9, v8, 0x40a00000, v32
  v_cos_f32 v14, v9
  s_waitcnt vmcnt(9)
  v_mfma_f32_32x32x16_bf16 v[96:111], a[108:111], a[200:203], v[96:111]
  v_sin_f32 v36, v9
  v_cvt_pk_bf16_f32 v138, v10, v12
  v_perm_b32 v142, v138, v138, v11
  v_xor_b32 v142, v142, v13
  v_fmamk_f32 v9, v8, 0x41000000, v32
  v_mfma_f32_32x32x16_bf16 v[120:135], a[112:115], a[200:203], v[120:135]
  buffer_load_dwordx4 a[76:79], v1, s[32:35], s36 offen offset:1024 sc1
  ds_write_b128 v3, a[24:27] offset:5120
  v_cos_f32 v10, v9
  v_sin_f32 v12, v9
  s_waitcnt vmcnt(9)
  v_mfma_f32_32x32x16_bf16 v[96:111], a[56:59], a[48:51], v[96:111]
  v_cvt_pk_bf16_f32 v139, v14, v36
  v_perm_b32 v143, v139, v139, v11
  v_xor_b32 v143, v143, v13
  v_fmamk_f32 v9, v8, 0x41100000, v32
  v_cos_f32 v14, v9
  v_mfma_f32_32x32x16_bf16 v[120:135], a[116:119], a[48:51], v[120:135]
  s_add_u32 s36, s69, s38
  buffer_load_dwordx4 a[12:15], v1, s[32:35], s36 offen offset:0 sc1
  v_sin_f32 v36, v9
  v_cvt_pk_bf16_f32 v116, v10, v12
  v_perm_b32 v144, v116, v116, v11
  s_waitcnt vmcnt(9)
  v_mfma_f32_32x32x16_bf16 v[96:111], a[60:63], a[52:55], v[96:111]
  s_waitcnt lgkmcnt(0)
  s_barrier
  v_xor_b32 v144, v144, v13
  v_fmamk_f32 v9, v8, 0x41400000, v32
  v_cos_f32 v10, v9
  v_mfma_f32_32x32x16_bf16 v[120:135], a[120:123], a[52:55], v[120:135]
  buffer_load_dwordx4 a[16:19], v1, s[32:35], s36 offen offset:1024 sc1
  ds_read_b128 v[148:151], v15 offset:0
  ds_read_b128 v[152:155], v15 offset:1024
  ds_read_b128 v[156:159], v17 offset:2048
  ds_read_b128 v[160:163], v17 offset:3072
  s_waitcnt vmcnt(9)
  v_mfma_f32_32x32x16_bf16 v[96:111], a[64:67], a[176:179], v[96:111]
  ds_read_b128 v[164:167], v18 offset:4096
  ds_read_b128 v[168:171], v18 offset:5120
  ds_read_b64 v[172:173], v35 offset:0
  ds_read_b64 v[174:175], v33 offset:0
  ds_read_b64 v[176:177], v35 offset:16384
  ds_read_b64 v[178:179], v33 offset:16384
  v_mfma_f32_32x32x16_bf16 v[120:135], a[124:127], a[176:179], v[120:135]
  s_add_u32 s36, s71, s38
  buffer_load_dwordx4 a[20:23], v1, s[32:35], s36 offen offset:0 sc1
  v_sin_f32 v12, v9
  v_cvt_pk_bf16_f32 v117, v14, v36
  v_perm_b32 v145, v117, v117, v11
  s_waitcnt vmcnt(9)
  v_mfma_f32_32x32x16_bf16 v[96:111], a[68:71], a[180:183], v[96:111]
  v_xor_b32 v145, v145, v13
  v_fmamk_f32 v9, v8, 0x41500000, v32
  v_cos_f32 v14, v9
  v_sin_f32 v33, v9
  v_mfma_f32_32x32x16_bf16 v[120:135], a[128:131], a[180:183], v[120:135]
  buffer_load_dwordx4 a[24:27], v1, s[32:35], s36 offen offset:1024 sc1
  s_waitcnt lgkmcnt(9)
  v_add_f32 v56, v56, v148
  v_add_f32 v57, v57, v149
  v_add_f32 v58, v58, v150
  v_add_f32 v59, v59, v151
  s_waitcnt lgkmcnt(8)
  v_add_f32 v60, v60, v152
  s_waitcnt vmcnt(8)
  v_mfma_f32_32x32x16_bf16 v[96:111], a[72:75], a[0:3], v[96:111]
  v_cmp_ne_u32 vcc, s48, v23
  s_nop 0
  s_cbranch_vccnz L_poll13
L_back13:
  s_add_u32 s36, s37, 0x800000
  s_add_u32 m0, s65, 0
  s_nop 0
  buffer_load_dwordx4 v16, s[32:35], s36 offen offset:0 sc1 lds
  v_add_f32 v61, v61, v153
  v_mfma_f32_32x32x16_bf16 v[120:135], a[132:135], a[0:3], v[120:135]
  buffer_load_dwordx4 v4, s[32:35], s36 offen offset:1024 sc1 lds
  buffer_load_dwordx4 v22, s[32:35], s36 offen offset:2048 sc1 lds
  buffer_load_dwordx4 v37, s[32:35], s36 offen offset:3072 sc1 lds
  s_add_u32 s36, s37, 0x821000
  s_add_u32 m0, s65, 0x1000
  s_nop 0
  buffer_load_dwordx4 v16, s[32:35], s36 offen offset:0 sc1 lds
  s_waitcnt vmcnt(12)
  v_mfma_f32_32x32x16_bf16 v[96:111], a[136:139], a[8:11], v[96:111]
  buffer_load_dwordx4 v4, s[32:35], s36 offen offset:1024 sc1 lds
  buffer_load_dwordx4 v22, s[32:35], s36 offen offset:2048 sc1 lds
  buffer_load_dwordx4 v37, s[32:35], s36 offen offset:3072 sc1 lds
  s_add_u32 s36, s37, 0x908000
  s_add_u32 m0, s65, 0x8000
  s_nop 0
  buffer_load_dwordx4 v16, s[32:35], s36 offen offset:0 sc1 lds
  v_mfma_f32_32x32x16_bf16 v[120:135], a[140:143], a[8:11], v[120:135]
  buffer_load_dwordx4 v4, s[32:35], s36 offen offset:1024 sc1 lds
  buffer_load_dwordx4 v22, s[32:35], s36 offen offset:2048 sc1 lds
  buffer_load_dwordx4 v37, s[32:35], s36 offen offset:3072 sc1 lds
  s_add_u32 s36, s37, 0x929000
  s_add_u32 m0, s65, 0x9000
  s_nop 0
  buffer_load_dwordx4 v16, s[32:35], s36 offen offset:0 sc1 lds
  s_waitcnt vmcnt(19)
  v_mfma_f32_32x32x16_bf16 v[96:111], a[80:83], a[44:47], v[96:111]
  v_add_f32 v62, v62, v154
  v_add_f32 v63, v63, v155
  s_waitcnt lgkmcnt(7)
  v_add_f32 v56, v56, v156
  v_add_f32 v57, v57, v157
  v_add_f32 v58, v58, v158
  v_add_f32 v59, v59, v159
  v_mfma_f32_32x32x16_bf16 v[120:135], a[144:147], a[44:47], v[120:135]
  buffer_load_dwordx4 v4, s[32:35], s36 offen offset:1024 sc1 lds
  s_waitcnt lgkmcnt(6)
  v_add_f32 v60, v60, v160
  v_add_f32 v61, v61, v161
  v_add_f32 v62, v62, v162
  v_add_f32 v63, v63, v163
  s_waitcnt lgkmcnt(5)
  v_add_f32 v56, v56, v164
  s_waitcnt vmcnt(19)
  v_mfma_f32_32x32x16_bf16 v[96:111], a[148:151], a[28:31], v[96:111]
  buffer_load_dwordx4 v22, s[32:35], s36 offen offset:2048 sc1 lds
  buffer_load_dwordx4 v37, s[32:35], s36 offen offset:3072 sc1 lds
  v_add_f32 v57, v57, v165
  v_add_f32 v58, v58, v166
  v_add_f32 v59, v59, v167
  s_waitcnt lgkmcnt(4)
  v_add_f32 v60, v60, v168
  v_mfma_f32_32x32x16_bf16 v[120:135], a[40:43], a[28:31], v[120:135]
  s_add_u32 s36, s72, s38
  buffer_load_dwordx4 a[0:3], v1, s[32:35], s36 offen offset:0 sc1
  v_add_f32 v61, v61, v169
  v_add_f32 v62, v62, v170
  v_add_f32 v63, v63, v171
  v_mul_f32 v148, 0xbfb8aa3b, v56
  s_waitcnt vmcnt(21)
  v_mfma_f32_32x32x16_bf16 v[96:111], a[156:159], a[76:79], v[96:111]
  v_mul_f32 v149, 0xbfb8aa3b, v57
  v_exp_f32 v148, v148
  v_exp_f32 v149, v149
  v_fma_f32 v148, v148, s39, s39
  v_mfma_f32_32x32x16_bf16 v[120:135], a[160:163], a[76:79], v[120:135]
  buffer_load_dwordx4 a[8:11], v1, s[32:35], s36 offen offset:1024 sc1
  v_fma_f32 v149, v149, s39, s39
  v_rcp_f32 v148, v148
  v_rcp_f32 v149, v149
  s_waitcnt vmcnt(21)
  v_mfma_f32_32x32x16_bf16 v[96:111], a[164:167], a[12:15], v[96:111]
  v_mul_f32 v148, v148, v56
  v_mul_f32 v149, v149, v57
  v_mul_f32 v150, 0xbfb8aa3b, v58
  v_mul_f32 v151, 0xbfb8aa3b, v59
  v_exp_f32 v150, v150
  v_mfma_f32_32x32x16_bf16 v[120:135], a[4:7], a[12:15], v[120:135]
  s_add_u32 s36, s76, s38
  buffer_load_dwordx4 a[4:7], v1, s[32:35], s36 offen offset:0 sc1
  v_exp_f32 v151, v151
  v_fma_f32 v150, v150, s39, s39
  v_fma_f32 v151, v151, s39, s39
  s_waitcnt vmcnt(21)
  v_mfma_f32_32x32x16_bf16 v[96:111], a[172:175], a[16:19], v[96:111]
  v_rcp_f32 v150, v150
  v_rcp_f32 v151, v151
  v_mul_f32 v150, v150, v58
  v_mul_f32 v151, v151, v59
  v_mfma_f32_32x32x16_bf16 v[120:135], a[192:195], a[16:19], v[120:135]
  buffer_load_dwordx4 a[12:15], v1, s[32:35], s36 offen offset:1024 sc1
  v_mul_f32 v152, 0xbfb8aa3b, v60
  v_mul_f32 v153, 0xbfb8aa3b, v61
  v_exp_f32 v152, v152
  v_exp_f32 v153, v153
  s_waitcnt vmcnt(21)
  v_mfma_f32_32x32x16_bf16 v[96:111], a[196:199], a[20:23], v[96:111]
  s_waitcnt vmcnt(16)
  ds_read_b64_tr_b16 a[16:17], v39 offset:0
  ds_read_b64_tr_b16 a[18:19], v39 offset:1024
  ds_read_b64_tr_b16 a[28:29], v2 offset:0
  ds_read_b64_tr_b16 a[30:31], v2 offset:1024
  v_mfma_f32_32x32x16_bf16 v[120:135], a[84:87], a[20:23], v[120:135]
  v_cvt_pk_bf16_f32 v118, v10, v12
  v_perm_b32 v146, v118, v118, v11
  v_xor_b32 v146, v146, v13
  v_fmamk_f32 v4, v8, 0x41800000, v32
  v_cos_f32 v5, v4
  v_sin_f32 v9, v4
  v_cvt_pk_bf16_f32 v119, v14, v33
  v_perm_b32 v147, v119, v119, v11
  v_xor_b32 v147, v147, v13
  v_fmamk_f32 v4, v8, 0x41880000, v32
  v_cos_f32 v10, v4
  v_sin_f32 v12, v4
  v_cvt_pk_bf16_f32 v156, v5, v9
  v_perm_b32 v160, v156, v156, v11
  v_xor_b32 v160, v160, v13
  v_fmamk_f32 v4, v8, 0x41a00000, v32
  v_cos_f32 v5, v4
  v_sin_f32 v9, v4
  v_cvt_pk_bf16_f32 v157, v10, v12
  v_perm_b32 v161, v157, v157, v11
  v_xor_b32 v161, v161, v13
  v_fmamk_f32 v4, v8, 0x41a80000, v32
  v_cos_f32 v10, v4
  v_sin_f32 v12, v4
  v_cvt_pk_bf16_f32 v158, v5, v9
  v_perm_b32 v162, v158, v158, v11
  v_xor_b32 v162, v162, v13
  v_fmamk_f32 v4, v8, 0x41c00000, v32
  v_cos_f32 v5, v4
  v_sin_f32 v9, v4
  v_cvt_pk_bf16_f32 v159, v10, v12
  v_perm_b32 v163, v159, v159, v11
  v_xor_b32 v163, v163, v13
  v_fmamk_f32 v4, v8, 0x41c80000, v32
  v_cos_f32 v10, v4
  v_sin_f32 v12, v4
  v_cvt_pk_bf16_f32 v164, v5, v9
  v_perm_b32 v168, v164, v164, v11
  v_xor_b32 v168, v168, v13
  v_fmamk_f32 v4, v8, 0x41e00000, v32
  v_cos_f32 v5, v4
  v_sin_f32 v9, v4
  v_cvt_pk_bf16_f32 v165, v10, v12
  v_perm_b32 v169, v165, v165, v11
  v_xor_b32 v169, v169, v13
  v_fmamk_f32 v4, v8, 0x41e80000, v32
  v_cos_f32 v8, v4
  v_sin_f32 v10, v4
  v_cvt_pk_bf16_f32 v166, v5, v9
  v_perm_b32 v170, v166, v166, v11
  v_xor_b32 v170, v170, v13
  v_cvt_pk_bf16_f32 v167, v8, v10
  v_perm_b32 v171, v167, v167, v11
  v_xor_b32 v171, v171, v13
  v_mfma_f32_32x32x16_bf16 v[96:111], a[204:207], a[24:27], v[96:111]
  s_add_u32 s36, s78, s38
  buffer_load_dwordx4 a[20:23], v1, s[32:35], s36 offen offset:0 sc1
  ds_read_b64_tr_b16 a[40:41], v39 offset:2048
  ds_read_b64_tr_b16 a[42:43], v39 offset:3072
  v_mfma_f32_32x32x16_bf16 v[120:135], a[208:211], a[24:27], v[120:135]
  ds_read_b64_tr_b16 a[24:25], v2 offset:2048
  ds_read_b64_tr_b16 a[26:27], v2 offset:3072
  buffer_load_dwordx4 a[44:47], v1, s[32:35], s36 offen offset:1024 sc1
  v_fma_f32 v152, v152, s39, s39
  v_fma_f32 v153, v153, s39, s39
  v_rcp_f32 v152, v152
  s_waitcnt lgkmcnt(6)
  v_mfma_f32_32x32x16_bf16 v[180:195], v[24:27], a[16:19], 0
  s_waitcnt vmcnt(14)
  ds_read_b64_tr_b16 a[48:49], v39 offset:4096
  ds_read_b64_tr_b16 a[50:51], v39 offset:5120
  ds_read_b64_tr_b16 a[52:53], v2 offset:4096
  ds_read_b64_tr_b16 a[54:55], v2 offset:5120
  v_mfma_f32_32x32x16_bf16 a[56:71], v[136:139], a[16:19], 0
  s_add_u32 s36, s79, s38
  buffer_load_dwordx4 a[16:19], v1, s[32:35], s36 offen offset:0 sc1
  v_rcp_f32 v153, v153
  v_mul_f32 v152, v152, v60
  v_mul_f32 v153, v153, v61
  s_waitcnt lgkmcnt(6)
  v_mfma_f32_32x32x16_bf16 v[180:195], v[40:43], a[40:43], v[180:195]
  ds_read_b64_tr_b16 a[72:73], v39 offset:6144
  ds_read_b64_tr_b16 a[74:75], v39 offset:7168
  ds_read_b64_tr_b16 a[76:77], v2 offset:6144
  ds_read_b64_tr_b16 a[78:79], v2 offset:7168
  v_mul_f32 v154, 0xbfb8aa3b, v62
  v_mul_f32 v155, 0xbfb8aa3b, v63
  v_mfma_f32_32x32x16_bf16 a[56:71], v[116:119], a[40:43], a[56:71]
  buffer_load_dwordx4 a[40:43], v1, s[32:35], s36 offen offset:1024 sc1
  v_exp_f32 v154, v154
  v_exp_f32 v155, v155
  v_fma_f32 v154, v154, s39, s39
  s_waitcnt lgkmcnt(6)
  v_mfma_f32_32x32x16_bf16 v[180:195], v[48:51], a[48:51], v[180:195]
  s_waitcnt vmcnt(12)
  ds_read_b64_tr_b16 a[80:81], v39 offset:32768
  ds_read_b64_tr_b16 a[82:83], v39 offset:33792
  ds_read_b64_tr_b16 a[84:85], v2 offset:32768
  ds_read_b64_tr_b16 a[86:87], v2 offset:33792
  v_fma_f32 v155, v155, s39, s39
  v_mfma_f32_32x32x16_bf16 a[56:71], v[156:159], a[48:51], a[56:71]
  v_rcp_f32 v154, v154
  v_rcp_f32 v155, v155
  v_mul_f32 v154, v154, v62
  v_mul_f32 v155, v155, v63
  s_waitcnt lgkmcnt(6)
  v_mfma_f32_32x32x16_bf16 v[180:195], v[76:79], a[72:75], v[180:195]
  ds_read_b64_tr_b16 a[48:49], v39 offset:34816
  ds_read_b64_tr_b16 a[50:51], v39 offset:35840
  ds_read_b64_tr_b16 a[88:89], v2 offset:34816
  ds_read_b64_tr_b16 a[90:91], v2 offset:35840
  v_lshlrev_b32 v56, 16, v172
  v_and_b32 v57, 0xffff0000, v172
  v_mfma_f32_32x32x16_bf16 a[56:71], v[164:167], a[72:75], a[56:71]
  v_lshlrev_b32 v58, 16, v173
  v_and_b32 v59, 0xffff0000, v173
  v_lshlrev_b32 v60, 16, v174
  v_and_b32 v61, 0xffff0000, v174
  v_lshlrev_b32 v62, 16, v175
  v_and_b32 v63, 0xffff0000, v175
  s_waitcnt lgkmcnt(6)
  v_mfma_f32_32x32x16_bf16 v[180:195], v[28:31], a[80:83], v[180:195]
  s_waitcnt vmcnt(8)
  ds_read_b64_tr_b16 a[72:73], v39 offset:36864
  ds_read_b64_tr_b16 a[74:75], v39 offset:37888
  ds_read_b64_tr_b16 a[92:93], v2 offset:36864
  ds_read_b64_tr_b16 a[94:95], v2 offset:37888
  v_lshlrev_b32 v64, 16, v176
  v_mfma_f32_32x32x16_bf16 a[56:71], v[140:143], a[80:83], a[56:71]
  v_and_b32 v65, 0xffff0000, v176
  v_lshlrev_b32 v66, 16, v177
  v_and_b32 v67, 0xffff0000, v177
  v_lshlrev_b32 v68, 16, v178
  v_and_b32 v69, 0xffff0000, v178
  v_lshlrev_b32 v70, 16, v179
  s_waitcnt lgkmcnt(6)
  v_mfma_f32_32x32x16_bf16 v[180:195], v[44:47], a[48:51], v[180:195]
  ds_read_b64_tr_b16 a[80:81], v39 offset:38912
  ds_read_b64_tr_b16 a[82:83], v39 offset:39936
  ds_read_b64_tr_b16 a[96:97], v2 offset:38912
  ds_read_b64_tr_b16 a[98:99], v2 offset:39936
  v_and_b32 v71, 0xffff0000, v179
  v_mfma_f32_32x32x16_bf16 a[56:71], v[144:147], a[48:51], a[56:71]
  s_waitcnt lgkmcnt(6)
  v_mfma_f32_32x32x16_bf16 v[180:195], v[52:55], a[72:75], v[180:195]
  v_mfma_f32_32x32x16_bf16 a[56:71], v[160:163], a[72:75], a[56:71]
  s_waitcnt lgkmcnt(2)
  v_mfma_f32_32x32x16_bf16 v[180:195], v[112:115], a[80:83], v[180:195]
  v_mfma_f32_32x32x16_bf16 a[56:71], v[168:171], a[80:83], a[56:71]
  v_mfma_f32_32x32x16_bf16 v[196:211], v[24:27], a[28:31], 0
  v_mfma_f32_32x32x16_bf16 a[100:115], v[136:139], a[28:31], 0
  v_mfma_f32_32x32x16_bf16 v[196:211], v[40:43], a[24:27], v[196:211]
  s_nop 8
  ds_write_b128 v7, a[56:59] offset:0
  v_mfma_f32_32x32x16_bf16 a[100:115], v[116:119], a[24:27], a[100:115]
  ds_write_b128 v7, a[60:63] offset:1024
  v_mfma_f32_32x32x16_bf16 v[196:211], v[48:51], a[52:55], v[196:211]
  v_fmac_f32 v56, v180, v148
  v_fmac_f32 v57, v181, v149
  v_fmac_f32 v58, v182, v150
  v_fmac_f32 v59, v183, v151
  v_fmac_f32 v60, v184, v152
  v_fmac_f32 v61, v185, v153
  v_mfma_f32_32x32x16_bf16 a[100:115], v[156:159], a[52:55], a[100:115]
  ds_write_b128 v7, v[188:191] offset:2048
  v_fmac_f32 v62, v186, v154
  v_fmac_f32 v63, v187, v155
  v_mfma_f32_32x32x16_bf16 v[196:211], v[76:79], a[76:79], v[196:211]
  ds_write_b128 v7, v[192:195] offset:3072
  v_mfma_f32_32x32x16_bf16 a[100:115], v[164:167], a[76:79], a[100:115]
  v_mfma_f32_32x32x16_bf16 v[196:211], v[28:31], a[84:87], v[196:211]
  ds_write_b128 v7, a[64:67] offset:4096
  v_mfma_f32_32x32x16_bf16 a[100:115], v[140:143], a[84:87], a[100:115]
  ds_write_b128 v7, a[68:71] offset:5120
  v_mfma_f32_32x32x16_bf16 v[196:211], v[44:47], a[88:91], v[196:211]
  v_mfma_f32_32x32x16_bf16 a[100:115], v[144:147], a[88:91], a[100:115]
  s_waitcnt lgkmcnt(0)
  s_barrier
  ds_read_b128 v[8:11], v19 offset:0
  ds_read_b128 v[24:27], v19 offset:1024
  ds_read_b128 v[28:31], v20 offset:2048
  ds_read_b128 v[40:43], v20 offset:3072
  v_mfma_f32_32x32x16_bf16 v[196:211], v[52:55], a[92:95], v[196:211]
  ds_read_b128 v[44:47], v21 offset:4096
  ds_read_b128 v[48:51], v21 offset:5120
  v_mfma_f32_32x32x16_bf16 a[100:115], v[160:163], a[92:95], a[100:115]
  v_mfma_f32_32x32x16_bf16 v[196:211], v[112:115], a[96:99], v[196:211]
  v_mfma_f32_32x32x16_bf16 a[100:115], v[168:171], a[96:99], a[100:115]
  s_waitcnt lgkmcnt(5)
  v_fmac_f32 v56, v8, v148
  v_fmac_f32 v57, v9, v149
  v_fmac_f32 v58, v10, v150
  v_fmac_f32 v59, v11, v151
  s_waitcnt lgkmcnt(4)
  v_fmac_f32 v60, v24, v152
  v_fmac_f32 v61, v25, v153
  s_waitcnt vmcnt(7)
  v_mfma_f32_32x32x16_bf16 v[96:111], a[212:215], a[0:3], v[96:111]
  v_fmac_f32 v62, v26, v154
  v_fmac_f32 v63, v27, v155
  s_waitcnt lgkmcnt(3)
  v_fmac_f32 v56, v28, v148
  v_mfma_f32_32x32x16_bf16 v[120:135], a[216:219], a[0:3], v[120:135]
  v_fmac_f32 v57, v29, v149
  v_fmac_f32 v58, v30, v150
  v_fmac_f32 v59, v31, v151
  s_waitcnt vmcnt(6)
  v_mfma_f32_32x32x16_bf16 v[96:111], a[220:223], a[8:11], v[96:111]
  ds_write_b128 v3, a[100:103] offset:32768
  s_waitcnt lgkmcnt(3)
  v_fmac_f32 v60, v40, v152
  v_fmac_f32 v61, v41, v153
  v_mfma_f32_32x32x16_bf16 v[120:135], a[224:227], a[8:11], v[120:135]
  ds_write_b128 v3, a[104:107] offset:33792
  v_fmac_f32 v62, v42, v154
  v_fmac_f32 v63, v43, v155
  s_waitcnt vmcnt(5)
  v_mfma_f32_32x32x16_bf16 v[120:135], a[36:39], a[4:7], v[120:135]
  s_waitcnt lgkmcnt(3)
  v_fmac_f32 v56, v44, v148
  v_fmac_f32 v57, v45, v149
  v_fmac_f32 v58, v46, v150
  s_waitcnt vmcnt(4)
  v_mfma_f32_32x32x16_bf16 v[120:135], a[240:243], a[12:15], v[120:135]
  ds_write_b128 v3, v[204:207] offset:34816
  v_fmac_f32 v59, v47, v151
  s_waitcnt lgkmcnt(3)
  v_fmac_f32 v60, v48, v152
  s_waitcnt vmcnt(3)
  v_mfma_f32_32x32x16_bf16 v[120:135], a[248:251], a[20:23], v[120:135]
  ds_write_b128 v3, v[208:211] offset:35840
  v_fmac_f32 v61, v49, v153
  v_fmac_f32 v62, v50, v154
  s_waitcnt vmcnt(2)
  v_mfma_f32_32x32x16_bf16 v[120:135], v[72:75], a[44:47], v[120:135]
  v_fmac_f32 v63, v51, v155
  v_cvt_pk_bf16_f32 v8, v56, v57
  v_cvt_pk_bf16_f32 v9, v58, v59
  s_waitcnt vmcnt(1)
  v_mfma_f32_32x32x16_bf16 v[120:135], v[84:87], a[16:19], v[120:135]
  ds_write_b128 v3, a[108:111] offset:36864
  v_cvt_pk_bf16_f32 v10, v60, v61
  v_cvt_pk_bf16_f32 v11, v62, v63
  s_waitcnt vmcnt(0)
  v_mfma_f32_32x32x16_bf16 v[120:135], v[92:95], a[40:43], v[120:135]
  ds_write_b128 v3, a[112:115] offset:37888
  v_permlane32_swap_b32 v8, v10
  v_permlane32_swap_b32 v9, v11
  v_mfma_f32_32x32x16_bf16 v[96:111], a[32:35], a[4:7], v[96:111]
  buffer_store_dwordx4 v[8:11], v6, s[28:31], s42 offen
  v_mfma_f32_32x32x16_bf16 v[96:111], a[236:239], a[12:15], v[96:111]
  s_waitcnt lgkmcnt(0)
  s_barrier
  ds_read_b128 v[8:11], v15 offset:32768
  v_mfma_f32_32x32x16_bf16 v[96:111], a[244:247], a[20:23], v[96:111]
  ds_read_b128 v[20:23], v15 offset:33792
  ds_read_b128 v[24:27], v17 offset:34816
  ds_read_b128 v[28:31], v17 offset:35840
  v_mfma_f32_32x32x16_bf16 v[96:111], a[252:255], a[44:47], v[96:111]
  ds_read_b128 v[40:43], v18 offset:36864
  ds_read_b128 v[44:47], v18 offset:37888
  ds_write_b128 v3, v[120:123] offset:0
  v_mfma_f32_32x32x16_bf16 v[96:111], v[80:83], a[16:19], v[96:111]
  ds_write_b128 v3, v[124:127] offset:1024
  ds_write_b128 v3, v[128:131] offset:4096
  ds_write_b128 v3, v[132:135] offset:5120
  v_mfma_f32_32x32x16_bf16 v[96:111], v[88:91], a[40:43], v[96:111]
  s_waitcnt lgkmcnt(9)
  v_add_f32 v196, v196, v8
  v_add_f32 v197, v197, v9
  v_add_f32 v198, v198, v10
  s_nop 7
  ds_write_b128 v3, v[104:107] offset:2048
  ds_write_b128 v3, v[108:111] offset:3072
  s_mov_b32 s36, 0xbfb8aa3b
  s_mov_b32 s37, 0x49000000
  v_add_f32 v199, v199, v11
  s_waitcnt lgkmcnt(10)
  v_add_f32 v200, v200, v20
  v_add_f32 v201, v201, v21
  v_add_f32 v202, v202, v22
  v_add_f32 v203, v203, v23
  s_waitcnt lgkmcnt(9)
  v_add_f32 v196, v196, v24
  v_add_f32 v197, v197, v25
  v_add_f32 v198, v198, v26
  v_add_f32 v199, v199, v27
  s_waitcnt lgkmcnt(8)
  v_add_f32 v200, v200, v28
  v_add_f32 v201, v201, v29
  v_add_f32 v202, v202, v30
  v_add_f32 v203, v203, v31
  s_waitcnt lgkmcnt(7)
  v_add_f32 v196, v196, v40
  v_add_f32 v197, v197, v41
  v_add_f32 v198, v198, v42
  v_add_f32 v199, v199, v43
  s_waitcnt lgkmcnt(6)
  v_add_f32 v200, v200, v44
  v_add_f32 v201, v201, v45
  v_add_f32 v202, v202, v46
  v_add_f32 v203, v203, v47
  s_waitcnt lgkmcnt(0)
  s_barrier
  ds_read_b128 v[8:11], v15 offset:0
  ds_read_b128 v[20:23], v15 offset:1024
  ds_read_b128 v[12:15], v17 offset:2048
  ds_read_b128 v[24:27], v17 offset:3072
  ds_read_b128 v[28:31], v18 offset:4096
  ds_read_b128 v[40:43], v18 offset:5120
  s_waitcnt lgkmcnt(5)
  v_pk_add_f32 v[96:97], v[96:97], v[8:9]
  v_pk_add_f32 v[98:99], v[98:99], v[10:11]
  s_waitcnt lgkmcnt(4)
  v_pk_add_f32 v[100:101], v[100:101], v[20:21]
  v_pk_add_f32 v[102:103], v[102:103], v[22:23]
  s_waitcnt lgkmcnt(3)
  v_pk_add_f32 v[96:97], v[96:97], v[12:13]
  v_pk_add_f32 v[98:99], v[98:99], v[14:15]
  s_waitcnt lgkmcnt(2)
  v_pk_add_f32 v[100:101], v[100:101], v[24:25]
  v_pk_add_f32 v[102:103], v[102:103], v[26:27]
  s_waitcnt lgkmcnt(1)
  v_pk_add_f32 v[96:97], v[96:97], v[28:29]
  v_pk_add_f32 v[98:99], v[98:99], v[30:31]
  s_waitcnt lgkmcnt(0)
  v_pk_add_f32 v[100:101], v[100:101], v[40:41]
  v_pk_add_f32 v[102:103], v[102:103], v[42:43]
  v_pk_mul_f32 v[8:9], v[96:97], s[36:37] op_sel_hi:[1,0]
  v_pk_mul_f32 v[10:11], v[98:99], s[36:37] op_sel_hi:[1,0]
  v_pk_mul_f32 v[12:13], v[100:101], s[36:37] op_sel_hi:[1,0]
  v_pk_mul_f32 v[14:15], v[102:103], s[36:37] op_sel_hi:[1,0]
  v_exp_f32 v8, v8
  v_exp_f32 v9, v9
  v_exp_f32 v10, v10
  v_exp_f32 v11, v11
  v_exp_f32 v12, v12
  v_exp_f32 v13, v13
  v_exp_f32 v14, v14
  v_exp_f32 v15, v15
  v_pk_fma_f32 v[8:9], v[8:9], s[36:37], s[36:37] op_sel:[0,1,1] op_sel_hi:[1,1,1]
  v_pk_fma_f32 v[10:11], v[10:11], s[36:37], s[36:37] op_sel:[0,1,1] op_sel_hi:[1,1,1]
  v_pk_fma_f32 v[12:13], v[12:13], s[36:37], s[36:37] op_sel:[0,1,1] op_sel_hi:[1,1,1]
  v_pk_fma_f32 v[14:15], v[14:15], s[36:37], s[36:37] op_sel:[0,1,1] op_sel_hi:[1,1,1]
  v_rcp_f32 v8, v8
  v_rcp_f32 v9, v9
  v_rcp_f32 v10, v10
  v_rcp_f32 v11, v11
  v_rcp_f32 v12, v12
  v_rcp_f32 v13, v13
  v_rcp_f32 v14, v14
  v_rcp_f32 v15, v15
  v_pk_mul_f32 v[96:97], v[96:97], v[196:197]
  v_pk_mul_f32 v[98:99], v[98:99], v[198:199]
  v_pk_mul_f32 v[100:101], v[100:101], v[200:201]
  v_pk_mul_f32 v[102:103], v[102:103], v[202:203]
  v_pk_fma_f32 v[64:65], v[96:97], v[8:9], v[64:65]
  v_pk_fma_f32 v[66:67], v[98:99], v[10:11], v[66:67]
  v_pk_fma_f32 v[68:69], v[100:101], v[12:13], v[68:69]
  v_pk_fma_f32 v[70:71], v[102:103], v[14:15], v[70:71]
  v_cvt_pk_bf16_f32 v8, v64, v65
  v_cvt_pk_bf16_f32 v9, v66, v67
  v_cvt_pk_bf16_f32 v10, v68, v69
  v_cvt_pk_bf16_f32 v11, v70, v71
  s_nop 0
  v_permlane32_swap_b32 v8, v10
  v_permlane32_swap_b32 v9, v11
  buffer_store_dwordx4 v[8:11], v6, s[28:31], s43 offen
  s_or_b32 s36, s2, s56
  s_cmp_eq_u32 s36, 0
  s_cselect_b32 s36, 0, 0x40000000
  buffer_store_dword v34, v38, s[32:35], s36 offen sc1
  s_endpgm
L_poll1:
  s_mov_b32 s68, 1
L_poll1x:
  s_sleep 8
  buffer_load_dwordx4 v[168:171], v22, s[32:35], s58 offen sc1
  s_waitcnt vmcnt(0)
  v_cmp_ne_u32 vcc, s48, v171
  s_nop 4
  s_cbranch_vccz L_back1
  s_add_u32 s68, s68, 1
  s_cmp_lt_u32 s68, 0x80000
  s_cbranch_scc1 L_poll1x
  s_branch L_back1
L_poll2:
  s_mov_b32 s68, 1
L_poll2x:
  s_sleep 8
  buffer_load_dwordx4 v[148:151], v22, s[32:35], s64 offen sc1
  s_waitcnt vmcnt(0)
  v_cmp_ne_u32 vcc, s48, v151
  s_nop 4
  s_cbranch_vccz L_back2
  s_add_u32 s68, s68, 1
  s_cmp_lt_u32 s68, 0x80000
  s_cbranch_scc1 L_poll2x
  s_branch L_back2
L_poll3:
  s_mov_b32 s68, 1
L_poll3x:
  s_sleep 8
  buffer_load_dwordx4 v[172:175], v22, s[32:35], s77 offen sc1
  s_waitcnt vmcnt(0)
  v_cmp_ne_u32 vcc, s48, v175
  s_nop 4
  s_cbranch_vccz L_back3
  s_add_u32 s68, s68, 1
  s_cmp_lt_u32 s68, 0x80000
  s_cbranch_scc1 L_poll3x
  s_branch L_back3
L_poll4:
  s_mov_b32 s68, 1
L_poll4x:
  s_sleep 8
  buffer_load_dwordx4 v[176:179], v22, s[32:35], s80 offen sc1
  s_waitcnt vmcnt(0)
  v_cmp_ne_u32 vcc, s48, v179
  s_nop 4
  s_cbranch_vccz L_back4
  s_add_u32 s68, s68, 1
  s_cmp_lt_u32 s68, 0x80000
  s_cbranch_scc1 L_poll4x
  s_branch L_back4
L_poll5:
  s_mov_b32 s68, 1
L_poll5x:
  s_sleep 8
  buffer_load_dwordx4 v[156:159], v22, s[32:35], s81 offen sc1
  s_waitcnt vmcnt(0)
  v_cmp_ne_u32 vcc, s48, v159
  s_nop 4
  s_cbranch_vccz L_back5
  s_add_u32 s68, s68, 1
  s_cmp_lt_u32 s68, 0x80000
  s_cbranch_scc1 L_poll5x
  s_branch L_back5
L_poll6:
  s_mov_b32 s68, 1
L_poll6x:
  s_sleep 8
  buffer_load_dwordx4 v[60:63], v22, s[32:35], s38 offen sc1
  s_waitcnt vmcnt(0)
  v_cmp_ne_u32 vcc, s48, v63
  s_nop 4
  s_cbranch_vccz L_back6
  s_add_u32 s68, s68, 1
  s_cmp_lt_u32 s68, 0x80000
  s_cbranch_scc1 L_poll6x
  s_branch L_back6
L_poll7:
  s_mov_b32 s68, 1
L_poll7x:
  s_sleep 8
  buffer_load_dwordx4 v[64:67], v22, s[32:35], s52 offen sc1
  s_waitcnt vmcnt(0)
  v_cmp_ne_u32 vcc, s48, v67
  s_nop 4
  s_cbranch_vccz L_back7
  s_add_u32 s68, s68, 1
  s_cmp_lt_u32 s68, 0x80000
  s_cbranch_scc1 L_poll7x
  s_branch L_back7
L_poll8:
  s_mov_b32 s68, 1
L_poll8x:
  s_sleep 8
  buffer_load_dwordx4 v[68:71], v22, s[32:35], s57 offen sc1
  s_waitcnt vmcnt(0)
  v_cmp_ne_u32 vcc, s48, v71
  s_nop 4
  s_cbranch_vccz L_back8
  s_add_u32 s68, s68, 1
  s_cmp_lt_u32 s68, 0x80000
  s_cbranch_scc1 L_poll8x
  s_branch L_back8
L_poll9:
  s_mov_b32 s68, 1
L_poll9x:
  s_sleep 8
  buffer_load_dword v33, v23, s[32:35], s39 offen sc1
  s_waitcnt vmcnt(0)
  v_cmp_ne_u32 vcc, s48, v33
  s_nop 4
  s_cbranch_vccz L_back9
  s_add_u32 s68, s68, 1
  s_cmp_lt_u32 s68, 0x80000
  s_cbranch_scc1 L_poll9x
  s_branch L_back9
L_poll10:
  s_mov_b32 s68, 1
L_poll10x:
  s_sleep 8
  buffer_load_dword v35, v32, s[32:35], s38 offen sc1
  s_waitcnt vmcnt(0)
  v_cmp_ne_u32 vcc, s48, v35
  s_nop 4
  s_cbranch_vccz L_back10
  s_add_u32 s68, s68, 1
  s_cmp_lt_u32 s68, 0x80000
  s_cbranch_scc1 L_poll10x
  s_branch L_back10
L_poll11:
  s_mov_b32 s68, 1
L_poll11x:
  s_sleep 8
  buffer_load_dword v19, v18, s[32:35], s37 offen sc1
  s_waitcnt vmcnt(0)
  v_cmp_ne_u32 vcc, s48, v19
  s_nop 4
  s_cbranch_vccz L_back11
  s_add_u32 s68, s68, 1
  s_cmp_lt_u32 s68, 0x80000
  s_cbranch_scc1 L_poll11x
  s_branch L_back11
L_poll12:
  s_mov_b32 s68, 1
L_poll12x:
  s_sleep 8
  buffer_load_dword v22, v18, s[32:35], s42 offen sc1
  s_waitcnt vmcnt(0)
  v_cmp_ne_u32 vcc, s48, v22
  s_nop 4
  s_cbranch_vccz L_back12
  s_add_u32 s68, s68, 1
  s_cmp_lt_u32 s68, 0x80000
  s_cbranch_scc1 L_poll12x
  s_branch L_back12
L_poll13:
  s_mov_b32 s68, 1
L_poll13x:
  s_sleep 8
  buffer_load_dword v23, v5, s[32:35], s44 offen sc1
  s_waitcnt vmcnt(0)
  v_cmp_ne_u32 vcc, s48, v23
  s_nop 4
  s_cbranch_vccz L_back13
  s_add_u32 s68, s68, 1
  s_cmp_lt_u32 s68, 0x80000
  s_cbranch_scc1 L_poll13x
  s_branch L_back13
L_helper2:
  s_mov_b32 s34, 0x2000000
  s_mov_b32 s35, 0x20000
  s_mov_b32 s10, 0x101000
  s_mov_b32 s11, 0x20000
  s_mov_b64 s[14:15], s[10:11]
  s_mov_b64 s[26:27], s[18:19]
  s_mov_b64 s[30:31], s[6:7]
  s_mov_b32 s62, s2
  s_xor_b32 s64, s59, 4
  s_mov_b32 s66, 0
  s_mov_b64 s[8:9], s[38:39]
  s_mov_b64 s[12:13], s[40:41]
  s_mov_b64 s[24:25], s[48:49]
  s_mov_b64 s[28:29], s[50:51]
  s_load_dword s36, s[32:33], 0
  v_and_b32 v3, 15, v6
  v_lshrrev_b32 v8, 4, v6
  v_cvt_f32_u32 v9, v3
  v_cvt_f32_u32 v10, v8
  v_mul_f32 v10, 4.0, v10
  v_cmp_eq_u32 s[38:39], 0, v3
  v_cmp_lt_u32 s[40:41], 7, v3
  v_mul_f32 v11, 0x3d000000, v9
  v_mul_f32 v12, v11, v10
  v_mov_b32 v13, 0.5
  v_cndmask_b32 v14, v11, v13, s[38:39]
  v_mov_b32 v13, 0x3e800000
  v_cndmask_b32 v13, v13, 0, s[38:39]
  v_fma_f32 v15, v14, v10, v13
  v_cos_f32 v16, v12
  v_fmamk_f32 v17, v11, 0x3f800000, v12
  v_cos_f32 v18, v17
  s_nop 0
  v_cvt_pk_bf16_f32 v20, v16, v18
  v_fmamk_f32 v16, v11, 0x40000000, v12
  v_cos_f32 v17, v16
  v_fmamk_f32 v16, v11, 0x40400000, v12
  v_cos_f32 v18, v16
  s_nop 0
  v_cvt_pk_bf16_f32 v21, v17, v18
  v_fmamk_f32 v16, v11, 0x41800000, v12
  v_cos_f32 v17, v16
  v_fmamk_f32 v16, v11, 0x41880000, v12
  v_cos_f32 v18, v16
  s_nop 0
  v_cvt_pk_bf16_f32 v22, v17, v18
  v_fmamk_f32 v16, v11, 0x41900000, v12
  v_cos_f32 v17, v16
  v_fmamk_f32 v16, v11, 0x41980000, v12
  v_cos_f32 v11, v16
  s_nop 0
  v_cvt_pk_bf16_f32 v23, v17, v11
  v_cos_f32 v11, v15
  v_fmamk_f32 v12, v14, 0x3f800000, v15
  v_cos_f32 v16, v12
  s_nop 0
  v_cvt_pk_bf16_f32 v24, v11, v16
  v_fmamk_f32 v11, v14, 0x40000000, v15
  v_cos_f32 v12, v11
  v_fmamk_f32 v11, v14, 0x40400000, v15
  v_cos_f32 v16, v11
  s_nop 0
  v_cvt_pk_bf16_f32 v25, v12, v16
  v_fmamk_f32 v11, v14, 0x41800000, v15
  v_cos_f32 v12, v11
  v_fmamk_f32 v11, v14, 0x41880000, v15
  v_cos_f32 v16, v11
  s_nop 0
  v_cvt_pk_bf16_f32 v26, v12, v16
  v_fmamk_f32 v11, v14, 0x41900000, v15
  v_cos_f32 v12, v11
  v_fmamk_f32 v11, v14, 0x41980000, v15
  v_cos_f32 v14, v11
  s_nop 0
  v_cvt_pk_bf16_f32 v27, v12, v14
  v_mul_f32 v11, 0x3b000000, v9
  v_mul_f32 v12, v11, v10
  v_cos_f32 v16, v12
  v_sin_f32 v28, v12
  v_fmamk_f32 v14, v11, 0x3f800000, v12
  v_cos_f32 v17, v14
  v_sin_f32 v29, v14
  v_fmamk_f32 v14, v11, 0x40000000, v12
  v_cos_f32 v18, v14
  v_sin_f32 v30, v14
  v_fmamk_f32 v14, v11, 0x40400000, v12
  v_cos_f32 v19, v14
  v_sin_f32 v31, v14
  v_mul_f32 v11, 0x3d800000, v9
  v_mul_f32 v9, v11, v10
  v_mov_b32 v13, -1.0
  v_cndmask_b32 v12, 1.0, v13, s[40:41]
  v_cos_f32 v14, v9
  v_sin_f32 v15, v9
  s_nop 0
  v_cvt_pk_bf16_f32 v32, v14, v15
  v_mul_f32 v36, v12, v14
  v_mul_f32 v14, v12, v15
  v_cvt_pk_bf16_f32 v40, -v14, v36
  v_fmamk_f32 v14, v11, 0x3f800000, v9
  v_cos_f32 v15, v14
  v_sin_f32 v36, v14
  s_nop 0
  v_cvt_pk_bf16_f32 v33, v15, v36
  v_mul_f32 v14, v12, v15
  v_mul_f32 v15, v12, v36
  v_cvt_pk_bf16_f32 v41, -v15, v14
  v_fmamk_f32 v14, v11, 0x40000000, v9
  v_cos_f32 v15, v14
  v_sin_f32 v36, v14
  s_nop 0
  v_cvt_pk_bf16_f32 v34, v15, v36
  v_mul_f32 v14, v12, v15
  v_mul_f32 v15, v12, v36
  v_cvt_pk_bf16_f32 v42, -v15, v14
  v_fmamk_f32 v14, v11, 0x40400000, v9
  v_cos_f32 v9, v14
  v_sin_f32 v11, v14
  s_nop 0
  v_cvt_pk_bf16_f32 v35, v9, v11
  v_mul_f32 v14, v12, v9
  v_mul_f32 v9, v12, v11
  v_cvt_pk_bf16_f32 v43, -v9, v14
  v_lshlrev_b32 v9, 5, v3
  v_add_u32 v13, 0xffffff10, v9
  v_cndmask_b32 v9, v9, v13, s[40:41]
  v_mov_b32 v11, 0x100
  v_cndmask_b32 v9, v9, v11, s[38:39]
  v_cvt_f32_u32 v12, v9
  v_mul_f32 v12, 0x3b000000, v12
  v_mul_f32 v9, v12, v10
  v_cndmask_b32 v11, 0, 16, s[40:41]
  v_cos_f32 v10, v9
  v_sin_f32 v14, v9
  v_cvt_pk_bf16_f32 v10, v10, 0
  v_cvt_pk_bf16_f32 v14, -v14, 0
  v_lshlrev_b32 v36, v11, v10
  v_lshlrev_b32 v44, v11, v14
  v_fmamk_f32 v10, v12, 0x3f800000, v9
  v_cos_f32 v14, v10
  v_sin_f32 v15, v10
  v_cvt_pk_bf16_f32 v14, v14, 0
  v_cvt_pk_bf16_f32 v15, -v15, 0
  v_lshlrev_b32 v37, v11, v14
  v_lshlrev_b32 v45, v11, v15
  v_fmamk_f32 v10, v12, 0x40000000, v9
  v_cos_f32 v14, v10
  v_sin_f32 v15, v10
  v_cvt_pk_bf16_f32 v14, v14, 0
  v_cvt_pk_bf16_f32 v15, -v15, 0
  v_lshlrev_b32 v38, v11, v14
  v_lshlrev_b32 v46, v11, v15
  v_fmamk_f32 v10, v12, 0x40400000, v9
  v_cos_f32 v9, v10
  v_sin_f32 v12, v10
  v_cvt_pk_bf16_f32 v9, v9, 0
  v_cvt_pk_bf16_f32 v12, -v12, 0
  v_lshlrev_b32 v39, v11, v9
  v_lshlrev_b32 v47, v11, v12
  v_mov_b32 v48, 0x3f803f80
  v_mov_b32 v49, 0x3f803f80
  v_mov_b32 v50, 0x3f803f80
  v_mov_b32 v51, 0x3f803f80
  v_xor_b32 v9, 0, v1
  s_add_u32 s37, s61, 0
  s_add_u32 m0, s63, 0
  s_nop 0
  buffer_load_dwordx4 v9, s[4:7], s37 offen offset:0 lds
  v_xor_b32 v9, 32, v1
  s_add_u32 s37, s61, 0xf800
  buffer_load_dwordx4 v9, s[4:7], s37 offen offset:2048 lds
  v_xor_b32 v9, 64, v1
  s_add_u32 s37, s61, 0x400
  s_add_u32 m0, s63, 0x1000
  s_nop 0
  buffer_load_dwordx4 v9, s[4:7], s37 offen offset:0 lds
  v_xor_b32 v9, 0x60, v1
  s_add_u32 s37, s61, 0xfc00
  buffer_load_dwordx4 v9, s[4:7], s37 offen offset:2048 lds
  v_xor_b32 v9, 0x80, v1
  s_add_u32 s37, s61, 0x1000
  s_add_u32 m0, s63, 0x2000
  s_nop 0
  buffer_load_dwordx4 v9, s[4:7], s37 offen offset:0 lds
  v_xor_b32 v9, 0xa0, v1
  s_add_u32 s37, s61, 0x10800
  buffer_load_dwordx4 v9, s[4:7], s37 offen offset:2048 lds
  v_xor_b32 v9, 0xc0, v1
  s_add_u32 s37, s61, 0x1400
  s_add_u32 m0, s63, 0x3000
  s_nop 0
  buffer_load_dwordx4 v9, s[4:7], s37 offen offset:0 lds
  v_xor_b32 v9, 0xe0, v1
  s_add_u32 s37, s61, 0x10c00
  buffer_load_dwordx4 v9, s[4:7], s37 offen offset:2048 lds
  v_min_u32 v9, 11, v6
  v_lshlrev_b32 v9, 21, v9
  v_min_u32 v10, 1, v6
  s_lshl_b32 s37, s56, 28
  buffer_load_dword v11, v9, s[32:35], s37 offen offset:2048
  v_mul_u32_u24 v9, 0x1ff7fc, v10
  buffer_load_dword v12, v9, s[28:31], s37 offen offset:2048
  v_mul_u32_u24 v9, 0x1bf7fc, v10
  buffer_load_dword v14, v9, s[24:27], s37 offen offset:2048
  v_mul_u32_u24 v9, 0x1007fc, v10
  buffer_load_dword v15, v9, s[8:11], s37 offen offset:2048
  v_mul_u32_u24 v9, 0x1007fc, v10
  buffer_load_dword v10, v9, s[12:15], s37 offen offset:2048
  s_lshr_b32 s37, s2, 5
  s_min_u32 s37, s37, 4
  s_lshl_b32 s37, s37, 17
  s_and_b32 s40, s2, 31
  s_lshl_b32 s40, s40, 7
  s_add_u32 s40, s40, s37
  s_add_u32 s40, s40, 0x20000
  s_lshl_b32 s41, s2, 7
  s_add_u32 s41, s41, 0x10000
  v_mov_b32 v9, s40
  v_writelane_b32 v9, s41, 1
  s_lshl_b32 s37, s56, 28
  buffer_load_dword v52, v9, s[32:35], s37 offen sc1
  v_xor_b32 v9, v8, v3
  v_lshlrev_b32 v9, 4, v9
  v_lshl_add_u32 v9, v3, 10, v9
  v_add_u32 v53, s63, v9
  v_xor_b32 v54, 64, v53
  v_xor_b32 v55, 0x80, v53
  v_xor_b32 v56, 0xc0, v53
  v_lshlrev_b32 v57, 3, v6
  v_add_u32 v57, s63, v57
  v_lshlrev_b32 v58, 7, v6
  s_lshl_b32 s37, s52, 2
  s_add_u32 s37, s37, s56
  s_mul_i32 s37, s37, 0x3800
  s_lshl_b32 s37, s57, 3
  s_lshl_b32 s40, s59, 8
  s_add_u32 s37, s37, s40
  s_lshl_b32 s40, s56, 1
  s_add_u32 s37, s37, s40
  s_mul_i32 s37, s37, 0x202
  s_lshl_b32 s40, s58, 7
  s_add_u32 s41, s37, s40
  v_lshrrev_b32 v58, 5, v6
  v_bfe_u32 v59, v6, 3, 2
  v_lshl_add_u32 v58, v59, 6, v58
  v_mul_u32_u24 v58, 0x202, v58
  v_and_b32 v59, 7, v6
  v_lshl_add_u32 v60, v59, 4, v58
  s_lshl_b32 s37, s56, 10
  s_and_b32 s40, s52, 3
  s_lshr_b32 s42, s52, 2
  s_lshl_b32 s43, s40, 4
  s_lshl_b32 s44, s42, 8
  s_add_u32 s44, s44, s43
  s_mul_i32 s44, s44, 0x202
  s_lshl_b32 s43, s56, 28
  s_add_u32 s44, s44, s43
  v_lshrrev_b32 v58, 2, v6
  v_and_b32 v59, 3, v6
  v_lshl_add_u32 v58, v59, 6, v58
  v_mul_u32_u24 v58, 0x202, v58
  s_lshl_b32 s45, s52, 2
  s_add_u32 s45, s45, s56
  s_mul_i32 s45, s45, 0x2020
  v_lshlrev_b32 v59, 10, v6
  s_lshl_b32 s45, s58, 2
  s_add_u32 s45, s45, s56
  s_mul_i32 s45, s45, 0x1c000
  s_lshl_b32 s60, s64, 7
  s_add_u32 s45, s45, s60
  v_cmp_lt_u32 s[46:47], 1, v8
  v_lshl_add_u32 v61, v8, 7, v3
  v_sub_u32 v13, 0x200, v61
  v_cndmask_b32 v61, v61, v13, s[46:47]
  v_and_b32 v62, 15, v61
  s_lshl_b32 s48, s56, 1
  v_xor_b32 v62, s48, v62
  v_lshlrev_b32 v62, 4, v62
  v_lshl_add_u32 v61, v61, 8, v62
  v_add_u32 v61, 0x10000, v61
  v_mov_b32 v13, 0xffffe000
  v_mov_b32 v62, 0x2000
  v_cndmask_b32 v62, v62, v13, s[46:47]
  v_add_u32 v63, 0x24000, v1
  v_cndmask_b32 v64, v61, v63, s[38:39]
  v_add_u32 v61, v61, v62
  v_cndmask_b32 v65, v61, v63, s[38:39]
  v_add_u32 v61, v61, v62
  v_cndmask_b32 v66, v61, v63, s[38:39]
  v_add_u32 v61, v61, v62
  v_cndmask_b32 v62, v61, v63, s[38:39]
  v_lshlrev_b32 v9, 7, v8
  v_add_u32 v13, 0xffffff10, v9
  v_cndmask_b32 v9, v9, v13, s[46:47]
  v_lshlrev_b32 v9, 8, v9
  v_and_b32 v13, 7, v3
  v_lshl_add_u32 v9, v13, 2, v9
  v_and_b32 v13, 8, v3
  v_lshl_add_u32 v9, v13, 4, v9
  s_lshl_b32 s60, s48, 4
  s_add_u32 s60, s60, 0x10000
  v_add_u32 v3, s60, v9
  s_lshl_b32 s60, s56, 10
  s_add_u32 s60, s60, 0x25000
  v_add_u32 v13, s60, v1
  v_cndmask_b32 v61, v63, v13, s[38:39]
  v_lshrrev_b32 v13, 3, v6
  v_xor_b32 v9, v13, v6
  v_and_b32 v9, 7, v9
  v_lshlrev_b32 v9, 4, v9
  v_lshl_add_u32 v9, v13, 8, v9
  s_add_u32 s60, s63, 0x10000
  v_add_u32 v61, s60, v9
  v_xor_b32 v63, 0x80, v61
  v_mul_u32_u24 v13, 0x2080, v13
  v_and_b32 v9, 7, v6
  v_lshl_add_u32 v67, v9, 4, v13
  s_mul_i32 s38, s56, 0x82000
  s_lshr_b32 s60, s53, 2
  s_lshl_b32 s60, s60, 11
  s_add_u32 s38, s38, s60
  s_and_b32 s60, s53, 3
  s_lshl_b32 s60, s60, 8
  s_add_u32 s38, s38, s60
  s_lshl_b32 s60, s54, 7
  s_add_u32 s38, s38, s60
  s_lshl_b32 s39, s56, 5
  s_add_u32 s39, s39, s52
  s_lshl_b32 s39, s39, 2
  s_add_u32 s39, s39, 0x40000
  s_waitcnt lgkmcnt(0)
  s_add_u32 s46, s36, 0x9e3779b9
  s_mov_b32 s47, s46
  v_mov_b32 v9, s46
  v_min_u32 v13, 1, v6
  v_lshlrev_b32 v13, 30, v13
  s_waitcnt vmcnt(6)
  s_add_u32 m0, s37, 0x20000
  s_nop 0
  buffer_load_dwordx4 v60, s[8:11], s41 offen lds
  s_add_u32 m0, s37, 0x21000
  s_nop 0
  buffer_load_dwordx4 v60, s[12:15], s41 offen lds
  buffer_load_ushort v60, v58, s[8:11], s44 offen offset:512
  buffer_load_ushort v68, v58, s[12:15], s44 offen offset:512
  ds_read_b128 v[72:75], v53 offset:0
  ds_read_b128 v[76:79], v54 offset:0
  ds_read_b128 v[80:83], v55 offset:0
  ds_read_b128 v[84:87], v56 offset:0
  ds_read_b128 v[88:91], v53 offset:256
  ds_read_b128 v[92:95], v54 offset:256
  ds_read_b128 v[96:99], v55 offset:256
  ds_read_b128 v[100:103], v56 offset:256
  ds_read_b128 v[104:107], v53 offset:512
  ds_read_b128 v[108:111], v54 offset:512
  ds_read_b128 v[112:115], v55 offset:512
  ds_read_b128 v[116:119], v56 offset:512
  ds_read_b128 v[120:123], v53 offset:768
  ds_read_b128 v[124:127], v54 offset:768
  ds_read_b128 v[128:131], v55 offset:768
  ds_read_b128 v[132:135], v56 offset:768
  v_and_b32 v53, 3, v6
  v_cmp_eq_u32 s[36:37], 1, v53
  v_cmp_eq_u32 s[48:49], 2, v53
  v_cmp_eq_u32 s[50:51], 3, v53
  v_mov_b32 v139, s46
  v_bfe_u32 v54, v6, 2, 2
  v_and_b32 v55, 2, v54
  v_add_u32 v55, v55, v54
  v_lshl_add_u32 v56, v53, 5, v55
  v_lshlrev_b32 v56, 4, v56
  v_xor_b32 v54, v54, v8
  v_min_u32 v54, 1, v54
  s_waitcnt lgkmcnt(15)
  v_mfma_f32_16x16x32_bf16 v[140:143], v[72:75], v[48:51], 0
  v_lshl_add_u32 v56, v54, 30, v56
  s_lshl_b32 s41, s55, 4
  v_mfma_f32_16x16x32_bf16 v[144:147], v[72:75], v[72:75], 0
  s_add_u32 s41, s41, 0x10000
  s_waitcnt lgkmcnt(14)
  v_mfma_f32_16x16x32_bf16 v[140:143], v[76:79], v[48:51], v[140:143]
  v_mfma_f32_16x16x32_bf16 v[144:147], v[76:79], v[76:79], v[144:147]
  s_waitcnt lgkmcnt(13)
  v_mfma_f32_16x16x32_bf16 v[140:143], v[80:83], v[48:51], v[140:143]
  v_mfma_f32_16x16x32_bf16 v[144:147], v[80:83], v[80:83], v[144:147]
  s_waitcnt lgkmcnt(12)
  v_mfma_f32_16x16x32_bf16 v[140:143], v[84:87], v[48:51], v[140:143]
  v_mfma_f32_16x16x32_bf16 v[144:147], v[84:87], v[84:87], v[144:147]
  v_xor_b32 v58, 0, v57
  s_waitcnt lgkmcnt(11)
  v_mfma_f32_16x16x32_bf16 v[140:143], v[88:91], v[48:51], v[140:143]
  ds_read_b64_tr_b16 v[72:73], v58 offset:0
  v_mfma_f32_16x16x32_bf16 v[144:147], v[88:91], v[88:91], v[144:147]
  ds_read_b64_tr_b16 v[74:75], v58 offset:512
  s_waitcnt lgkmcnt(12)
  v_mfma_f32_16x16x32_bf16 v[140:143], v[92:95], v[48:51], v[140:143]
  v_mfma_f32_16x16x32_bf16 v[144:147], v[92:95], v[92:95], v[144:147]
  s_waitcnt lgkmcnt(11)
  v_mfma_f32_16x16x32_bf16 v[140:143], v[96:99], v[48:51], v[140:143]
  v_mfma_f32_16x16x32_bf16 v[144:147], v[96:99], v[96:99], v[144:147]
  s_waitcnt lgkmcnt(10)
  v_mfma_f32_16x16x32_bf16 v[140:143], v[100:103], v[48:51], v[140:143]
  v_mfma_f32_16x16x32_bf16 v[144:147], v[100:103], v[100:103], v[144:147]
  s_waitcnt lgkmcnt(9)
  v_mfma_f32_16x16x32_bf16 v[140:143], v[104:107], v[48:51], v[140:143]
  v_mfma_f32_16x16x32_bf16 v[144:147], v[104:107], v[104:107], v[144:147]
  s_waitcnt lgkmcnt(8)
  v_mfma_f32_16x16x32_bf16 v[140:143], v[108:111], v[48:51], v[140:143]
  v_mfma_f32_16x16x32_bf16 v[144:147], v[108:111], v[108:111], v[144:147]
  s_waitcnt lgkmcnt(7)
  v_mfma_f32_16x16x32_bf16 v[140:143], v[112:115], v[48:51], v[140:143]
  v_mfma_f32_16x16x32_bf16 v[144:147], v[112:115], v[112:115], v[144:147]
  s_waitcnt lgkmcnt(6)
  v_mfma_f32_16x16x32_bf16 v[140:143], v[116:119], v[48:51], v[140:143]
  v_mfma_f32_16x16x32_bf16 v[144:147], v[116:119], v[116:119], v[144:147]
  s_waitcnt lgkmcnt(5)
  v_mfma_f32_16x16x32_bf16 v[140:143], v[120:123], v[48:51], v[140:143]
  v_mfma_f32_16x16x32_bf16 v[144:147], v[120:123], v[120:123], v[144:147]
  s_waitcnt lgkmcnt(4)
  v_mfma_f32_16x16x32_bf16 v[140:143], v[124:127], v[48:51], v[140:143]
  v_mfma_f32_16x16x32_bf16 v[144:147], v[124:127], v[124:127], v[144:147]
  s_waitcnt lgkmcnt(3)
  v_mfma_f32_16x16x32_bf16 v[140:143], v[128:131], v[48:51], v[140:143]
  v_xor_b32 v58, 16, v57
  v_mfma_f32_16x16x32_bf16 v[144:147], v[128:131], v[128:131], v[144:147]
  ds_read_b64_tr_b16 v[76:77], v58 offset:1024
  ds_read_b64_tr_b16 v[78:79], v58 offset:1536
  s_waitcnt lgkmcnt(4)
  v_mfma_f32_16x16x32_bf16 v[140:143], v[132:135], v[48:51], v[140:143]
  v_mfma_f32_16x16x32_bf16 v[144:147], v[132:135], v[132:135], v[144:147]
  s_waitcnt lgkmcnt(2)
  v_mfma_f32_16x16x32_bf16 v[48:51], v[72:75], v[20:23], 0
  s_nop 4
  v_cndmask_b32 v58, v140, v141, s[36:37]
  v_cndmask_b32 v58, v58, v142, s[48:49]
  v_cndmask_b32 v58, v58, v143, s[50:51]
  v_cndmask_b32 v69, v144, v145, s[36:37]
  v_cndmask_b32 v69, v69, v146, s[48:49]
  v_cndmask_b32 v69, v69, v147, s[50:51]
  v_mul_f32 v70, 0xbb000000, v58
  v_mul_f32 v58, 0x3b000000, v69
  v_fma_f32 v58, -v70, v70, v58
  v_max_f32 v58, 0, v58
  v_add_f32 v58, 0x3727c5ac, v58
  v_rsq_f32 v69, v58
  v_sqrt_f32 v138, v58
  v_mul_f32 v137, 0xbfb8aa3b, v69
  v_cvt_pk_bf16_f32 v58, v70, v70
  v_and_b32 v58, 0xffff0000, v58
  v_sub_f32 v71, v70, v58
  v_cvt_pk_bf16_f32 v136, v58, v71
  buffer_store_dwordx4 v[136:139], v56, s[32:35], s41 offen sc1
  v_readlane_b32 s36, v69, 0
  v_readlane_b32 s37, v69, 1
  v_readlane_b32 s48, v69, 2
  v_readlane_b32 s49, v69, 3
  v_readlane_b32 s50, v69, 20
  v_readlane_b32 s51, v69, 21
  v_readlane_b32 s54, v69, 22
  v_readlane_b32 s55, v69, 23
  v_readlane_b32 s60, v69, 40
  v_readlane_b32 s61, v69, 41
  v_readlane_b32 s68, v69, 42
  v_readlane_b32 s69, v69, 43
  v_readlane_b32 s70, v69, 60
  v_readlane_b32 s71, v69, 61
  v_readlane_b32 s72, v69, 62
  v_readlane_b32 s73, v69, 63
  v_mfma_f32_16x16x32_bf16 v[80:83], v[72:75], v[24:27], 0
  v_xor_b32 v56, 32, v57
  ds_read_b64_tr_b16 v[72:73], v56 offset:2048
  s_waitcnt lgkmcnt(1)
  v_mfma_f32_16x16x32_bf16 v[84:87], v[76:79], v[20:23], 0
  ds_read_b64_tr_b16 v[74:75], v56 offset:2560
  v_xor_b32 v56, 48, v57
  v_mfma_f32_16x16x32_bf16 v[88:91], v[76:79], v[24:27], 0
  ds_read_b64_tr_b16 v[76:77], v56 offset:3072
  v_pk_mul_f32 v[70:71], v[16:17], s[36:37] op_sel_hi:[1,0]
  v_pk_mul_f32 v[92:93], v[28:29], s[36:37] op_sel_hi:[1,0]
  v_pk_mul_f32 v[94:95], v[48:49], v[70:71]
  v_pk_mul_f32 v[96:97], v[80:81], v[70:71]
  v_pk_fma_f32 v[94:95], v[80:81], v[92:93], v[94:95]
  v_pk_fma_f32 v[96:97], v[48:49], v[92:93], v[96:97] neg_lo:[1,0,0] neg_hi:[1,0,0]
  v_cvt_pk_bf16_f32 v100, v94, v96
  v_cvt_pk_bf16_f32 v101, v95, v97
  v_pk_mul_f32 v[70:71], v[18:19], s[36:37] op_sel_hi:[1,0]
  v_pk_mul_f32 v[92:93], v[30:31], s[36:37] op_sel_hi:[1,0]
  v_pk_mul_f32 v[94:95], v[50:51], v[70:71]
  v_pk_mul_f32 v[96:97], v[82:83], v[70:71]
  v_pk_fma_f32 v[94:95], v[82:83], v[92:93], v[94:95]
  v_pk_fma_f32 v[96:97], v[50:51], v[92:93], v[96:97] neg_lo:[1,0,0] neg_hi:[1,0,0]
  v_cvt_pk_bf16_f32 v102, v94, v96
  v_cvt_pk_bf16_f32 v103, v95, v97
  v_mov_b32 v48, v100
  v_mov_b32 v49, v101
  v_mfma_f32_16x16x32_bf16 v[80:83], v[32:35], v[100:103], 0
  v_mov_b32 v50, v102
  v_mov_b32 v51, v103
  v_mfma_f32_16x16x32_bf16 v[92:95], v[40:43], v[100:103], 0
  ds_read_b64_tr_b16 v[78:79], v56 offset:3584
  s_waitcnt lgkmcnt(2)
  v_mfma_f32_16x16x32_bf16 v[96:99], v[72:75], v[20:23], 0
  v_mfma_f32_16x16x32_bf16 v[100:103], v[72:75], v[24:27], 0
  s_nop 3
  v_cvt_pk_bf16_f32 v72, v80, v92
  v_cvt_pk_bf16_f32 v104, v81, v93
  v_cvt_pk_bf16_f32 v108, v82, v94
  v_cvt_pk_bf16_f32 v112, v83, v95
  v_pk_mul_f32 v[70:71], v[16:17], s[36:37] op_sel:[0,1] op_sel_hi:[1,1]
  v_pk_mul_f32 v[80:81], v[28:29], s[36:37] op_sel:[0,1] op_sel_hi:[1,1]
  v_pk_mul_f32 v[82:83], v[84:85], v[70:71]
  v_pk_mul_f32 v[92:93], v[88:89], v[70:71]
  v_pk_fma_f32 v[82:83], v[88:89], v[80:81], v[82:83]
  v_pk_fma_f32 v[92:93], v[84:85], v[80:81], v[92:93] neg_lo:[1,0,0] neg_hi:[1,0,0]
  v_cvt_pk_bf16_f32 v116, v82, v92
  v_cvt_pk_bf16_f32 v117, v83, v93
  v_pk_mul_f32 v[70:71], v[18:19], s[36:37] op_sel:[0,1] op_sel_hi:[1,1]
  v_pk_mul_f32 v[80:81], v[30:31], s[36:37] op_sel:[0,1] op_sel_hi:[1,1]
  v_pk_mul_f32 v[82:83], v[86:87], v[70:71]
  v_pk_mul_f32 v[92:93], v[90:91], v[70:71]
  v_pk_fma_f32 v[82:83], v[90:91], v[80:81], v[82:83]
  v_pk_fma_f32 v[92:93], v[86:87], v[80:81], v[92:93] neg_lo:[1,0,0] neg_hi:[1,0,0]
  v_cvt_pk_bf16_f32 v118, v82, v92
  v_cvt_pk_bf16_f32 v119, v83, v93
  v_mov_b32_dpp v48, v116 row_shr:1 row_mask:0xf bank_mask:0xf
  v_mov_b32_dpp v49, v117 row_shr:1 row_mask:0xf bank_mask:0xf
  v_mfma_f32_16x16x32_bf16 v[80:83], v[32:35], v[116:119], 0
  v_mov_b32_dpp v50, v118 row_shr:1 row_mask:0xf bank_mask:0xf
  v_mov_b32_dpp v51, v119 row_shr:1 row_mask:0xf bank_mask:0xf
  v_mfma_f32_16x16x32_bf16 v[84:87], v[40:43], v[116:119], 0
  v_xor_b32 v56, 64, v57
  ds_read_b64_tr_b16 v[88:89], v56 offset:4096
  s_waitcnt lgkmcnt(1)
  v_mfma_f32_16x16x32_bf16 v[92:95], v[76:79], v[20:23], 0
  ds_read_b64_tr_b16 v[90:91], v56 offset:4608
  v_mfma_f32_16x16x32_bf16 v[116:119], v[76:79], v[24:27], 0
  s_nop 1
  v_cvt_pk_bf16_f32 v73, v80, v84
  v_cvt_pk_bf16_f32 v105, v81, v85
  v_cvt_pk_bf16_f32 v109, v82, v86
  v_cvt_pk_bf16_f32 v113, v83, v87
  v_pk_mul_f32 v[70:71], v[16:17], s[48:49] op_sel_hi:[1,0]
  v_pk_mul_f32 v[76:77], v[28:29], s[48:49] op_sel_hi:[1,0]
  v_pk_mul_f32 v[78:79], v[96:97], v[70:71]
  v_pk_mul_f32 v[80:81], v[100:101], v[70:71]
  v_pk_fma_f32 v[78:79], v[100:101], v[76:77], v[78:79]
  v_pk_fma_f32 v[80:81], v[96:97], v[76:77], v[80:81] neg_lo:[1,0,0] neg_hi:[1,0,0]
  v_cvt_pk_bf16_f32 v84, v78, v80
  v_cvt_pk_bf16_f32 v85, v79, v81
  v_pk_mul_f32 v[70:71], v[18:19], s[48:49] op_sel_hi:[1,0]
  v_pk_mul_f32 v[76:77], v[30:31], s[48:49] op_sel_hi:[1,0]
  v_pk_mul_f32 v[78:79], v[98:99], v[70:71]
  v_pk_mul_f32 v[80:81], v[102:103], v[70:71]
  v_pk_fma_f32 v[78:79], v[102:103], v[76:77], v[78:79]
  v_pk_fma_f32 v[80:81], v[98:99], v[76:77], v[80:81] neg_lo:[1,0,0] neg_hi:[1,0,0]
  v_cvt_pk_bf16_f32 v86, v78, v80
  v_cvt_pk_bf16_f32 v87, v79, v81
  v_mov_b32_dpp v48, v84 row_shr:2 row_mask:0xf bank_mask:0xf
  v_mov_b32_dpp v49, v85 row_shr:2 row_mask:0xf bank_mask:0xf
  v_mfma_f32_16x16x32_bf16 v[76:79], v[32:35], v[84:87], 0
  v_mov_b32_dpp v50, v86 row_shr:2 row_mask:0xf bank_mask:0xf
  v_mov_b32_dpp v51, v87 row_shr:2 row_mask:0xf bank_mask:0xf
  v_mfma_f32_16x16x32_bf16 v[80:83], v[40:43], v[84:87], 0
  v_xor_b32 v56, 0x50, v57
  ds_read_b64_tr_b16 v[84:85], v56 offset:5120
  s_waitcnt lgkmcnt(1)
  v_mfma_f32_16x16x32_bf16 v[96:99], v[88:91], v[20:23], 0
  ds_read_b64_tr_b16 v[86:87], v56 offset:5632
  v_mfma_f32_16x16x32_bf16 v[100:103], v[88:91], v[24:27], 0
  s_nop 1
  v_cvt_pk_bf16_f32 v74, v76, v80
  v_cvt_pk_bf16_f32 v106, v77, v81
  v_cvt_pk_bf16_f32 v110, v78, v82
  v_cvt_pk_bf16_f32 v114, v79, v83
  v_pk_mul_f32 v[70:71], v[16:17], s[48:49] op_sel:[0,1] op_sel_hi:[1,1]
  v_pk_mul_f32 v[76:77], v[28:29], s[48:49] op_sel:[0,1] op_sel_hi:[1,1]
  v_pk_mul_f32 v[78:79], v[92:93], v[70:71]
  v_pk_mul_f32 v[80:81], v[116:117], v[70:71]
  v_pk_fma_f32 v[78:79], v[116:117], v[76:77], v[78:79]
  v_pk_fma_f32 v[80:81], v[92:93], v[76:77], v[80:81] neg_lo:[1,0,0] neg_hi:[1,0,0]
  v_cvt_pk_bf16_f32 v88, v78, v80
  v_cvt_pk_bf16_f32 v89, v79, v81
  v_pk_mul_f32 v[70:71], v[18:19], s[48:49] op_sel:[0,1] op_sel_hi:[1,1]
  v_pk_mul_f32 v[76:77], v[30:31], s[48:49] op_sel:[0,1] op_sel_hi:[1,1]
  v_pk_mul_f32 v[78:79], v[94:95], v[70:71]
  v_pk_mul_f32 v[80:81], v[118:119], v[70:71]
  v_pk_fma_f32 v[78:79], v[118:119], v[76:77], v[78:79]
  v_pk_fma_f32 v[80:81], v[94:95], v[76:77], v[80:81] neg_lo:[1,0,0] neg_hi:[1,0,0]
  v_cvt_pk_bf16_f32 v90, v78, v80
  v_cvt_pk_bf16_f32 v91, v79, v81
  v_mov_b32_dpp v48, v88 row_shr:3 row_mask:0xf bank_mask:0xf
  v_mov_b32_dpp v49, v89 row_shr:3 row_mask:0xf bank_mask:0xf
  v_mfma_f32_16x16x32_bf16 v[76:79], v[32:35], v[88:91], 0
  v_mov_b32_dpp v50, v90 row_shr:3 row_mask:0xf bank_mask:0xf
  v_mov_b32_dpp v51, v91 row_shr:3 row_mask:0xf bank_mask:0xf
  v_mfma_f32_16x16x32_bf16 v[80:83], v[40:43], v[88:91], 0
  v_xor_b32 v56, 0x60, v57
  ds_read_b64_tr_b16 v[88:89], v56 offset:6144
  s_waitcnt lgkmcnt(1)
  v_mfma_f32_16x16x32_bf16 v[92:95], v[84:87], v[20:23], 0
  ds_read_b64_tr_b16 v[90:91], v56 offset:6656
  v_mfma_f32_16x16x32_bf16 v[116:119], v[84:87], v[24:27], 0
  s_nop 1
  v_cvt_pk_bf16_f32 v75, v76, v80
  v_cvt_pk_bf16_f32 v107, v77, v81
  v_cvt_pk_bf16_f32 v111, v78, v82
  v_cvt_pk_bf16_f32 v115, v79, v83
  ds_write_b128 v64, v[72:75]
  ds_write_b128 v65, v[104:107]
  ds_write_b128 v66, v[108:111]
  ds_write_b128 v62, v[112:115]
  v_pk_mul_f32 v[70:71], v[16:17], s[50:51] op_sel_hi:[1,0]
  v_pk_mul_f32 v[72:73], v[28:29], s[50:51] op_sel_hi:[1,0]
  v_pk_mul_f32 v[74:75], v[96:97], v[70:71]
  v_pk_mul_f32 v[76:77], v[100:101], v[70:71]
  v_pk_fma_f32 v[74:75], v[100:101], v[72:73], v[74:75]
  v_pk_fma_f32 v[76:77], v[96:97], v[72:73], v[76:77] neg_lo:[1,0,0] neg_hi:[1,0,0]
  v_cvt_pk_bf16_f32 v80, v74, v76
  v_cvt_pk_bf16_f32 v81, v75, v77
  v_pk_mul_f32 v[70:71], v[18:19], s[50:51] op_sel_hi:[1,0]
  v_pk_mul_f32 v[72:73], v[30:31], s[50:51] op_sel_hi:[1,0]
  v_pk_mul_f32 v[74:75], v[98:99], v[70:71]
  v_pk_mul_f32 v[76:77], v[102:103], v[70:71]
  v_pk_fma_f32 v[74:75], v[102:103], v[72:73], v[74:75]
  v_pk_fma_f32 v[76:77], v[98:99], v[72:73], v[76:77] neg_lo:[1,0,0] neg_hi:[1,0,0]
  v_cvt_pk_bf16_f32 v82, v74, v76
  v_cvt_pk_bf16_f32 v83, v75, v77
  v_mov_b32_dpp v48, v80 row_shr:4 row_mask:0xf bank_mask:0xf
  v_mov_b32_dpp v49, v81 row_shr:4 row_mask:0xf bank_mask:0xf
  v_mfma_f32_16x16x32_bf16 v[72:75], v[32:35], v[80:83], 0
  v_mov_b32_dpp v50, v82 row_shr:4 row_mask:0xf bank_mask:0xf
  v_mov_b32_dpp v51, v83 row_shr:4 row_mask:0xf bank_mask:0xf
  v_mfma_f32_16x16x32_bf16 v[76:79], v[40:43], v[80:83], 0
  v_xor_b32 v56, 0x70, v57
  ds_read_b64_tr_b16 v[80:81], v56 offset:7168
  s_waitcnt lgkmcnt(5)
  v_mfma_f32_16x16x32_bf16 v[84:87], v[88:91], v[20:23], 0
  ds_read_b64_tr_b16 v[82:83], v56 offset:7680
  v_mfma_f32_16x16x32_bf16 v[96:99], v[88:91], v[24:27], 0
  s_nop 1
  v_cvt_pk_bf16_f32 v88, v72, v76
  v_cvt_pk_bf16_f32 v100, v73, v77
  v_cvt_pk_bf16_f32 v104, v74, v78
  v_cvt_pk_bf16_f32 v108, v75, v79
  v_xor_b32 v56, 16, v64
  v_pk_mul_f32 v[70:71], v[16:17], s[50:51] op_sel:[0,1] op_sel_hi:[1,1]
  v_pk_mul_f32 v[72:73], v[28:29], s[50:51] op_sel:[0,1] op_sel_hi:[1,1]
  v_pk_mul_f32 v[74:75], v[92:93], v[70:71]
  v_pk_mul_f32 v[76:77], v[116:117], v[70:71]
  v_pk_fma_f32 v[74:75], v[116:117], v[72:73], v[74:75]
  v_pk_fma_f32 v[76:77], v[92:93], v[72:73], v[76:77] neg_lo:[1,0,0] neg_hi:[1,0,0]
  v_cvt_pk_bf16_f32 v112, v74, v76
  v_cvt_pk_bf16_f32 v113, v75, v77
  v_pk_mul_f32 v[70:71], v[18:19], s[50:51] op_sel:[0,1] op_sel_hi:[1,1]
  v_pk_mul_f32 v[72:73], v[30:31], s[50:51] op_sel:[0,1] op_sel_hi:[1,1]
  v_pk_mul_f32 v[74:75], v[94:95], v[70:71]
  v_pk_mul_f32 v[76:77], v[118:119], v[70:71]
  v_pk_fma_f32 v[74:75], v[118:119], v[72:73], v[74:75]
  v_pk_fma_f32 v[76:77], v[94:95], v[72:73], v[76:77] neg_lo:[1,0,0] neg_hi:[1,0,0]
  v_cvt_pk_bf16_f32 v114, v74, v76
  v_cvt_pk_bf16_f32 v115, v75, v77
  v_mov_b32_dpp v48, v112 row_shr:5 row_mask:0xf bank_mask:0xf
  v_mov_b32_dpp v49, v113 row_shr:5 row_mask:0xf bank_mask:0xf
  v_mfma_f32_16x16x32_bf16 v[72:75], v[32:35], v[112:115], 0
  v_mov_b32_dpp v50, v114 row_shr:5 row_mask:0xf bank_mask:0xf
  v_mov_b32_dpp v51, v115 row_shr:5 row_mask:0xf bank_mask:0xf
  v_mfma_f32_16x16x32_bf16 v[76:79], v[40:43], v[112:115], 0
  v_xor_b32 v58, 16, v65
  v_xor_b32 v69, 16, v66
  s_waitcnt lgkmcnt(0)
  v_mfma_f32_16x16x32_bf16 v[92:95], v[80:83], v[20:23], 0
  v_xor_b32 v70, 16, v62
  v_xor_b32 v71, 0x80, v57
  v_mfma_f32_16x16x32_bf16 v[112:115], v[80:83], v[24:27], 0
  s_nop 0
  v_cvt_pk_bf16_f32 v89, v72, v76
  v_cvt_pk_bf16_f32 v101, v73, v77
  v_cvt_pk_bf16_f32 v105, v74, v78
  v_cvt_pk_bf16_f32 v109, v75, v79
  s_add_u32 s36, s38, 0x400000
  v_pk_mul_f32 v[72:73], v[16:17], s[54:55] op_sel_hi:[1,0]
  v_pk_mul_f32 v[74:75], v[28:29], s[54:55] op_sel_hi:[1,0]
  v_pk_mul_f32 v[76:77], v[84:85], v[72:73]
  v_pk_mul_f32 v[78:79], v[96:97], v[72:73]
  v_pk_fma_f32 v[76:77], v[96:97], v[74:75], v[76:77]
  v_pk_fma_f32 v[78:79], v[84:85], v[74:75], v[78:79] neg_lo:[1,0,0] neg_hi:[1,0,0]
  v_cvt_pk_bf16_f32 v72, v76, v78
  v_cvt_pk_bf16_f32 v73, v77, v79
  v_pk_mul_f32 v[76:77], v[18:19], s[54:55] op_sel_hi:[1,0]
  v_pk_mul_f32 v[78:79], v[30:31], s[54:55] op_sel_hi:[1,0]
  v_pk_mul_f32 v[80:81], v[86:87], v[76:77]
  v_pk_mul_f32 v[82:83], v[98:99], v[76:77]
  v_pk_fma_f32 v[80:81], v[98:99], v[78:79], v[80:81]
  v_pk_fma_f32 v[82:83], v[86:87], v[78:79], v[82:83] neg_lo:[1,0,0] neg_hi:[1,0,0]
  v_cvt_pk_bf16_f32 v74, v80, v82
  v_cvt_pk_bf16_f32 v75, v81, v83
  v_mov_b32_dpp v48, v72 row_shr:6 row_mask:0xf bank_mask:0xf
  v_mov_b32_dpp v49, v73 row_shr:6 row_mask:0xf bank_mask:0xf
  v_mfma_f32_16x16x32_bf16 v[76:79], v[32:35], v[72:75], 0
  v_mov_b32_dpp v50, v74 row_shr:6 row_mask:0xf bank_mask:0xf
  v_mov_b32_dpp v51, v75 row_shr:6 row_mask:0xf bank_mask:0xf
  v_mfma_f32_16x16x32_bf16 v[80:83], v[40:43], v[72:75], 0
  v_xor_b32 v72, 0x90, v57
  v_pk_mul_f32 v[74:75], v[16:17], s[54:55] op_sel:[0,1] op_sel_hi:[1,1]
  v_pk_mul_f32 v[84:85], v[28:29], s[54:55] op_sel:[0,1] op_sel_hi:[1,1]
  v_pk_mul_f32 v[86:87], v[92:93], v[74:75]
  s_nop 3
  v_cvt_pk_bf16_f32 v90, v76, v80
  v_cvt_pk_bf16_f32 v102, v77, v81
  v_cvt_pk_bf16_f32 v106, v78, v82
  v_cvt_pk_bf16_f32 v110, v79, v83
  v_pk_mul_f32 v[76:77], v[112:113], v[74:75]
  v_pk_fma_f32 v[86:87], v[112:113], v[84:85], v[86:87]
  v_pk_fma_f32 v[76:77], v[92:93], v[84:85], v[76:77] neg_lo:[1,0,0] neg_hi:[1,0,0]
  v_cvt_pk_bf16_f32 v80, v86, v76
  v_cvt_pk_bf16_f32 v81, v87, v77
  v_pk_mul_f32 v[74:75], v[18:19], s[54:55] op_sel:[0,1] op_sel_hi:[1,1]
  v_pk_mul_f32 v[76:77], v[30:31], s[54:55] op_sel:[0,1] op_sel_hi:[1,1]
  v_pk_mul_f32 v[78:79], v[94:95], v[74:75]
  v_pk_mul_f32 v[84:85], v[114:115], v[74:75]
  v_pk_fma_f32 v[78:79], v[114:115], v[76:77], v[78:79]
  v_pk_fma_f32 v[84:85], v[94:95], v[76:77], v[84:85] neg_lo:[1,0,0] neg_hi:[1,0,0]
  v_cvt_pk_bf16_f32 v82, v78, v84
  v_cvt_pk_bf16_f32 v83, v79, v85
  v_mov_b32_dpp v48, v80 row_shr:7 row_mask:0xf bank_mask:0xf
  v_mov_b32_dpp v49, v81 row_shr:7 row_mask:0xf bank_mask:0xf
  v_mfma_f32_16x16x32_bf16 v[76:79], v[32:35], v[80:83], 0
  v_mov_b32_dpp v50, v82 row_shr:7 row_mask:0xf bank_mask:0xf
  v_mov_b32_dpp v51, v83 row_shr:7 row_mask:0xf bank_mask:0xf
  v_mfma_f32_16x16x32_bf16 v[84:87], v[40:43], v[80:83], 0
  s_add_u32 s37, s38, 0x410400
  v_mfma_f32_16x16x32_bf16 v[80:83], v[36:39], v[48:51], 0
  v_mfma_f32_16x16x32_bf16 v[92:95], v[44:47], v[48:51], 0
  s_nop 4
  v_cvt_pk_bf16_f32 v91, v76, v84
  v_cvt_pk_bf16_f32 v103, v77, v85
  v_cvt_pk_bf16_f32 v107, v78, v86
  v_cvt_pk_bf16_f32 v111, v79, v87
  ds_write_b128 v56, v[88:91]
  ds_write_b128 v58, v[100:103]
  ds_write_b128 v69, v[104:107]
  ds_write_b128 v70, v[108:111]
  v_cvt_pk_bf16_f32 v56, v80, v92
  ds_write_b32 v3, v56 offset:0
  v_cvt_pk_bf16_f32 v56, v81, v93
  ds_write_b32 v3, v56 offset:8192
  v_cvt_pk_bf16_f32 v56, v82, v94
  ds_write_b32 v3, v56 offset:16384
  v_cvt_pk_bf16_f32 v56, v83, v95
  ds_write_b32 v3, v56 offset:24576
  v_pk_mul_f32 v[74:75], v[16:17], s[60:61] op_sel_hi:[1,0]
  v_pk_mul_f32 v[76:77], v[28:29], s[60:61] op_sel_hi:[1,0]
  v_pk_mul_f32 v[78:79], v[18:19], s[60:61] op_sel_hi:[1,0]
  v_pk_mul_f32 v[80:81], v[30:31], s[60:61] op_sel_hi:[1,0]
  v_pk_mul_f32 v[82:83], v[16:17], s[60:61] op_sel:[0,1] op_sel_hi:[1,1]
  v_pk_mul_f32 v[84:85], v[28:29], s[60:61] op_sel:[0,1] op_sel_hi:[1,1]
  v_pk_mul_f32 v[86:87], v[18:19], s[60:61] op_sel:[0,1] op_sel_hi:[1,1]
  v_pk_mul_f32 v[88:89], v[30:31], s[60:61] op_sel:[0,1] op_sel_hi:[1,1]
  v_xor_b32 v56, 0xa0, v57
  v_pk_mul_f32 v[90:91], v[16:17], s[68:69] op_sel_hi:[1,0]
  v_pk_mul_f32 v[92:93], v[28:29], s[68:69] op_sel_hi:[1,0]
  s_add_u32 s41, s38, 0x420800
  v_pk_mul_f32 v[94:95], v[18:19], s[68:69] op_sel_hi:[1,0]
  v_pk_mul_f32 v[96:97], v[30:31], s[68:69] op_sel_hi:[1,0]
  s_waitcnt lgkmcnt(0)
  s_barrier
  ds_read_b64_tr_b16 v[100:101], v71 offset:8192
  ds_read_b64_tr_b16 v[102:103], v71 offset:8704
  ds_read_b128 v[104:107], v61 offset:0
  ds_read_b64_tr_b16 v[108:109], v72 offset:9216
  ds_read_b64_tr_b16 v[110:111], v72 offset:9728
  ds_read_b128 v[112:115], v63 offset:2048
  ds_read_b64_tr_b16 v[116:117], v56 offset:10240
  ds_read_b64_tr_b16 v[118:119], v56 offset:10752
  ds_read_b128 v[120:123], v61 offset:4096
  s_waitcnt lgkmcnt(7)
  v_mfma_f32_16x16x32_bf16 v[124:127], v[100:103], v[20:23], 0
  s_waitcnt lgkmcnt(6)
  buffer_store_dwordx4 v[104:107], v67, s[32:35], s36 offen sc1
  s_nop 1
  v_mfma_f32_16x16x32_bf16 v[104:107], v[100:103], v[24:27], 0
  s_waitcnt lgkmcnt(3)
  buffer_store_dwordx4 v[112:115], v67, s[32:35], s37 offen sc1
  s_waitcnt lgkmcnt(0)
  buffer_store_dwordx4 v[120:123], v67, s[32:35], s41 offen sc1
  v_mfma_f32_16x16x32_bf16 v[100:103], v[108:111], v[20:23], 0
  v_mfma_f32_16x16x32_bf16 v[112:115], v[108:111], v[24:27], 0
  v_mfma_f32_16x16x32_bf16 v[108:111], v[116:119], v[20:23], 0
  v_mfma_f32_16x16x32_bf16 v[120:123], v[116:119], v[24:27], 0
  v_pk_mul_f32 v[70:71], v[124:125], v[74:75]
  v_pk_mul_f32 v[72:73], v[104:105], v[74:75]
  v_pk_fma_f32 v[70:71], v[104:105], v[76:77], v[70:71]
  v_pk_fma_f32 v[72:73], v[124:125], v[76:77], v[72:73] neg_lo:[1,0,0] neg_hi:[1,0,0]
  v_cvt_pk_bf16_f32 v116, v70, v72
  v_cvt_pk_bf16_f32 v117, v71, v73
  v_pk_mul_f32 v[70:71], v[126:127], v[78:79]
  v_pk_mul_f32 v[72:73], v[106:107], v[78:79]
  v_pk_fma_f32 v[70:71], v[106:107], v[80:81], v[70:71]
  v_pk_fma_f32 v[72:73], v[126:127], v[80:81], v[72:73] neg_lo:[1,0,0] neg_hi:[1,0,0]
  v_cvt_pk_bf16_f32 v118, v70, v72
  v_cvt_pk_bf16_f32 v119, v71, v73
  v_mov_b32_dpp v48, v116 row_shr:8 row_mask:0xf bank_mask:0xf
  v_mov_b32_dpp v49, v117 row_shr:8 row_mask:0xf bank_mask:0xf
  v_mfma_f32_16x16x32_bf16 v[72:75], v[32:35], v[116:119], 0
  v_mov_b32_dpp v50, v118 row_shr:8 row_mask:0xf bank_mask:0xf
  v_mov_b32_dpp v51, v119 row_shr:8 row_mask:0xf bank_mask:0xf
  v_mfma_f32_16x16x32_bf16 v[76:79], v[40:43], v[116:119], 0
  v_xor_b32 v56, 0xb0, v57
  ds_read_b64_tr_b16 v[104:105], v56 offset:11264
  ds_read_b64_tr_b16 v[106:107], v56 offset:11776
  ds_read_b128 v[116:119], v63 offset:6144
  s_add_u32 s36, s38, 0x430c00
  v_pk_mul_f32 v[70:71], v[100:101], v[82:83]
  v_pk_mul_f32 v[80:81], v[112:113], v[82:83]
  s_nop 0
  v_cvt_pk_bf16_f32 v124, v72, v76
  v_cvt_pk_bf16_f32 v128, v73, v77
  v_cvt_pk_bf16_f32 v132, v74, v78
  v_cvt_pk_bf16_f32 v136, v75, v79
  v_pk_fma_f32 v[70:71], v[112:113], v[84:85], v[70:71]
  v_pk_fma_f32 v[80:81], v[100:101], v[84:85], v[80:81] neg_lo:[1,0,0] neg_hi:[1,0,0]
  v_cvt_pk_bf16_f32 v72, v70, v80
  v_cvt_pk_bf16_f32 v73, v71, v81
  v_pk_mul_f32 v[70:71], v[102:103], v[86:87]
  v_pk_mul_f32 v[76:77], v[114:115], v[86:87]
  v_pk_fma_f32 v[70:71], v[114:115], v[88:89], v[70:71]
  v_pk_fma_f32 v[76:77], v[102:103], v[88:89], v[76:77] neg_lo:[1,0,0] neg_hi:[1,0,0]
  v_cvt_pk_bf16_f32 v74, v70, v76
  v_cvt_pk_bf16_f32 v75, v71, v77
  v_mov_b32_dpp v48, v72 row_shr:9 row_mask:0xf bank_mask:0xf
  v_mov_b32_dpp v49, v73 row_shr:9 row_mask:0xf bank_mask:0xf
  v_mfma_f32_16x16x32_bf16 v[76:79], v[32:35], v[72:75], 0
  v_mov_b32_dpp v50, v74 row_shr:9 row_mask:0xf bank_mask:0xf
  v_mov_b32_dpp v51, v75 row_shr:9 row_mask:0xf bank_mask:0xf
  v_mfma_f32_16x16x32_bf16 v[80:83], v[40:43], v[72:75], 0
  v_xor_b32 v56, 0x80, v64
  v_xor_b32 v58, 0x80, v65
  s_waitcnt lgkmcnt(1)
  v_mfma_f32_16x16x32_bf16 v[72:75], v[104:107], v[20:23], 0
  s_waitcnt lgkmcnt(0)
  buffer_store_dwordx4 v[116:119], v67, s[32:35], s36 offen sc1
  v_xor_b32 v69, 0x80, v66
  v_mfma_f32_16x16x32_bf16 v[84:87], v[104:107], v[24:27], 0
  v_cvt_pk_bf16_f32 v125, v76, v80
  v_cvt_pk_bf16_f32 v129, v77, v81
  v_cvt_pk_bf16_f32 v133, v78, v82
  v_cvt_pk_bf16_f32 v137, v79, v83
  v_xor_b32 v70, 0x80, v62
  v_pk_mul_f32 v[76:77], v[108:109], v[90:91]
  v_pk_mul_f32 v[78:79], v[120:121], v[90:91]
  v_pk_fma_f32 v[76:77], v[120:121], v[92:93], v[76:77]
  v_pk_fma_f32 v[78:79], v[108:109], v[92:93], v[78:79] neg_lo:[1,0,0] neg_hi:[1,0,0]
  v_cvt_pk_bf16_f32 v80, v76, v78
  v_cvt_pk_bf16_f32 v81, v77, v79
  v_pk_mul_f32 v[76:77], v[110:111], v[94:95]
  v_pk_mul_f32 v[78:79], v[122:123], v[94:95]
  v_pk_fma_f32 v[76:77], v[122:123], v[96:97], v[76:77]
  v_pk_fma_f32 v[78:79], v[110:111], v[96:97], v[78:79] neg_lo:[1,0,0] neg_hi:[1,0,0]
  v_cvt_pk_bf16_f32 v82, v76, v78
  v_cvt_pk_bf16_f32 v83, v77, v79
  v_mov_b32_dpp v48, v80 row_shr:10 row_mask:0xf bank_mask:0xf
  v_mov_b32_dpp v49, v81 row_shr:10 row_mask:0xf bank_mask:0xf
  v_mfma_f32_16x16x32_bf16 v[76:79], v[32:35], v[80:83], 0
  v_mov_b32_dpp v50, v82 row_shr:10 row_mask:0xf bank_mask:0xf
  v_mov_b32_dpp v51, v83 row_shr:10 row_mask:0xf bank_mask:0xf
  v_mfma_f32_16x16x32_bf16 v[88:91], v[40:43], v[80:83], 0
  v_xor_b32 v71, 0xc0, v57
  ds_read_b64_tr_b16 v[80:81], v71 offset:12288
  ds_read_b64_tr_b16 v[82:83], v71 offset:12800
  ds_read_b128 v[92:95], v61 offset:8192
  s_add_u32 s36, s38, 0x441000
  v_pk_mul_f32 v[96:97], v[16:17], s[68:69] op_sel:[0,1] op_sel_hi:[1,1]
  v_pk_mul_f32 v[98:99], v[28:29], s[68:69] op_sel:[0,1] op_sel_hi:[1,1]
  s_nop 0
  v_cvt_pk_bf16_f32 v126, v76, v88
  v_cvt_pk_bf16_f32 v130, v77, v89
  v_cvt_pk_bf16_f32 v134, v78, v90
  v_cvt_pk_bf16_f32 v138, v79, v91
  v_pk_mul_f32 v[76:77], v[72:73], v[96:97]
  v_pk_mul_f32 v[78:79], v[84:85], v[96:97]
  v_pk_fma_f32 v[76:77], v[84:85], v[98:99], v[76:77]
  v_pk_fma_f32 v[78:79], v[72:73], v[98:99], v[78:79] neg_lo:[1,0,0] neg_hi:[1,0,0]
  v_cvt_pk_bf16_f32 v88, v76, v78
  v_cvt_pk_bf16_f32 v89, v77, v79
  v_pk_mul_f32 v[76:77], v[18:19], s[68:69] op_sel:[0,1] op_sel_hi:[1,1]
  v_pk_mul_f32 v[78:79], v[30:31], s[68:69] op_sel:[0,1] op_sel_hi:[1,1]
  v_pk_mul_f32 v[96:97], v[74:75], v[76:77]
  v_pk_mul_f32 v[98:99], v[86:87], v[76:77]
  v_pk_fma_f32 v[96:97], v[86:87], v[78:79], v[96:97]
  v_pk_fma_f32 v[98:99], v[74:75], v[78:79], v[98:99] neg_lo:[1,0,0] neg_hi:[1,0,0]
  v_cvt_pk_bf16_f32 v90, v96, v98
  v_cvt_pk_bf16_f32 v91, v97, v99
  v_mov_b32_dpp v48, v88 row_shr:11 row_mask:0xf bank_mask:0xf
  v_mov_b32_dpp v49, v89 row_shr:11 row_mask:0xf bank_mask:0xf
  v_mfma_f32_16x16x32_bf16 v[72:75], v[32:35], v[88:91], 0
  v_mov_b32_dpp v50, v90 row_shr:11 row_mask:0xf bank_mask:0xf
  v_mov_b32_dpp v51, v91 row_shr:11 row_mask:0xf bank_mask:0xf
  v_mfma_f32_16x16x32_bf16 v[76:79], v[40:43], v[88:91], 0
  s_waitcnt lgkmcnt(0)
  buffer_store_dwordx4 v[92:95], v67, s[32:35], s36 offen sc1
  v_xor_b32 v71, 0xd0, v57
  v_mfma_f32_16x16x32_bf16 v[84:87], v[80:83], v[20:23], 0
  ds_read_b64_tr_b16 v[88:89], v71 offset:13312
  ds_read_b64_tr_b16 v[90:91], v71 offset:13824
  v_mfma_f32_16x16x32_bf16 v[92:95], v[80:83], v[24:27], 0
  s_nop 0
  v_cvt_pk_bf16_f32 v127, v72, v76
  v_cvt_pk_bf16_f32 v131, v73, v77
  v_cvt_pk_bf16_f32 v135, v74, v78
  v_cvt_pk_bf16_f32 v139, v75, v79
  ds_write_b128 v56, v[124:127]
  ds_write_b128 v58, v[128:131]
  ds_write_b128 v69, v[132:135]
  ds_write_b128 v70, v[136:139]
  v_pk_mul_f32 v[70:71], v[16:17], s[70:71] op_sel_hi:[1,0]
  v_pk_mul_f32 v[72:73], v[28:29], s[70:71] op_sel_hi:[1,0]
  v_pk_mul_f32 v[74:75], v[84:85], v[70:71]
  v_pk_mul_f32 v[76:77], v[92:93], v[70:71]
  v_pk_fma_f32 v[74:75], v[92:93], v[72:73], v[74:75]
  v_pk_fma_f32 v[76:77], v[84:85], v[72:73], v[76:77] neg_lo:[1,0,0] neg_hi:[1,0,0]
  v_cvt_pk_bf16_f32 v80, v74, v76
  v_cvt_pk_bf16_f32 v81, v75, v77
  v_pk_mul_f32 v[70:71], v[18:19], s[70:71] op_sel_hi:[1,0]
  v_pk_mul_f32 v[72:73], v[30:31], s[70:71] op_sel_hi:[1,0]
  v_pk_mul_f32 v[74:75], v[86:87], v[70:71]
  v_pk_mul_f32 v[76:77], v[94:95], v[70:71]
  v_pk_fma_f32 v[74:75], v[94:95], v[72:73], v[74:75]
  v_pk_fma_f32 v[76:77], v[86:87], v[72:73], v[76:77] neg_lo:[1,0,0] neg_hi:[1,0,0]
  v_cvt_pk_bf16_f32 v82, v74, v76
  v_cvt_pk_bf16_f32 v83, v75, v77
  v_mov_b32_dpp v48, v80 row_shr:12 row_mask:0xf bank_mask:0xf
  v_mov_b32_dpp v49, v81 row_shr:12 row_mask:0xf bank_mask:0xf
  v_mfma_f32_16x16x32_bf16 v[72:75], v[32:35], v[80:83], 0
  v_mov_b32_dpp v50, v82 row_shr:12 row_mask:0xf bank_mask:0xf
  v_mov_b32_dpp v51, v83 row_shr:12 row_mask:0xf bank_mask:0xf
  v_mfma_f32_16x16x32_bf16 v[76:79], v[40:43], v[80:83], 0
  ds_read_b128 v[80:83], v63 offset:10240
  s_add_u32 s36, s38, 0x451400
  s_waitcnt lgkmcnt(5)
  v_mfma_f32_16x16x32_bf16 v[84:87], v[88:91], v[20:23], 0
  v_xor_b32 v56, 0xe0, v57
  ds_read_b64_tr_b16 v[92:93], v56 offset:14336
  v_mfma_f32_16x16x32_bf16 v[96:99], v[88:91], v[24:27], 0
  s_nop 0
  v_cvt_pk_bf16_f32 v88, v72, v76
  v_cvt_pk_bf16_f32 v100, v73, v77
  v_cvt_pk_bf16_f32 v104, v74, v78
  v_cvt_pk_bf16_f32 v108, v75, v79
  ds_read_b64_tr_b16 v[94:95], v56 offset:14848
  v_pk_mul_f32 v[70:71], v[16:17], s[70:71] op_sel:[0,1] op_sel_hi:[1,1]
  v_pk_mul_f32 v[72:73], v[28:29], s[70:71] op_sel:[0,1] op_sel_hi:[1,1]
  v_pk_mul_f32 v[74:75], v[84:85], v[70:71]
  v_pk_mul_f32 v[76:77], v[96:97], v[70:71]
  v_pk_fma_f32 v[74:75], v[96:97], v[72:73], v[74:75]
  v_pk_fma_f32 v[76:77], v[84:85], v[72:73], v[76:77] neg_lo:[1,0,0] neg_hi:[1,0,0]
  v_cvt_pk_bf16_f32 v112, v74, v76
  v_cvt_pk_bf16_f32 v113, v75, v77
  v_pk_mul_f32 v[70:71], v[18:19], s[70:71] op_sel:[0,1] op_sel_hi:[1,1]
  v_pk_mul_f32 v[72:73], v[30:31], s[70:71] op_sel:[0,1] op_sel_hi:[1,1]
  v_pk_mul_f32 v[74:75], v[86:87], v[70:71]
  v_pk_mul_f32 v[76:77], v[98:99], v[70:71]
  v_pk_fma_f32 v[74:75], v[98:99], v[72:73], v[74:75]
  v_pk_fma_f32 v[76:77], v[86:87], v[72:73], v[76:77] neg_lo:[1,0,0] neg_hi:[1,0,0]
  v_cvt_pk_bf16_f32 v114, v74, v76
  s_waitcnt lgkmcnt(2)
  buffer_store_dwordx4 v[80:83], v67, s[32:35], s36 offen sc1
  v_cvt_pk_bf16_f32 v115, v75, v77
  v_mov_b32_dpp v48, v112 row_shr:13 row_mask:0xf bank_mask:0xf
  v_mov_b32_dpp v49, v113 row_shr:13 row_mask:0xf bank_mask:0xf
  v_mfma_f32_16x16x32_bf16 v[72:75], v[32:35], v[112:115], 0
  v_mov_b32_dpp v50, v114 row_shr:13 row_mask:0xf bank_mask:0xf
  v_mov_b32_dpp v51, v115 row_shr:13 row_mask:0xf bank_mask:0xf
  v_mfma_f32_16x16x32_bf16 v[76:79], v[40:43], v[112:115], 0
  ds_read_b128 v[80:83], v61 offset:12288
  s_add_u32 s36, s38, 0x461800
  s_waitcnt lgkmcnt(1)
  v_mfma_f32_16x16x32_bf16 v[84:87], v[92:95], v[20:23], 0
  v_xor_b32 v56, 0xf0, v57
  ds_read_b64_tr_b16 v[96:97], v56 offset:15360
  v_mfma_f32_16x16x32_bf16 v[112:115], v[92:95], v[24:27], 0
  s_nop 0
  v_cvt_pk_bf16_f32 v89, v72, v76
  v_cvt_pk_bf16_f32 v101, v73, v77
  v_cvt_pk_bf16_f32 v105, v74, v78
  v_cvt_pk_bf16_f32 v109, v75, v79
  ds_read_b64_tr_b16 v[98:99], v56 offset:15872
  v_pk_mul_f32 v[56:57], v[16:17], s[72:73] op_sel_hi:[1,0]
  v_pk_mul_f32 v[70:71], v[28:29], s[72:73] op_sel_hi:[1,0]
  v_pk_mul_f32 v[72:73], v[84:85], v[56:57]
  v_pk_mul_f32 v[74:75], v[112:113], v[56:57]
  v_pk_fma_f32 v[72:73], v[112:113], v[70:71], v[72:73]
  v_pk_fma_f32 v[74:75], v[84:85], v[70:71], v[74:75] neg_lo:[1,0,0] neg_hi:[1,0,0]
  v_cvt_pk_bf16_f32 v76, v72, v74
  v_cvt_pk_bf16_f32 v77, v73, v75
  v_pk_mul_f32 v[56:57], v[18:19], s[72:73] op_sel_hi:[1,0]
  v_pk_mul_f32 v[70:71], v[30:31], s[72:73] op_sel_hi:[1,0]
  v_pk_mul_f32 v[72:73], v[86:87], v[56:57]
  v_pk_mul_f32 v[74:75], v[114:115], v[56:57]
  v_pk_fma_f32 v[72:73], v[114:115], v[70:71], v[72:73]
  v_pk_fma_f32 v[74:75], v[86:87], v[70:71], v[74:75] neg_lo:[1,0,0] neg_hi:[1,0,0]
  v_cvt_pk_bf16_f32 v78, v72, v74
  s_waitcnt lgkmcnt(2)
  buffer_store_dwordx4 v[80:83], v67, s[32:35], s36 offen sc1
  v_cvt_pk_bf16_f32 v79, v73, v75
  v_mov_b32_dpp v48, v76 row_shr:14 row_mask:0xf bank_mask:0xf
  v_mov_b32_dpp v49, v77 row_shr:14 row_mask:0xf bank_mask:0xf
  v_mfma_f32_16x16x32_bf16 v[72:75], v[32:35], v[76:79], 0
  v_mov_b32_dpp v50, v78 row_shr:14 row_mask:0xf bank_mask:0xf
  v_mov_b32_dpp v51, v79 row_shr:14 row_mask:0xf bank_mask:0xf
  v_mfma_f32_16x16x32_bf16 v[80:83], v[40:43], v[76:79], 0
  ds_read_b128 v[76:79], v63 offset:14336
  s_add_u32 s36, s38, 0x471c00
  s_waitcnt lgkmcnt(1)
  v_mfma_f32_16x16x32_bf16 v[84:87], v[96:99], v[20:23], 0
  v_xor_b32 v20, 0x90, v64
  v_xor_b32 v21, 0x90, v65
  v_mfma_f32_16x16x32_bf16 v[92:95], v[96:99], v[24:27], 0
  s_nop 0
  v_cvt_pk_bf16_f32 v90, v72, v80
  v_cvt_pk_bf16_f32 v102, v73, v81
  v_cvt_pk_bf16_f32 v106, v74, v82
  v_cvt_pk_bf16_f32 v110, v75, v83
  v_xor_b32 v22, 0x90, v66
  v_pk_mul_f32 v[24:25], v[16:17], s[72:73] op_sel:[0,1] op_sel_hi:[1,1]
  v_pk_mul_f32 v[26:27], v[28:29], s[72:73] op_sel:[0,1] op_sel_hi:[1,1]
  v_pk_mul_f32 v[56:57], v[84:85], v[24:25]
  v_pk_mul_f32 v[64:65], v[92:93], v[24:25]
  v_pk_fma_f32 v[56:57], v[92:93], v[26:27], v[56:57]
  v_pk_fma_f32 v[64:65], v[84:85], v[26:27], v[64:65] neg_lo:[1,0,0] neg_hi:[1,0,0]
  v_cvt_pk_bf16_f32 v24, v56, v64
  v_cvt_pk_bf16_f32 v25, v57, v65
  v_pk_mul_f32 v[56:57], v[18:19], s[72:73] op_sel:[0,1] op_sel_hi:[1,1]
  v_pk_mul_f32 v[16:17], v[30:31], s[72:73] op_sel:[0,1] op_sel_hi:[1,1]
  v_pk_mul_f32 v[18:19], v[86:87], v[56:57]
  v_pk_mul_f32 v[28:29], v[94:95], v[56:57]
  v_pk_fma_f32 v[18:19], v[94:95], v[16:17], v[18:19]
  v_pk_fma_f32 v[28:29], v[86:87], v[16:17], v[28:29] neg_lo:[1,0,0] neg_hi:[1,0,0]
  v_cvt_pk_bf16_f32 v26, v18, v28
  s_waitcnt lgkmcnt(0)
  buffer_store_dwordx4 v[76:79], v67, s[32:35], s36 offen sc1
  v_cvt_pk_bf16_f32 v27, v19, v29
  v_mov_b32_dpp v48, v24 row_shr:15 row_mask:0xf bank_mask:0xf
  v_mov_b32_dpp v49, v25 row_shr:15 row_mask:0xf bank_mask:0xf
  v_mfma_f32_16x16x32_bf16 v[16:19], v[32:35], v[24:27], 0
  v_mov_b32_dpp v50, v26 row_shr:15 row_mask:0xf bank_mask:0xf
  v_mov_b32_dpp v51, v27 row_shr:15 row_mask:0xf bank_mask:0xf
  v_mfma_f32_16x16x32_bf16 v[28:31], v[40:43], v[24:27], 0
  v_xor_b32 v23, 0x90, v62
  s_and_b32 s36, s42, 1
  v_mfma_f32_16x16x32_bf16 v[24:27], v[36:39], v[48:51], 0
  s_lshl_b32 s36, s36, 12
  s_lshl_b32 s37, s40, 10
  v_mfma_f32_16x16x32_bf16 v[32:35], v[44:47], v[48:51], 0
  s_nop 1
  v_cvt_pk_bf16_f32 v91, v16, v28
  v_cvt_pk_bf16_f32 v103, v17, v29
  v_cvt_pk_bf16_f32 v107, v18, v30
  v_cvt_pk_bf16_f32 v111, v19, v31
  ds_write_b128 v20, v[88:91]
  ds_write_b128 v21, v[100:103]
  ds_write_b128 v22, v[104:107]
  ds_write_b128 v23, v[108:111]
  v_cvt_pk_bf16_f32 v16, v24, v32
  ds_write_b32 v3, v16 offset:0
  v_cvt_pk_bf16_f32 v16, v25, v33
  ds_write_b32 v3, v16 offset:8192
  v_cvt_pk_bf16_f32 v16, v26, v34
  ds_write_b32 v3, v16 offset:16384
  v_cvt_pk_bf16_f32 v16, v27, v35
  ds_write_b32 v3, v16 offset:24576
  s_add_u32 s36, s36, s37
  s_lshr_b32 s37, s42, 1
  s_lshl_b32 s37, s37, 8
  s_add_u32 s36, s36, s37
  s_add_u32 s36, s36, s43
  s_add_u32 s36, s36, 0x100000
  v_lshlrev_b32 v3, 2, v6
  s_waitcnt vmcnt(9)
  v_lshl_or_b32 v60, v68, 16, v60
  buffer_store_dword v60, v3, s[32:35], s36 offen sc1
  s_waitcnt lgkmcnt(0)
  s_barrier
  ds_read_b128 v[16:19], v63 offset:0
  s_add_u32 s36, s38, 0x400400
  ds_read_b128 v[20:23], v61 offset:2048
  s_add_u32 s37, s38, 0x410800
  ds_read_b128 v[24:27], v63 offset:4096
  s_add_u32 s40, s38, 0x420c00
  ds_read_b128 v[28:31], v61 offset:6144
  s_add_u32 s41, s38, 0x431000
  ds_read_b128 v[32:35], v63 offset:8192
  s_add_u32 s42, s38, 0x441400
  ds_read_b128 v[36:39], v61 offset:10240
  s_add_u32 s43, s38, 0x451800
  ds_read_b128 v[40:43], v63 offset:12288
  s_add_u32 s44, s38, 0x461c00
  ds_read_b128 v[44:47], v61 offset:14336
  s_add_u32 s48, s38, 0x472000
  s_waitcnt lgkmcnt(7)
  buffer_store_dwordx4 v[16:19], v67, s[32:35], s36 offen sc1
  s_waitcnt lgkmcnt(6)
  buffer_store_dwordx4 v[20:23], v67, s[32:35], s37 offen sc1
  s_waitcnt lgkmcnt(5)
  buffer_store_dwordx4 v[24:27], v67, s[32:35], s40 offen sc1
  s_waitcnt lgkmcnt(4)
  buffer_store_dwordx4 v[28:31], v67, s[32:35], s41 offen sc1
  s_waitcnt lgkmcnt(3)
  buffer_store_dwordx4 v[32:35], v67, s[32:35], s42 offen sc1
  s_waitcnt lgkmcnt(2)
  buffer_store_dwordx4 v[36:39], v67, s[32:35], s43 offen sc1
  s_waitcnt lgkmcnt(1)
  buffer_store_dwordx4 v[40:43], v67, s[32:35], s44 offen sc1
  s_waitcnt lgkmcnt(0)
  buffer_store_dwordx4 v[44:47], v67, s[32:35], s48 offen sc1
  v_lshrrev_b32 v3, 2, v6
  v_and_b32 v16, 3, v6
  v_lshlrev_b32 v16, 3, v16
  v_lshl_add_u32 v17, v3, 7, v16
  s_lshl_b32 s36, s56, 5
  s_add_u32 s36, s36, 0x20000
  v_add_u32 v17, s36, v17
  ds_read_b64_tr_b16 v[18:19], v17 offset:0
  ds_read_b64_tr_b16 v[20:21], v17 offset:4096
  ds_read_b64_tr_b16 v[22:23], v17 offset:2048
  ds_read_b64_tr_b16 v[24:25], v17 offset:6144
  s_mov_b32 s36, 0x5040100
  s_mov_b32 s37, 0x7060302
  s_lshl_b32 s38, s58, 2
  s_add_u32 s38, s38, s56
  v_and_b32 v3, 7, v6
  v_or_b32 v16, s38, v3
  v_min_u32 v16, 1, v16
  v_xor_b32 v16, 1, v16
  v_mul_u32_u24 v3, 0x2080, v3
  v_lshrrev_b32 v17, 4, v6
  v_lshl_add_u32 v3, v17, 4, v3
  v_and_b32 v17, 8, v6
  v_lshl_add_u32 v3, v17, 3, v3
  v_lshl_add_u32 v17, v16, 30, v3
  v_add_u32 v16, 0x10400, v3
  s_lshl_b32 s40, s38, 3
  s_add_u32 s40, s40, s57
  s_lshl_b32 s40, s40, 3
  s_add_u32 s40, s40, s59
  s_lshl_b32 s40, s40, 2
  s_add_u32 s40, s40, 0x20000
  s_mul_i32 s38, s38, 0x20800
  s_and_b32 s41, s59, 1
  s_lshl_b32 s41, s41, 12
  s_add_u32 s38, s38, s41
  s_lshr_b32 s41, s57, 1
  s_lshl_b32 s41, s41, 10
  s_add_u32 s38, s38, s41
  s_lshr_b32 s41, s59, 1
  s_lshl_b32 s41, s41, 8
  s_add_u32 s38, s38, s41
  s_and_b32 s41, s57, 1
  s_lshl_b32 s41, s41, 7
  s_add_u32 s38, s38, s41
  s_add_u32 s38, s38, 0x100000
  s_waitcnt lgkmcnt(2)
  v_perm_b32 v28, v20, v18, s36
  v_perm_b32 v29, v20, v18, s37
  v_perm_b32 v30, v21, v19, s36
  v_perm_b32 v31, v21, v19, s37
  s_waitcnt lgkmcnt(0)
  v_perm_b32 v32, v24, v22, s36
  v_perm_b32 v33, v24, v22, s37
  v_perm_b32 v34, v25, v23, s36
  v_perm_b32 v35, v25, v23, s37
  v_mov_b32 v20, v28
  v_mov_b32 v21, v29
  v_mov_b32 v22, v30
  v_mov_b32 v23, v31
  v_mov_b32_dpp v28, v32 row_ror:8 row_mask:0xf bank_mask:0xc
  v_mov_b32_dpp v29, v33 row_ror:8 row_mask:0xf bank_mask:0xc
  v_mov_b32_dpp v30, v34 row_ror:8 row_mask:0xf bank_mask:0xc
  v_mov_b32_dpp v31, v35 row_ror:8 row_mask:0xf bank_mask:0xc
  v_mov_b32_dpp v32, v20 row_ror:8 row_mask:0xf bank_mask:0x3
  v_mov_b32_dpp v33, v21 row_ror:8 row_mask:0xf bank_mask:0x3
  v_mov_b32_dpp v34, v22 row_ror:8 row_mask:0xf bank_mask:0x3
  v_mov_b32_dpp v35, v23 row_ror:8 row_mask:0xf bank_mask:0x3
  buffer_store_dwordx4 v[28:31], v17, s[32:35], s38 offen sc1
  buffer_store_dwordx4 v[32:35], v16, s[32:35], s38 offen sc1
  s_and_b32 s36, s56, 1
  s_lshl_b32 s36, s36, 5
  s_lshr_b32 s37, s56, 1
  s_lshl_b32 s37, s37, 4
  s_add_u32 s36, s36, s37
  s_and_b32 s37, s59, 7
  s_mul_i32 s37, s37, 7
  s_lshr_b32 s37, s37, 2
  s_mul_i32 s38, s58, 0
  s_lshr_b32 s38, s38, 1
  s_add_u32 s37, s37, s38
  s_mul_i32 s38, s57, 7
  s_lshr_b32 s38, s38, 2
  s_add_u32 s37, s37, s38
  s_sub_u32 s38, s37, 14
  s_min_u32 s37, s37, s38
  s_sub_u32 s38, s37, 14
  s_min_u32 s37, s37, s38
  s_mul_i32 s38, s56, 14
  s_add_u32 s41, s37, 0
  s_sub_u32 s42, s41, 14
  s_min_u32 s41, s41, s42
  s_add_u32 s41, s41, s38
  s_lshl_b32 s41, s41, 11
  s_add_u32 s42, s37, 1
  s_sub_u32 s43, s42, 14
  s_min_u32 s42, s42, s43
  s_add_u32 s42, s42, s38
  s_lshl_b32 s42, s42, 11
  s_add_u32 s43, s37, 2
  s_sub_u32 s44, s43, 14
  s_min_u32 s43, s43, s44
  s_add_u32 s43, s43, s38
  s_lshl_b32 s43, s43, 11
  s_add_u32 s44, s37, 3
  s_sub_u32 s48, s44, 14
  s_min_u32 s44, s44, s48
  s_add_u32 s44, s44, s38
  s_lshl_b32 s44, s44, 11
  s_add_u32 s48, s37, 4
  s_sub_u32 s49, s48, 14
  s_min_u32 s48, s48, s49
  s_add_u32 s48, s48, s38
  s_lshl_b32 s48, s48, 11
  s_add_u32 s49, s37, 5
  s_sub_u32 s50, s49, 14
  s_min_u32 s49, s49, s50
  s_add_u32 s49, s49, s38
  s_lshl_b32 s49, s49, 11
  s_add_u32 s50, s37, 6
  s_sub_u32 s51, s50, 14
  s_min_u32 s50, s50, s51
  s_add_u32 s50, s50, s38
  s_lshl_b32 s50, s50, 11
  s_add_u32 s51, s37, 7
  s_sub_u32 s53, s51, 14
  s_min_u32 s51, s51, s53
  s_add_u32 s51, s51, s38
  s_lshl_b32 s51, s51, 11
  s_add_u32 s53, s37, 8
  s_sub_u32 s54, s53, 14
  s_min_u32 s53, s53, s54
  s_add_u32 s53, s53, s38
  s_lshl_b32 s53, s53, 11
  s_add_u32 s54, s37, 9
  s_sub_u32 s55, s54, 14
  s_min_u32 s54, s54, s55
  s_add_u32 s54, s54, s38
  s_lshl_b32 s54, s54, 11
  s_add_u32 s55, s37, 10
  s_sub_u32 s57, s55, 14
  s_min_u32 s55, s55, s57
  s_add_u32 s55, s55, s38
  s_lshl_b32 s55, s55, 11
  s_add_u32 s57, s37, 11
  s_sub_u32 s58, s57, 14
  s_min_u32 s57, s57, s58
  s_add_u32 s57, s57, s38
  s_lshl_b32 s57, s57, 11
  s_add_u32 s58, s37, 12
  s_sub_u32 s59, s58, 14
  s_min_u32 s58, s58, s59
  s_add_u32 s58, s58, s38
  s_lshl_b32 s58, s58, 11
  s_add_u32 s59, s37, 13
  s_sub_u32 s37, s59, 14
  s_min_u32 s59, s59, s37
  s_add_u32 s59, s59, s38
  s_lshl_b32 s59, s59, 11
  s_lshl_b32 s37, s64, 7
  s_mul_i32 s38, s52, 0x38000
  s_add_u32 s38, s38, 0x1000000
  v_bfe_u32 v3, v6, 4, 1
  v_lshlrev_b32 v3, 2, v3
  v_and_b32 v16, 7, v6
  v_xor_b32 v3, v3, v16
  v_lshlrev_b32 v17, 4, v3
  v_lshrrev_b32 v16, 3, v6
  v_lshl_add_u32 v3, v16, 10, v17
  v_add_u32 v16, 0x1c00, v3
  v_add_u32 v18, 0x3800, v3
  v_add_u32 v19, 0x5400, v3
  s_waitcnt vmcnt(2)
  buffer_store_dword v9, v13, s[32:35], s39 offen sc1
  s_waitcnt vmcnt(1)
  buffer_store_dword v9, v13, s[32:35], s40 offen sc1
  s_add_u32 s39, s45, 0
  buffer_load_dword v2, v59, s[24:27], s39 offen
  s_add_u32 s39, s45, 0xc000
  buffer_load_dword v4, v59, s[24:27], s39 offen
  s_barrier
  s_lshl_b32 s39, s41, 4
  v_and_b32 v5, 15, v6
  v_lshrrev_b32 v7, 4, v6
  s_lshl_b32 s40, s56, 4
  v_add_u32 v8, s40, v5
  v_cvt_f32_u32 v10, v8
  v_cvt_f32_u32 v11, v7
  s_add_u32 s39, s39, s37
  v_and_b32 v8, 12, v5
  v_add_u32 v7, v5, v8
  v_cvt_f32_u32 v5, v7
  v_mul_f32 v7, 0x3c800000, v10
  v_mul_f32 v8, v7, v11
  v_mul_f32 v8, 4.0, v8
  s_add_u32 m0, s65, 0x20000
  s_nop 0
  buffer_load_dwordx4 v3, s[24:27], s39 offen offset:0 lds
  v_cos_f32 v12, v8
  v_sin_f32 v14, v8
  v_fmamk_f32 v15, v7, 0x3f800000, v8
  v_cos_f32 v20, v15
  v_sin_f32 v21, v15
  v_cvt_pk_bf16_f32 v15, v12, v14
  buffer_load_dwordx4 v16, s[24:27], s39 offen offset:1024 lds
  v_cvt_pk_bf16_f32 v22, -v14, v12
  v_accvgpr_write_b32 a0, v15
  v_accvgpr_write_b32 a4, v22
  v_fmamk_f32 v12, v7, 0x40000000, v8
  v_cos_f32 v14, v12
  v_sin_f32 v15, v12
  buffer_load_dwordx4 v18, s[24:27], s39 offen offset:2048 lds
  v_cvt_pk_bf16_f32 v12, v20, v21
  v_cvt_pk_bf16_f32 v22, -v21, v20
  v_accvgpr_write_b32 a1, v12
  v_accvgpr_write_b32 a5, v22
  v_fmamk_f32 v12, v7, 0x40400000, v8
  v_cos_f32 v20, v12
  buffer_load_dwordx4 v19, s[24:27], s39 offen offset:3072 lds
  v_sin_f32 v21, v12
  v_cvt_pk_bf16_f32 v12, v14, v15
  v_cvt_pk_bf16_f32 v22, -v15, v14
  v_accvgpr_write_b32 a2, v12
  v_accvgpr_write_b32 a6, v22
  v_fmamk_f32 v12, v7, 0x41800000, v8
  s_lshl_b32 s39, s42, 4
  v_cos_f32 v14, v12
  v_sin_f32 v15, v12
  v_cvt_pk_bf16_f32 v12, v20, v21
  v_cvt_pk_bf16_f32 v22, -v21, v20
  v_accvgpr_write_b32 a3, v12
  v_accvgpr_write_b32 a7, v22
  s_add_u32 s39, s39, s37
  v_fmamk_f32 v12, v7, 0x41880000, v8
  v_cos_f32 v20, v12
  v_sin_f32 v21, v12
  v_cvt_pk_bf16_f32 v12, v14, v15
  v_cvt_pk_bf16_f32 v22, -v15, v14
  v_accvgpr_write_b32 a8, v12
  s_add_u32 m0, s65, 0x21000
  s_nop 0
  buffer_load_dwordx4 v3, s[24:27], s39 offen offset:0 lds
  v_accvgpr_write_b32 a12, v22
  v_fmamk_f32 v12, v7, 0x41900000, v8
  v_cos_f32 v14, v12
  v_sin_f32 v15, v12
  v_cvt_pk_bf16_f32 v12, v20, v21
  v_cvt_pk_bf16_f32 v22, -v21, v20
  buffer_load_dwordx4 v16, s[24:27], s39 offen offset:1024 lds
  v_accvgpr_write_b32 a9, v12
  v_accvgpr_write_b32 a13, v22
  v_fmamk_f32 v12, v7, 0x41980000, v8
  v_cos_f32 v20, v12
  v_sin_f32 v21, v12
  v_cvt_pk_bf16_f32 v12, v14, v15
  buffer_load_dwordx4 v18, s[24:27], s39 offen offset:2048 lds
  v_cvt_pk_bf16_f32 v22, -v15, v14
  v_accvgpr_write_b32 a10, v12
  v_accvgpr_write_b32 a14, v22
  v_fmamk_f32 v12, v7, 0x42000000, v8
  v_cos_f32 v14, v12
  v_sin_f32 v15, v12
  buffer_load_dwordx4 v19, s[24:27], s39 offen offset:3072 lds
  v_cvt_pk_bf16_f32 v12, v20, v21
  v_cvt_pk_bf16_f32 v22, -v21, v20
  v_accvgpr_write_b32 a11, v12
  v_accvgpr_write_b32 a15, v22
  v_fmamk_f32 v12, v7, 0x42040000, v8
  v_cos_f32 v20, v12
  s_lshl_b32 s39, s43, 4
  v_sin_f32 v21, v12
  v_cvt_pk_bf16_f32 v12, v14, v15
  v_cvt_pk_bf16_f32 v22, -v15, v14
  v_accvgpr_write_b32 a16, v12
  v_accvgpr_write_b32 a20, v22
  v_fmamk_f32 v12, v7, 0x42080000, v8
  s_add_u32 s39, s39, s37
  v_cos_f32 v14, v12
  v_sin_f32 v15, v12
  v_cvt_pk_bf16_f32 v12, v20, v21
  v_cvt_pk_bf16_f32 v22, -v21, v20
  v_accvgpr_write_b32 a17, v12
  v_accvgpr_write_b32 a21, v22
  s_add_u32 m0, s65, 0
  s_nop 0
  buffer_load_dwordx4 v3, s[24:27], s39 offen offset:0 lds
  v_fmamk_f32 v12, v7, 0x420c0000, v8
  v_cos_f32 v20, v12
  v_sin_f32 v21, v12
  v_cvt_pk_bf16_f32 v12, v14, v15
  v_cvt_pk_bf16_f32 v22, -v15, v14
  v_accvgpr_write_b32 a18, v12
  buffer_load_dwordx4 v16, s[24:27], s39 offen offset:1024 lds
  v_accvgpr_write_b32 a22, v22
  v_fmamk_f32 v12, v7, 0x42400000, v8
  v_cos_f32 v14, v12
  v_sin_f32 v15, v12
  v_cvt_pk_bf16_f32 v12, v20, v21
  v_cvt_pk_bf16_f32 v22, -v21, v20
  buffer_load_dwordx4 v18, s[24:27], s39 offen offset:2048 lds
  v_accvgpr_write_b32 a19, v12
  v_accvgpr_write_b32 a23, v22
  v_fmamk_f32 v12, v7, 0x42440000, v8
  v_cos_f32 v20, v12
  v_sin_f32 v21, v12
  v_cvt_pk_bf16_f32 v12, v14, v15
  buffer_load_dwordx4 v19, s[24:27], s39 offen offset:3072 lds
  v_cvt_pk_bf16_f32 v22, -v15, v14
  v_accvgpr_write_b32 a24, v12
  v_accvgpr_write_b32 a28, v22
  v_fmamk_f32 v12, v7, 0x42480000, v8
  v_cos_f32 v14, v12
  v_sin_f32 v15, v12
  s_lshl_b32 s39, s44, 4
  v_cvt_pk_bf16_f32 v12, v20, v21
  v_cvt_pk_bf16_f32 v22, -v21, v20
  v_accvgpr_write_b32 a25, v12
  v_accvgpr_write_b32 a29, v22
  v_fmamk_f32 v12, v7, 0x424c0000, v8
  v_cos_f32 v7, v12
  s_add_u32 s39, s39, s37
  v_sin_f32 v8, v12
  v_cvt_pk_bf16_f32 v12, v14, v15
  v_cvt_pk_bf16_f32 v20, -v15, v14
  v_accvgpr_write_b32 a26, v12
  v_accvgpr_write_b32 a30, v20
  v_mul_f32 v12, 0x41000000, v11
  s_add_u32 m0, s65, 0x1000
  s_nop 0
  buffer_load_dwordx4 v3, s[24:27], s39 offen offset:0 lds
  v_mul_f32 v14, 0x3d000000, v5
  v_mul_f32 v15, v14, v12
  v_cos_f32 v20, v15
  v_sin_f32 v21, v15
  v_cvt_pk_bf16_f32 v22, v7, v8
  v_cvt_pk_bf16_f32 v23, -v8, v7
  buffer_load_dwordx4 v16, s[24:27], s39 offen offset:1024 lds
  v_accvgpr_write_b32 a27, v22
  v_accvgpr_write_b32 a31, v23
  v_fmamk_f32 v7, v14, 0x3f800000, v15
  v_cos_f32 v8, v7
  v_sin_f32 v22, v7
  v_cvt_pk_bf16_f32 v7, v20, v21
  buffer_load_dwordx4 v18, s[24:27], s39 offen offset:2048 lds
  v_accvgpr_write_b32 a32, v7
  v_fmamk_f32 v7, v14, 0x40000000, v15
  v_cos_f32 v20, v7
  v_sin_f32 v21, v7
  v_cvt_pk_bf16_f32 v7, v8, v22
  v_accvgpr_write_b32 a33, v7
  buffer_load_dwordx4 v19, s[24:27], s39 offen offset:3072 lds
  v_fmamk_f32 v7, v14, 0x40400000, v15
  v_cos_f32 v8, v7
  v_sin_f32 v22, v7
  v_cvt_pk_bf16_f32 v7, v20, v21
  v_accvgpr_write_b32 a34, v7
  v_fmamk_f32 v7, v14, 0x40800000, v15
  s_lshl_b32 s39, s48, 4
  v_cos_f32 v20, v7
  v_sin_f32 v21, v7
  v_cvt_pk_bf16_f32 v7, v8, v22
  v_accvgpr_write_b32 a35, v7
  v_fmamk_f32 v7, v14, 0x40a00000, v15
  v_cos_f32 v8, v7
  s_add_u32 s39, s39, s37
  v_sin_f32 v22, v7
  v_cvt_pk_bf16_f32 v7, v20, v21
  v_accvgpr_write_b32 a36, v7
  v_fmamk_f32 v7, v14, 0x40c00000, v15
  v_cos_f32 v20, v7
  v_sin_f32 v21, v7
  s_add_u32 m0, s65, 0x8000
  s_nop 0
  buffer_load_dwordx4 v3, s[24:27], s39 offen offset:0 lds
  v_cvt_pk_bf16_f32 v7, v8, v22
  v_accvgpr_write_b32 a37, v7
  v_fmamk_f32 v7, v14, 0x40e00000, v15
  v_cos_f32 v8, v7
  v_sin_f32 v14, v7
  v_cvt_pk_bf16_f32 v7, v20, v21
  buffer_load_dwordx4 v16, s[24:27], s39 offen offset:1024 lds
  v_accvgpr_write_b32 a38, v7
  v_add_f32 v7, 4.0, v5
  v_mul_f32 v15, 0x3d000000, v7
  v_mul_f32 v20, v15, v12
  v_cos_f32 v21, v20
  v_sin_f32 v22, v20
  buffer_load_dwordx4 v18, s[24:27], s39 offen offset:2048 lds
  v_cvt_pk_bf16_f32 v23, v8, v14
  v_accvgpr_write_b32 a39, v23
  v_fmamk_f32 v8, v15, 0x3f800000, v20
  v_cos_f32 v14, v8
  v_sin_f32 v23, v8
  v_cvt_pk_bf16_f32 v8, v21, v22
  buffer_load_dwordx4 v19, s[24:27], s39 offen offset:3072 lds
  v_accvgpr_write_b32 a40, v8
  v_fmamk_f32 v8, v15, 0x40000000, v20
  v_cos_f32 v21, v8
  v_sin_f32 v22, v8
  v_cvt_pk_bf16_f32 v8, v14, v23
  v_accvgpr_write_b32 a41, v8
  s_lshl_b32 s39, s49, 4
  v_fmamk_f32 v8, v15, 0x40400000, v20
  v_cos_f32 v14, v8
  v_sin_f32 v23, v8
  v_cvt_pk_bf16_f32 v8, v21, v22
  v_accvgpr_write_b32 a42, v8
  v_fmamk_f32 v8, v15, 0x40800000, v20
  s_add_u32 s39, s39, s37
  v_cos_f32 v21, v8
  v_sin_f32 v22, v8
  v_cvt_pk_bf16_f32 v8, v14, v23
  v_accvgpr_write_b32 a43, v8
  v_fmamk_f32 v8, v15, 0x40a00000, v20
  v_cos_f32 v14, v8
  s_add_u32 m0, s65, 0x9000
  s_nop 0
  buffer_load_dwordx4 v3, s[24:27], s39 offen offset:0 lds
  v_sin_f32 v23, v8
  v_cvt_pk_bf16_f32 v8, v21, v22
  v_accvgpr_write_b32 a44, v8
  v_fmamk_f32 v8, v15, 0x40c00000, v20
  v_cos_f32 v21, v8
  v_sin_f32 v22, v8
  buffer_load_dwordx4 v16, s[24:27], s39 offen offset:1024 lds
  v_cvt_pk_bf16_f32 v8, v14, v23
  v_accvgpr_write_b32 a45, v8
  v_fmamk_f32 v8, v15, 0x40e00000, v20
  v_cos_f32 v14, v8
  v_sin_f32 v15, v8
  v_cvt_pk_bf16_f32 v8, v21, v22
  buffer_load_dwordx4 v18, s[24:27], s39 offen offset:2048 lds
  v_accvgpr_write_b32 a46, v8
  v_cvt_pk_bf16_f32 v8, v14, v15
  v_accvgpr_write_b32 a47, v8
  v_mul_f32 v8, 0x3a000000, v10
  v_mul_f32 v10, v8, v12
  v_cos_f32 v20, v10
  buffer_load_dwordx4 v19, s[24:27], s39 offen offset:3072 lds
  v_sin_f32 v24, v10
  v_fmamk_f32 v12, v8, 0x3f800000, v10
  v_cos_f32 v21, v12
  v_sin_f32 v25, v12
  v_fmamk_f32 v12, v8, 0x40000000, v10
  v_cos_f32 v22, v12
  s_lshl_b32 s39, s50, 4
  v_sin_f32 v26, v12
  v_fmamk_f32 v12, v8, 0x40400000, v10
  v_cos_f32 v23, v12
  v_sin_f32 v27, v12
  v_fmamk_f32 v12, v8, 0x40800000, v10
  v_cos_f32 v28, v12
  s_add_u32 s39, s39, s37
  v_sin_f32 v32, v12
  v_fmamk_f32 v12, v8, 0x40a00000, v10
  v_cos_f32 v29, v12
  v_sin_f32 v33, v12
  v_fmamk_f32 v12, v8, 0x40c00000, v10
  v_cos_f32 v30, v12
  s_add_u32 m0, s65, 0x10000
  s_nop 0
  buffer_load_dwordx4 v3, s[24:27], s39 offen offset:0 lds
  v_sin_f32 v34, v12
  v_fmamk_f32 v12, v8, 0x40e00000, v10
  v_cos_f32 v31, v12
  v_sin_f32 v35, v12
  s_lshl_b32 s40, s56, 4
  v_cvt_f32_u32 v8, s40
  buffer_load_dwordx4 v16, s[24:27], s39 offen offset:1024 lds
  v_fmamk_f32 v8, v11, 0x40800000, v8
  v_mul_f32 v10, 0x3a000000, v5
  v_mul_f32 v5, v10, v8
  v_cos_f32 v36, v5
  v_sin_f32 v40, v5
  v_fmamk_f32 v11, v10, 0x3f800000, v5
  buffer_load_dwordx4 v18, s[24:27], s39 offen offset:2048 lds
  v_cos_f32 v37, v11
  v_sin_f32 v41, v11
  v_fmamk_f32 v11, v10, 0x40000000, v5
  v_cos_f32 v38, v11
  v_sin_f32 v42, v11
  v_fmamk_f32 v11, v10, 0x40400000, v5
  buffer_load_dwordx4 v19, s[24:27], s39 offen offset:3072 lds
  v_cos_f32 v39, v11
  v_sin_f32 v43, v11
  v_mul_f32 v5, 0x3a000000, v7
  v_mul_f32 v7, v5, v8
  v_cos_f32 v44, v7
  v_sin_f32 v48, v7
  v_fmamk_f32 v8, v5, 0x3f800000, v7
  v_cos_f32 v45, v8
  v_sin_f32 v49, v8
  v_fmamk_f32 v8, v5, 0x40000000, v7
  v_cos_f32 v46, v8
  v_sin_f32 v50, v8
  v_fmamk_f32 v8, v5, 0x40400000, v7
  v_cos_f32 v47, v8
  v_sin_f32 v51, v8
  v_lshrrev_b32 v5, 5, v6
  v_bfe_u32 v7, v6, 2, 2
  v_lshl_add_u32 v5, v5, 2, v7
  v_lshlrev_b32 v5, 7, v5
  v_bfe_u32 v7, v6, 4, 1
  v_lshlrev_b32 v7, 5, v7
  v_and_b32 v8, 3, v6
  v_lshl_add_u32 v7, v8, 3, v7
  v_bfe_u32 v8, v6, 3, 1
  v_lshlrev_b32 v8, 6, v8
  v_xor_b32 v7, v7, v8
  s_lshl_b32 s39, s36, 1
  v_xor_b32 v7, s39, v7
  v_add3_u32 v8, v5, v7, s65
  v_xor_b32 v5, 64, v8
  v_add_u32 v7, 0x10000, v8
  v_add_u32 v10, 0x10000, v5
  v_add_u32 v11, 0x20000, v8
  v_add_u32 v12, 0x20000, v5
  v_lshlrev_b32 v14, 2, v6
  v_and_b32 v15, 0x7f, v14
  s_lshr_b32 s39, s62, 6
  s_lshl_b32 s39, s39, 7
  s_add_u32 s39, s39, 0x40000
  s_lshr_b32 s40, s62, 4
  s_lshl_b32 s40, s40, 8
  s_add_u32 s40, s40, 0x20000
  buffer_load_dword v52, v14, s[32:35], s40 offen sc1
  buffer_load_dword v53, v15, s[32:35], s39 offen sc1
  s_waitcnt vmcnt(26)
  ds_read_b64_tr_b16 a[48:49], v11 offset:0
  ds_read_b64_tr_b16 a[50:51], v11 offset:1024
  ds_read_b64_tr_b16 a[52:53], v12 offset:0
  ds_read_b64_tr_b16 a[54:55], v12 offset:1024
  ds_read_b64_tr_b16 a[56:57], v11 offset:2048
  ds_read_b64_tr_b16 a[58:59], v11 offset:3072
  ds_read_b64_tr_b16 a[60:61], v12 offset:2048
  ds_read_b64_tr_b16 a[62:63], v12 offset:3072
  s_waitcnt vmcnt(22)
  ds_read_b64_tr_b16 a[64:65], v11 offset:4096
  ds_read_b64_tr_b16 a[66:67], v11 offset:5120
  ds_read_b64_tr_b16 a[68:69], v12 offset:4096
  ds_read_b64_tr_b16 a[70:71], v12 offset:5120
  ds_read_b64_tr_b16 a[72:73], v11 offset:6144
  ds_read_b64_tr_b16 a[74:75], v11 offset:7168
  ds_read_b64_tr_b16 a[76:77], v12 offset:6144
  ds_read_b64_tr_b16 a[78:79], v12 offset:7168
  s_waitcnt vmcnt(18)
  ds_read_b64_tr_b16 a[80:81], v8 offset:0
  ds_read_b64_tr_b16 a[82:83], v8 offset:1024
  ds_read_b64_tr_b16 a[84:85], v5 offset:0
  ds_read_b64_tr_b16 a[86:87], v5 offset:1024
  ds_read_b64_tr_b16 a[88:89], v8 offset:2048
  ds_read_b64_tr_b16 a[90:91], v8 offset:3072
  ds_read_b64_tr_b16 a[92:93], v5 offset:2048
  ds_read_b64_tr_b16 a[94:95], v5 offset:3072
  s_waitcnt vmcnt(14)
  ds_read_b64_tr_b16 a[96:97], v8 offset:4096
  ds_read_b64_tr_b16 a[98:99], v8 offset:5120
  ds_read_b64_tr_b16 a[100:101], v5 offset:4096
  ds_read_b64_tr_b16 a[102:103], v5 offset:5120
  ds_read_b64_tr_b16 a[104:105], v8 offset:6144
  ds_read_b64_tr_b16 a[106:107], v8 offset:7168
  ds_read_b64_tr_b16 a[108:109], v5 offset:6144
  ds_read_b64_tr_b16 a[110:111], v5 offset:7168
  s_waitcnt vmcnt(10)
  ds_read_b64_tr_b16 a[112:113], v8 offset:32768
  ds_read_b64_tr_b16 a[114:115], v8 offset:33792
  ds_read_b64_tr_b16 a[116:117], v5 offset:32768
  ds_read_b64_tr_b16 a[118:119], v5 offset:33792
  ds_read_b64_tr_b16 a[120:121], v8 offset:34816
  ds_read_b64_tr_b16 a[122:123], v8 offset:35840
  ds_read_b64_tr_b16 a[124:125], v5 offset:34816
  ds_read_b64_tr_b16 a[126:127], v5 offset:35840
  s_mul_i32 s45, s62, 0x2080
  s_lshl_b32 s60, s56, 11
  s_add_u32 s60, s60, s45
  s_add_u32 s60, s60, 0x400000
  s_waitcnt vmcnt(1)
  v_cmp_ne_u32 vcc, s46, v52
  s_nop 0
  s_cbranch_vccnz L_poll14
L_back14:
  s_waitcnt vmcnt(0)
  v_cmp_ne_u32 vcc, s46, v53
  s_nop 0
  s_cbranch_vccnz L_poll15
L_back15:
  s_add_u32 m0, s65, 0x11000
  s_nop 0
  buffer_load_dwordx4 v1, s[32:35], s60 offen offset:0 sc1 lds
  buffer_load_dwordx4 v1, s[32:35], s60 offen offset:1024 sc1 lds
  s_lshl_b32 s39, s56, 10
  s_add_u32 s39, s39, s45
  s_add_u32 s40, s39, 0x100000
  buffer_load_dwordx4 v[52:55], v1, s[32:35], s40 offen sc1
  s_add_u32 s40, s39, 0x101000
  buffer_load_dwordx4 v[56:59], v1, s[32:35], s40 offen sc1
  s_lshl_b32 s39, s54, 4
  s_add_u32 s39, s39, s37
  s_waitcnt lgkmcnt(15)
  s_add_u32 m0, s65, 0x20000
  s_nop 0
  buffer_load_dwordx4 v3, s[24:27], s39 offen offset:0 lds
  buffer_load_dwordx4 v16, s[24:27], s39 offen offset:1024 lds
  buffer_load_dwordx4 v18, s[24:27], s39 offen offset:2048 lds
  buffer_load_dwordx4 v19, s[24:27], s39 offen offset:3072 lds
  s_lshl_b32 s39, s55, 4
  s_add_u32 s39, s39, s37
  s_add_u32 m0, s65, 0x21000
  s_nop 0
  buffer_load_dwordx4 v3, s[24:27], s39 offen offset:0 lds
  buffer_load_dwordx4 v16, s[24:27], s39 offen offset:1024 lds
  buffer_load_dwordx4 v18, s[24:27], s39 offen offset:2048 lds
  buffer_load_dwordx4 v19, s[24:27], s39 offen offset:3072 lds
  s_lshl_b32 s39, s57, 4
  s_add_u32 s39, s39, s37
  s_add_u32 m0, s65, 0
  s_nop 0
  buffer_load_dwordx4 v3, s[24:27], s39 offen offset:0 lds
  buffer_load_dwordx4 v16, s[24:27], s39 offen offset:1024 lds
  buffer_load_dwordx4 v18, s[24:27], s39 offen offset:2048 lds
  buffer_load_dwordx4 v19, s[24:27], s39 offen offset:3072 lds
  s_lshl_b32 s39, s58, 4
  s_add_u32 s39, s39, s37
  s_waitcnt lgkmcnt(8)
  s_add_u32 m0, s65, 0x1000
  s_nop 0
  buffer_load_dwordx4 v3, s[24:27], s39 offen offset:0 lds
  buffer_load_dwordx4 v16, s[24:27], s39 offen offset:1024 lds
  buffer_load_dwordx4 v18, s[24:27], s39 offen offset:2048 lds
  buffer_load_dwordx4 v19, s[24:27], s39 offen offset:3072 lds
  s_lshl_b32 s39, s59, 4
  s_add_u32 s39, s39, s37
  s_waitcnt lgkmcnt(0)
  s_add_u32 m0, s65, 0x8000
  s_nop 0
  buffer_load_dwordx4 v3, s[24:27], s39 offen offset:0 lds
  buffer_load_dwordx4 v16, s[24:27], s39 offen offset:1024 lds
  buffer_load_dwordx4 v18, s[24:27], s39 offen offset:2048 lds
  buffer_load_dwordx4 v19, s[24:27], s39 offen offset:3072 lds
  v_min_u32 v15, 27, v6
  v_lshlrev_b32 v15, 2, v15
  s_and_b32 s39, s52, 28
  s_add_u32 s39, s39, s56
  s_lshl_b32 s39, s39, 7
  s_add_u32 s39, s39, 0x60000
  buffer_load_dword v60, v15, s[32:35], s39 offen sc1
  s_waitcnt vmcnt(23)
  s_barrier
  v_add_u32 v2, 0x11000, v1
  ds_read_b128 a[128:131], v2 offset:0
  ds_read_b128 a[132:135], v2 offset:8192
  ds_read_b128 a[136:139], v2 offset:1024
  ds_read_b128 a[140:143], v2 offset:16384
  ds_read_b128 a[144:147], v2 offset:9216
  ds_read_b128 a[148:151], v2 offset:24576
  ds_read_b128 a[152:155], v2 offset:17408
  ds_read_b128 a[156:159], v2 offset:25600
  s_waitcnt vmcnt(22)
  v_lshlrev_b32 v64, 16, v52
  v_lshlrev_b32 v65, 16, v53
  v_lshlrev_b32 v66, 16, v54
  v_lshlrev_b32 v67, 16, v55
  v_and_b32 v52, 0xffff0000, v52
  v_and_b32 v53, 0xffff0000, v53
  v_and_b32 v54, 0xffff0000, v54
  v_and_b32 v55, 0xffff0000, v55
  s_waitcnt vmcnt(21)
  v_lshlrev_b32 v68, 16, v56
  v_lshlrev_b32 v69, 16, v57
  v_lshlrev_b32 v70, 16, v58
  v_lshlrev_b32 v71, 16, v59
  v_and_b32 v56, 0xffff0000, v56
  v_and_b32 v57, 0xffff0000, v57
  v_and_b32 v58, 0xffff0000, v58
  v_and_b32 v59, 0xffff0000, v59
  s_add_u32 s40, s65, 0x19000
  v_add_u32 v2, s40, v1
  s_lshl_b32 s40, s53, 4
  s_add_u32 s40, s40, s37
  s_waitcnt lgkmcnt(7)
  v_mfma_f32_16x16x32_bf16 v[72:75], a[128:131], a[0:3], 0
  s_add_u32 m0, s65, 0x18000
  s_nop 0
  buffer_load_dwordx4 v3, s[24:27], s40 offen offset:0 lds
  v_mfma_f32_16x16x32_bf16 v[76:79], a[128:131], a[4:7], 0
  buffer_load_dwordx4 v16, s[24:27], s40 offen offset:1024 lds
  buffer_load_dwordx4 v18, s[24:27], s40 offen offset:2048 lds
  s_waitcnt lgkmcnt(6)
  v_mfma_f32_16x16x32_bf16 v[72:75], a[132:135], a[8:11], v[72:75]
  s_lshl_b32 s45, s51, 4
  s_add_u32 s45, s45, s37
  v_mfma_f32_16x16x32_bf16 v[76:79], a[132:135], a[12:15], v[76:79]
  v_add_u32 v4, 0x19000, v1
  v_lshrrev_b32 v61, 4, v6
  s_waitcnt lgkmcnt(5)
  v_mfma_f32_16x16x32_bf16 v[80:83], a[136:139], a[0:3], 0
  s_lshl_b32 s60, s56, 10
  s_mul_i32 s61, s62, 0x2100
  v_mfma_f32_16x16x32_bf16 v[84:87], a[136:139], a[4:7], 0
  v_and_b32 v62, 15, v6
  v_lshlrev_b32 v61, 4, v61
  s_waitcnt lgkmcnt(4)
  v_mfma_f32_16x16x32_bf16 v[72:75], a[140:143], a[16:19], v[72:75]
  buffer_load_dwordx4 v19, s[24:27], s40 offen offset:3072 lds
  s_add_u32 s61, s61, s60
  v_mfma_f32_16x16x32_bf16 v[76:79], a[140:143], a[20:23], v[76:79]
  v_lshl_add_u32 v63, v62, 6, v61
  s_add_u32 s40, s61, 0x800000
  s_waitcnt lgkmcnt(3)
  v_mfma_f32_16x16x32_bf16 v[80:83], a[144:147], a[8:11], v[80:83]
  s_waitcnt vmcnt(4)
  v_cmp_ne_u32 vcc, s46, v60
  s_nop 0
  s_cbranch_vccnz L_poll16
L_back16:
  v_mfma_f32_16x16x32_bf16 v[84:87], a[144:147], a[12:15], v[84:87]
  s_add_u32 s39, s61, 0x801080
  s_waitcnt lgkmcnt(2)
  v_mfma_f32_16x16x32_bf16 v[72:75], a[148:151], a[24:27], v[72:75]
  v_mfma_f32_16x16x32_bf16 v[76:79], a[148:151], a[28:31], v[76:79]
  s_add_u32 s60, s41, s38
  buffer_load_dwordx4 a[128:131], v1, s[32:35], s60 offen offset:0 sc1
  s_waitcnt lgkmcnt(1)
  v_mfma_f32_16x16x32_bf16 v[80:83], a[152:155], a[16:19], v[80:83]
  v_mfma_f32_16x16x32_bf16 v[84:87], a[152:155], a[20:23], v[84:87]
  s_waitcnt lgkmcnt(0)
  v_mfma_f32_16x16x32_bf16 v[80:83], a[156:159], a[24:27], v[80:83]
  v_mfma_f32_16x16x32_bf16 v[84:87], a[156:159], a[28:31], v[84:87]
  buffer_load_dwordx4 a[132:135], v1, s[32:35], s60 offen offset:1024 sc1
  v_pk_mul_f32 v[88:89], v[72:73], v[20:21]
  v_pk_mul_f32 v[92:93], v[76:77], v[20:21]
  v_pk_mul_f32 v[90:91], v[74:75], v[22:23]
  v_pk_mul_f32 v[94:95], v[78:79], v[22:23]
  v_pk_fma_f32 v[88:89], v[76:77], v[24:25], v[88:89]
  v_pk_fma_f32 v[92:93], v[72:73], v[24:25], v[92:93] neg_lo:[1,0,0] neg_hi:[1,0,0]
  v_pk_fma_f32 v[90:91], v[78:79], v[26:27], v[90:91]
  v_pk_fma_f32 v[94:95], v[74:75], v[26:27], v[94:95] neg_lo:[1,0,0] neg_hi:[1,0,0]
  v_cvt_pk_bf16_f32 v20, v88, v92
  v_cvt_pk_bf16_f32 v24, v92, -v88
  v_cvt_pk_bf16_f32 v21, v89, v93
  v_cvt_pk_bf16_f32 v25, v93, -v89
  v_cvt_pk_bf16_f32 v22, v90, v94
  v_cvt_pk_bf16_f32 v26, v94, -v90
  v_cvt_pk_bf16_f32 v23, v91, v95
  v_cvt_pk_bf16_f32 v27, v95, -v91
  v_pk_mul_f32 v[72:73], v[80:81], v[28:29]
  v_pk_mul_f32 v[76:77], v[84:85], v[28:29]
  v_pk_mul_f32 v[74:75], v[82:83], v[30:31]
  v_pk_mul_f32 v[78:79], v[86:87], v[30:31]
  v_pk_fma_f32 v[72:73], v[84:85], v[32:33], v[72:73]
  v_pk_fma_f32 v[76:77], v[80:81], v[32:33], v[76:77] neg_lo:[1,0,0] neg_hi:[1,0,0]
  v_pk_fma_f32 v[74:75], v[86:87], v[34:35], v[74:75]
  v_pk_fma_f32 v[78:79], v[82:83], v[34:35], v[78:79] neg_lo:[1,0,0] neg_hi:[1,0,0]
  v_mfma_f32_16x16x32_bf16 v[28:31], a[32:35], v[20:23], 0
  v_cvt_pk_bf16_f32 v32, v72, v76
  v_cvt_pk_bf16_f32 v80, v76, -v72
  v_mfma_f32_16x16x32_bf16 v[84:87], a[32:35], v[24:27], 0
  v_cvt_pk_bf16_f32 v33, v73, v77
  v_cvt_pk_bf16_f32 v81, v77, -v73
  v_cvt_pk_bf16_f32 v34, v74, v78
  v_cvt_pk_bf16_f32 v82, v78, -v74
  v_cvt_pk_bf16_f32 v35, v75, v79
  v_cvt_pk_bf16_f32 v83, v79, -v75
  v_mfma_f32_16x16x32_bf16 v[72:75], a[40:43], v[20:23], 0
  s_add_u32 s60, s42, s38
  buffer_load_dwordx4 a[136:139], v1, s[32:35], s60 offen offset:0 sc1
  v_mfma_f32_16x16x32_bf16 v[20:23], a[40:43], v[24:27], 0
  buffer_load_dwordx4 a[140:143], v1, s[32:35], s60 offen offset:1024 sc1
  v_mfma_f32_16x16x32_bf16 v[28:31], a[36:39], v[32:35], v[28:31]
  v_mfma_f32_16x16x32_bf16 v[84:87], a[36:39], v[80:83], v[84:87]
  v_mfma_f32_16x16x32_bf16 v[72:75], a[44:47], v[32:35], v[72:75]
  s_add_u32 s60, s43, s38
  buffer_load_dwordx4 a[144:147], v1, s[32:35], s60 offen offset:0 sc1
  v_mfma_f32_16x16x32_bf16 v[20:23], a[44:47], v[80:83], v[20:23]
  s_nop 2
  v_pk_mul_f32 v[24:25], v[28:29], v[64:65]
  v_pk_mul_f32 v[32:33], v[84:85], v[64:65]
  v_pk_mul_f32 v[26:27], v[30:31], v[66:67]
  v_pk_mul_f32 v[34:35], v[86:87], v[66:67]
  v_pk_fma_f32 v[24:25], v[84:85], v[52:53], v[24:25] neg_lo:[1,0,0] neg_hi:[1,0,0]
  v_pk_fma_f32 v[32:33], v[28:29], v[52:53], v[32:33]
  v_pk_fma_f32 v[26:27], v[86:87], v[54:55], v[26:27] neg_lo:[1,0,0] neg_hi:[1,0,0]
  v_pk_fma_f32 v[34:35], v[30:31], v[54:55], v[34:35]
  v_cvt_pk_bf16_f32 v28, v24, -v32
  v_cvt_pk_bf16_f32 v52, v32, v24
  v_cvt_pk_bf16_f32 v29, v25, -v33
  v_cvt_pk_bf16_f32 v53, v33, v25
  v_cvt_pk_bf16_f32 v30, v26, -v34
  v_cvt_pk_bf16_f32 v54, v34, v26
  v_cvt_pk_bf16_f32 v31, v27, -v35
  v_cvt_pk_bf16_f32 v55, v35, v27
  v_pk_mul_f32 v[24:25], v[72:73], v[68:69]
  v_pk_mul_f32 v[32:33], v[20:21], v[68:69]
  v_pk_mul_f32 v[26:27], v[74:75], v[70:71]
  v_pk_mul_f32 v[34:35], v[22:23], v[70:71]
  v_pk_fma_f32 v[24:25], v[20:21], v[56:57], v[24:25] neg_lo:[1,0,0] neg_hi:[1,0,0]
  v_pk_fma_f32 v[32:33], v[72:73], v[56:57], v[32:33]
  v_pk_fma_f32 v[26:27], v[22:23], v[58:59], v[26:27] neg_lo:[1,0,0] neg_hi:[1,0,0]
  v_pk_fma_f32 v[34:35], v[74:75], v[58:59], v[34:35]
  v_mfma_f32_16x16x32_bf16 v[20:23], v[28:31], a[32:35], 0
  v_cvt_pk_bf16_f32 v56, v24, -v32
  v_cvt_pk_bf16_f32 v64, v32, v24
  v_mfma_f32_16x16x32_bf16 v[68:71], v[52:55], a[32:35], 0
  v_cvt_pk_bf16_f32 v57, v25, -v33
  v_cvt_pk_bf16_f32 v65, v33, v25
  v_cvt_pk_bf16_f32 v58, v26, -v34
  v_cvt_pk_bf16_f32 v66, v34, v26
  v_cvt_pk_bf16_f32 v59, v27, -v35
  v_cvt_pk_bf16_f32 v67, v35, v27
  v_mfma_f32_16x16x32_bf16 v[24:27], v[28:31], a[40:43], 0
  buffer_load_dwordx4 a[32:35], v1, s[32:35], s60 offen offset:1024 sc1
  s_add_u32 s60, s44, s38
  buffer_load_dwordx4 a[148:151], v1, s[32:35], s60 offen offset:0 sc1
  v_mfma_f32_16x16x32_bf16 v[28:31], v[52:55], a[40:43], 0
  v_mfma_f32_16x16x32_bf16 v[20:23], v[56:59], a[36:39], v[20:23]
  buffer_load_dwordx4 a[40:43], v1, s[32:35], s60 offen offset:1024 sc1
  v_mfma_f32_16x16x32_bf16 v[68:71], v[64:67], a[36:39], v[68:71]
  v_mfma_f32_16x16x32_bf16 v[24:27], v[56:59], a[44:47], v[24:27]
  v_mfma_f32_16x16x32_bf16 v[28:31], v[64:67], a[44:47], v[28:31]
  s_nop 3
  v_pk_mul_f32 v[32:33], v[20:21], v[36:37]
  s_nop 0
  v_pk_mul_f32 v[52:53], v[68:69], v[36:37]
  v_pk_mul_f32 v[34:35], v[22:23], v[38:39]
  v_pk_mul_f32 v[54:55], v[70:71], v[38:39]
  v_pk_fma_f32 v[32:33], v[68:69], v[40:41], v[32:33] neg_lo:[1,0,0] neg_hi:[1,0,0]
  v_pk_fma_f32 v[52:53], v[20:21], v[40:41], v[52:53]
  v_pk_fma_f32 v[34:35], v[70:71], v[42:43], v[34:35] neg_lo:[1,0,0] neg_hi:[1,0,0]
  v_pk_fma_f32 v[54:55], v[22:23], v[42:43], v[54:55]
  v_pk_mul_f32 v[20:21], v[24:25], v[44:45]
  v_pk_mul_f32 v[36:37], v[28:29], v[44:45]
  v_pk_mul_f32 v[22:23], v[26:27], v[46:47]
  v_pk_mul_f32 v[38:39], v[30:31], v[46:47]
  v_cvt_pk_bf16_f32 v40, v32, -v52
  v_cvt_pk_bf16_f32 v41, v33, -v53
  v_cvt_pk_bf16_f32 v42, v34, -v54
  v_cvt_pk_bf16_f32 v43, v35, -v55
  v_pk_fma_f32 v[20:21], v[28:29], v[48:49], v[20:21] neg_lo:[1,0,0] neg_hi:[1,0,0]
  v_pk_fma_f32 v[36:37], v[24:25], v[48:49], v[36:37]
  v_pk_fma_f32 v[22:23], v[30:31], v[50:51], v[22:23] neg_lo:[1,0,0] neg_hi:[1,0,0]
  v_pk_fma_f32 v[38:39], v[26:27], v[50:51], v[38:39]
  ds_write_b128 v2, v[40:43] offset:0
  v_cvt_pk_bf16_f32 v24, v20, -v36
  v_cvt_pk_bf16_f32 v25, v21, -v37
  v_cvt_pk_bf16_f32 v26, v22, -v38
  v_cvt_pk_bf16_f32 v27, v23, -v39
  ds_write_b128 v2, v[24:27] offset:1024
  s_add_u32 s60, s48, s38
  buffer_load_dwordx4 a[36:39], v1, s[32:35], s60 offen offset:0 sc1
  buffer_load_dwordx4 a[44:47], v1, s[32:35], s60 offen offset:1024 sc1
  s_add_u32 s60, s49, s38
  buffer_load_dwordx4 a[152:155], v1, s[32:35], s60 offen offset:0 sc1
  s_waitcnt lgkmcnt(0)
  s_barrier
  ds_read_b128 v[20:23], v4 offset:0
  ds_read_b128 v[24:27], v4 offset:1024
  ds_read_b128 v[28:31], v4 offset:8192
  ds_read_b128 v[32:35], v4 offset:9216
  ds_read_b128 v[36:39], v4 offset:16384
  ds_read_b128 v[40:43], v4 offset:17408
  ds_read_b128 v[44:47], v4 offset:24576
  ds_read_b128 v[48:51], v4 offset:25600
  buffer_load_dwordx4 a[156:159], v1, s[32:35], s60 offen offset:1024 sc1
  s_waitcnt lgkmcnt(7)
  v_mfma_f32_16x16x32_bf16 v[52:55], v[20:23], a[0:3], 0
  s_waitcnt lgkmcnt(6)
  v_mfma_f32_16x16x32_bf16 v[56:59], v[24:27], a[0:3], 0
  s_add_u32 s60, s50, s38
  buffer_load_dwordx4 a[0:3], v1, s[32:35], s60 offen offset:0 sc1
  v_mfma_f32_16x16x32_bf16 v[64:67], v[20:23], a[4:7], 0
  v_mfma_f32_16x16x32_bf16 v[20:23], v[24:27], a[4:7], 0
  s_waitcnt lgkmcnt(5)
  v_mfma_f32_16x16x32_bf16 v[52:55], v[28:31], a[8:11], v[52:55]
  s_waitcnt lgkmcnt(4)
  v_mfma_f32_16x16x32_bf16 v[56:59], v[32:35], a[8:11], v[56:59]
  v_mfma_f32_16x16x32_bf16 v[64:67], v[28:31], a[12:15], v[64:67]
  buffer_load_dwordx4 a[4:7], v1, s[32:35], s60 offen offset:1024 sc1
  s_add_u32 m0, s65, 0x11000
  s_nop 0
  buffer_load_dwordx4 v3, s[24:27], s45 offen offset:0 lds
  buffer_load_dwordx4 v16, s[24:27], s45 offen offset:1024 lds
  buffer_load_dwordx4 v18, s[24:27], s45 offen offset:2048 lds
  buffer_load_dwordx4 v19, s[24:27], s45 offen offset:3072 lds
  v_mfma_f32_16x16x32_bf16 v[20:23], v[32:35], a[12:15], v[20:23]
  s_waitcnt lgkmcnt(3)
  v_mfma_f32_16x16x32_bf16 v[52:55], v[36:39], a[16:19], v[52:55]
  s_waitcnt lgkmcnt(2)
  v_mfma_f32_16x16x32_bf16 v[56:59], v[40:43], a[16:19], v[56:59]
  v_mfma_f32_16x16x32_bf16 v[64:67], v[36:39], a[20:23], v[64:67]
  v_mfma_f32_16x16x32_bf16 v[20:23], v[40:43], a[20:23], v[20:23]
  s_waitcnt lgkmcnt(1)
  v_mfma_f32_16x16x32_bf16 v[52:55], v[44:47], a[24:27], v[52:55]
  s_waitcnt lgkmcnt(0)
  v_mfma_f32_16x16x32_bf16 v[56:59], v[48:51], a[24:27], v[56:59]
  v_mfma_f32_16x16x32_bf16 v[64:67], v[44:47], a[28:31], v[64:67]
  s_nop 4
  v_cvt_pk_bf16_f32 v24, v52, v53
  v_cvt_pk_bf16_f32 v25, v54, v55
  v_mfma_f32_16x16x32_bf16 v[20:23], v[48:51], a[28:31], v[20:23]
  v_cvt_pk_bf16_f32 v26, v56, v57
  v_cvt_pk_bf16_f32 v27, v58, v59
  buffer_store_dwordx4 v[24:27], v63, s[32:35], s40 offen sc1
  s_nop 1
  v_cvt_pk_bf16_f32 v24, v64, v65
  v_cvt_pk_bf16_f32 v25, v66, v67
  s_nop 0
  v_cvt_pk_bf16_f32 v26, v20, v21
  v_cvt_pk_bf16_f32 v27, v22, v23
  buffer_store_dwordx4 v[24:27], v63, s[32:35], s39 offen sc1
  s_waitcnt vmcnt(19)
  s_nop 0
  v_mfma_f32_32x32x16_bf16 v[20:35], a[48:51], a[128:131], 0
  s_add_u32 s39, s51, s38
  buffer_load_dwordx4 a[8:11], v1, s[32:35], s39 offen offset:0 sc1
  s_lshl_b32 s40, s56, 8
  s_add_u32 s40, s40, s62
  s_lshl_b32 s40, s40, 2
  s_add_u32 s40, s40, 0xa0000
  s_add_u32 s45, s38, 0x1c000
  v_mfma_f32_32x32x16_bf16 a[12:27], a[52:55], a[128:131], 0
  buffer_load_dwordx4 a[28:31], v1, s[32:35], s39 offen offset:1024 sc1
  v_and_b32 v2, 31, v6
  v_xor_b32 v2, s36, v2
  s_lshl_b32 s39, s64, 6
  v_add_u32 v2, s39, v2
  v_lshrrev_b32 v3, 5, v6
  v_lshlrev_b32 v3, 1, v3
  s_waitcnt vmcnt(20)
  v_mfma_f32_32x32x16_bf16 v[20:35], a[56:59], a[132:135], v[20:35]
  s_lshl_b32 s39, s56, 5
  v_add_u32 v3, s39, v3
  v_cvt_f32_u32 v4, v3
  v_cmp_eq_u32 s[60:61], 0, v3
  v_and_b32 v3, 1, v2
  v_mul_u32_u24 v16, 0x202, v3
  v_lshl_or_b32 v16, v16, 16, v16
  v_mfma_f32_32x32x16_bf16 a[12:27], a[60:63], a[132:135], a[12:27]
  s_add_u32 s39, s53, s38
  buffer_load_dwordx4 a[128:131], v1, s[32:35], s39 offen offset:0 sc1
  v_xor_b32 v16, 0x3020100, v16
  v_add_u32 v18, 1, v2
  v_and_b32 v18, 2, v18
  v_lshlrev_b32 v19, 14, v18
  v_and_b32 v18, 2, v2
  s_waitcnt vmcnt(20)
  v_mfma_f32_32x32x16_bf16 v[20:35], a[64:67], a[136:139], v[20:35]
  v_lshl_or_b32 v19, v18, 30, v19
  v_lshlrev_b32 v3, 15, v3
  v_or_b32 v3, 0x3f00, v3
  v_cvt_f32_u32 v18, v2
  v_mul_f32 v18, 0x3b000000, v18
  v_mul_f32 v36, v18, v4
  v_cos_f32 v37, v36
  v_mfma_f32_32x32x16_bf16 a[12:27], a[68:71], a[136:139], a[12:27]
  buffer_load_dwordx4 a[132:135], v1, s[32:35], s39 offen offset:1024 sc1
  v_sin_f32 v38, v36
  v_fmamk_f32 v39, v18, 0x3f800000, v36
  v_cos_f32 v40, v39
  s_waitcnt vmcnt(20)
  v_mfma_f32_32x32x16_bf16 v[20:35], a[72:75], a[140:143], v[20:35]
  v_sin_f32 v41, v39
  v_cvt_pk_bf16_f32 v44, v37, v38
  v_perm_b32 v48, v44, v44, v16
  v_xor_b32 v48, v48, v19
  v_cndmask_b32 v44, v44, v3, s[60:61]
  v_fmamk_f32 v37, v18, 0x40800000, v36
  v_mfma_f32_32x32x16_bf16 a[12:27], a[76:79], a[140:143], a[12:27]
  s_add_u32 s39, s54, s38
  buffer_load_dwordx4 a[136:139], v1, s[32:35], s39 offen offset:0 sc1
  v_cos_f32 v38, v37
  v_sin_f32 v39, v37
  v_cvt_pk_bf16_f32 v45, v40, v41
  s_waitcnt vmcnt(20)
  v_mfma_f32_32x32x16_bf16 v[20:35], a[80:83], a[144:147], v[20:35]
  v_perm_b32 v49, v45, v45, v16
  v_xor_b32 v49, v49, v19
  v_fmamk_f32 v37, v18, 0x40a00000, v36
  v_cos_f32 v40, v37
  v_sin_f32 v41, v37
  v_mfma_f32_32x32x16_bf16 a[12:27], a[84:87], a[144:147], a[12:27]
  v_cvt_pk_bf16_f32 v46, v38, v39
  v_perm_b32 v50, v46, v46, v16
  v_xor_b32 v50, v50, v19
  v_fmamk_f32 v37, v18, 0x41000000, v36
  v_cos_f32 v38, v37
  v_sin_f32 v39, v37
  s_waitcnt vmcnt(19)
  v_mfma_f32_32x32x16_bf16 v[20:35], a[88:91], a[32:35], v[20:35]
  v_cvt_pk_bf16_f32 v47, v40, v41
  v_perm_b32 v51, v47, v47, v16
  v_xor_b32 v51, v51, v19
  v_fmamk_f32 v37, v18, 0x41100000, v36
  v_cos_f32 v40, v37
  v_mfma_f32_32x32x16_bf16 a[12:27], a[92:95], a[32:35], a[12:27]
  v_sin_f32 v41, v37
  v_cvt_pk_bf16_f32 v52, v38, v39
  v_perm_b32 v56, v52, v52, v16
  v_xor_b32 v56, v56, v19
  v_fmamk_f32 v37, v18, 0x41400000, v36
  v_cos_f32 v38, v37
  s_waitcnt vmcnt(18)
  v_mfma_f32_32x32x16_bf16 v[20:35], a[96:99], a[148:151], v[20:35]
  v_sin_f32 v39, v37
  v_cvt_pk_bf16_f32 v53, v40, v41
  v_perm_b32 v57, v53, v53, v16
  v_xor_b32 v57, v57, v19
  v_fmamk_f32 v37, v18, 0x41500000, v36
  v_mfma_f32_32x32x16_bf16 a[12:27], a[100:103], a[148:151], a[12:27]
  v_cos_f32 v40, v37
  v_sin_f32 v41, v37
  v_cvt_pk_bf16_f32 v54, v38, v39
  v_perm_b32 v58, v54, v54, v16
  v_xor_b32 v58, v58, v19
  s_waitcnt vmcnt(17)
  v_mfma_f32_32x32x16_bf16 v[20:35], a[104:107], a[40:43], v[20:35]
  v_fmamk_f32 v37, v18, 0x41800000, v36
  v_cos_f32 v38, v37
  v_sin_f32 v39, v37
  v_cvt_pk_bf16_f32 v55, v40, v41
  v_perm_b32 v59, v55, v55, v16
  v_mfma_f32_32x32x16_bf16 a[12:27], a[108:111], a[40:43], a[12:27]
  v_xor_b32 v59, v59, v19
  v_fmamk_f32 v37, v18, 0x41880000, v36
  v_cos_f32 v40, v37
  v_sin_f32 v41, v37
  v_cvt_pk_bf16_f32 v60, v38, v39
  s_waitcnt vmcnt(16)
  v_mfma_f32_32x32x16_bf16 v[20:35], a[112:115], a[36:39], v[20:35]
  ds_read_b64_tr_b16 a[32:33], v8 offset:36864
  ds_read_b64_tr_b16 a[34:35], v8 offset:37888
  ds_read_b64_tr_b16 a[40:41], v5 offset:36864
  ds_read_b64_tr_b16 a[42:43], v5 offset:37888
  v_perm_b32 v64, v60, v60, v16
  v_xor_b32 v64, v64, v19
  v_mfma_f32_32x32x16_bf16 a[12:27], a[116:119], a[36:39], a[12:27]
  v_fmamk_f32 v37, v18, 0x41a00000, v36
  v_cos_f32 v38, v37
  v_sin_f32 v39, v37
  v_cvt_pk_bf16_f32 v61, v40, v41
  v_perm_b32 v65, v61, v61, v16
  s_waitcnt vmcnt(15)
  v_mfma_f32_32x32x16_bf16 v[20:35], a[120:123], a[44:47], v[20:35]
  ds_read_b64_tr_b16 a[36:37], v8 offset:38912
  ds_read_b64_tr_b16 a[38:39], v8 offset:39936
  ds_read_b64_tr_b16 a[140:141], v5 offset:38912
  s_and_b32 s62, s52, 28
  s_add_u32 s62, s62, s56
  s_lshl_b32 s62, s62, 7
  s_add_u32 s62, s62, 0x80000
  v_mfma_f32_32x32x16_bf16 a[12:27], a[124:127], a[44:47], a[12:27]
  buffer_load_dword v37, v15, s[32:35], s62 offen sc1
  ds_read_b64_tr_b16 a[142:143], v5 offset:39936
  buffer_load_dwordx4 a[44:47], v1, s[32:35], s39 offen offset:1024 sc1
  v_xor_b32 v65, v65, v19
  v_fmamk_f32 v40, v18, 0x41a80000, v36
  v_cos_f32 v41, v40
  s_waitcnt vmcnt(16) lgkmcnt(6)
  v_mfma_f32_32x32x16_bf16 v[20:35], a[32:35], a[152:155], v[20:35]
  ds_read_b64_tr_b16 a[144:145], v7 offset:0
  ds_read_b64_tr_b16 a[146:147], v7 offset:1024
  ds_read_b64_tr_b16 a[148:149], v10 offset:0
  ds_read_b64_tr_b16 a[150:151], v10 offset:1024
  v_sin_f32 v42, v40
  s_waitcnt lgkmcnt(8)
  v_mfma_f32_32x32x16_bf16 a[12:27], a[40:43], a[152:155], a[12:27]
  v_cvt_pk_bf16_f32 v62, v38, v39
  v_perm_b32 v66, v62, v62, v16
  v_xor_b32 v66, v66, v19
  v_fmamk_f32 v38, v18, 0x41c00000, v36
  v_cos_f32 v39, v38
  v_sin_f32 v40, v38
  s_waitcnt vmcnt(15) lgkmcnt(6)
  v_mfma_f32_32x32x16_bf16 v[20:35], a[36:39], a[156:159], v[20:35]
  ds_read_b64_tr_b16 a[152:153], v7 offset:2048
  ds_read_b64_tr_b16 a[154:155], v7 offset:3072
  ds_read_b64_tr_b16 a[160:161], v10 offset:2048
  s_waitcnt vmcnt(7)
  buffer_store_dword v9, v13, s[32:35], s40 offen sc1
  ds_read_b64_tr_b16 a[162:163], v10 offset:3072
  s_waitcnt lgkmcnt(8)
  v_mfma_f32_32x32x16_bf16 a[12:27], a[140:143], a[156:159], a[12:27]
  s_add_u32 s39, s55, s38
  buffer_load_dwordx4 a[156:159], v1, s[32:35], s39 offen offset:0 sc1
  v_cvt_pk_bf16_f32 v63, v41, v42
  v_perm_b32 v67, v63, v63, v16
  v_xor_b32 v67, v67, v19
  v_fmamk_f32 v38, v18, 0x41c80000, v36
  v_cos_f32 v41, v38
  s_waitcnt lgkmcnt(6)
  v_mfma_f32_32x32x16_bf16 v[20:35], a[144:147], a[0:3], v[20:35]
  ds_read_b64_tr_b16 a[164:165], v7 offset:4096
  ds_read_b64_tr_b16 a[166:167], v7 offset:5120
  ds_read_b64_tr_b16 a[168:169], v10 offset:4096
  ds_read_b64_tr_b16 a[170:171], v10 offset:5120
  v_sin_f32 v42, v38
  s_waitcnt lgkmcnt(8)
  v_mfma_f32_32x32x16_bf16 a[12:27], a[148:151], a[0:3], a[12:27]
  buffer_load_dwordx4 a[0:3], v1, s[32:35], s39 offen offset:1024 sc1
  v_cvt_pk_bf16_f32 v68, v39, v40
  v_perm_b32 v72, v68, v68, v16
  v_xor_b32 v72, v72, v19
  v_fmamk_f32 v38, v18, 0x41e00000, v36
  v_cos_f32 v39, v38
  s_waitcnt lgkmcnt(6)
  v_mfma_f32_32x32x16_bf16 v[20:35], a[152:155], a[4:7], v[20:35]
  ds_read_b64_tr_b16 a[172:173], v7 offset:6144
  ds_read_b64_tr_b16 a[174:175], v7 offset:7168
  ds_read_b64_tr_b16 a[176:177], v10 offset:6144
  ds_read_b64_tr_b16 a[178:179], v10 offset:7168
  v_sin_f32 v40, v38
  s_waitcnt lgkmcnt(8)
  v_mfma_f32_32x32x16_bf16 a[12:27], a[160:163], a[4:7], a[12:27]
  s_add_u32 s39, s57, s38
  buffer_load_dwordx4 a[4:7], v1, s[32:35], s39 offen offset:0 sc1
  v_cvt_pk_bf16_f32 v69, v41, v42
  v_perm_b32 v73, v69, v69, v16
  v_xor_b32 v73, v73, v19
  v_fmamk_f32 v38, v18, 0x41e80000, v36
  v_cos_f32 v18, v38
  s_waitcnt vmcnt(10) lgkmcnt(6)
  v_mfma_f32_32x32x16_bf16 v[20:35], a[164:167], a[8:11], v[20:35]
  ds_read_b64_tr_b16 a[180:181], v7 offset:32768
  ds_read_b64_tr_b16 a[182:183], v7 offset:33792
  ds_read_b64_tr_b16 a[184:185], v10 offset:32768
  ds_read_b64_tr_b16 a[186:187], v10 offset:33792
  v_sin_f32 v36, v38
  s_waitcnt lgkmcnt(8)
  v_mfma_f32_32x32x16_bf16 a[12:27], a[168:171], a[8:11], a[12:27]
  buffer_load_dwordx4 a[8:11], v1, s[32:35], s39 offen offset:1024 sc1
  v_cvt_pk_bf16_f32 v70, v39, v40
  v_perm_b32 v74, v70, v70, v16
  v_xor_b32 v74, v74, v19
  v_xor_b32 v38, 32, v2
  v_cvt_f32_u32 v2, v38
  s_waitcnt vmcnt(10) lgkmcnt(6)
  v_mfma_f32_32x32x16_bf16 v[20:35], a[172:175], a[28:31], v[20:35]
  ds_read_b64_tr_b16 a[188:189], v7 offset:34816
  ds_read_b64_tr_b16 a[190:191], v7 offset:35840
  ds_read_b64_tr_b16 a[192:193], v10 offset:34816
  ds_read_b64_tr_b16 a[194:195], v10 offset:35840
  v_mul_f32 v2, 0x3b000000, v2
  v_mul_f32 v7, v2, v4
  v_cos_f32 v4, v7
  s_waitcnt lgkmcnt(8)
  v_mfma_f32_32x32x16_bf16 a[12:27], a[176:179], a[28:31], a[12:27]
  s_add_u32 s39, s58, s38
  buffer_load_dwordx4 a[28:31], v1, s[32:35], s39 offen offset:0 sc1
  v_sin_f32 v10, v7
  v_cvt_pk_bf16_f32 v71, v18, v36
  v_perm_b32 v75, v71, v71, v16
  s_waitcnt vmcnt(10) lgkmcnt(6)
  v_mfma_f32_32x32x16_bf16 v[20:35], a[180:183], a[128:131], v[20:35]
  ds_read_b64_tr_b16 a[196:197], v11 offset:0
  ds_read_b64_tr_b16 a[198:199], v11 offset:1024
  ds_read_b64_tr_b16 a[200:201], v12 offset:0
  ds_read_b64_tr_b16 a[202:203], v12 offset:1024
  v_xor_b32 v75, v75, v19
  v_fmamk_f32 v18, v2, 0x3f800000, v7
  s_waitcnt lgkmcnt(8)
  v_mfma_f32_32x32x16_bf16 a[12:27], a[184:187], a[128:131], a[12:27]
  buffer_load_dwordx4 a[128:131], v1, s[32:35], s39 offen offset:1024 sc1
  v_cos_f32 v36, v18
  v_sin_f32 v38, v18
  v_cvt_pk_bf16_f32 v40, v4, v10
  v_perm_b32 v76, v40, v40, v16
  s_waitcnt vmcnt(10) lgkmcnt(6)
  v_mfma_f32_32x32x16_bf16 v[20:35], a[188:191], a[132:135], v[20:35]
  ds_read_b64_tr_b16 a[204:205], v11 offset:2048
  ds_read_b64_tr_b16 a[206:207], v11 offset:3072
  ds_read_b64_tr_b16 a[208:209], v12 offset:2048
  ds_read_b64_tr_b16 a[210:211], v12 offset:3072
  v_xor_b32 v76, v76, v19
  v_cndmask_b32 v40, v40, v3, s[60:61]
  v_fmamk_f32 v3, v2, 0x40800000, v7
  s_waitcnt lgkmcnt(8)
  v_mfma_f32_32x32x16_bf16 a[12:27], a[192:195], a[132:135], a[12:27]
  s_add_u32 s39, s59, s38
  buffer_load_dwordx4 a[132:135], v1, s[32:35], s39 offen offset:0 sc1
  v_cos_f32 v4, v3
  v_sin_f32 v10, v3
  v_cvt_pk_bf16_f32 v41, v36, v38
  s_waitcnt vmcnt(10) lgkmcnt(6)
  v_mfma_f32_32x32x16_bf16 v[20:35], a[196:199], a[136:139], v[20:35]
  ds_read_b64_tr_b16 a[212:213], v11 offset:4096
  ds_read_b64_tr_b16 a[214:215], v11 offset:5120
  ds_read_b64_tr_b16 a[216:217], v12 offset:4096
  ds_read_b64_tr_b16 a[218:219], v12 offset:5120
  v_perm_b32 v77, v41, v41, v16
  v_xor_b32 v77, v77, v19
  s_waitcnt lgkmcnt(8)
  v_mfma_f32_32x32x16_bf16 a[12:27], a[200:203], a[136:139], a[12:27]
  buffer_load_dwordx4 a[136:139], v1, s[32:35], s39 offen offset:1024 sc1
  v_fmamk_f32 v3, v2, 0x40a00000, v7
  v_cos_f32 v18, v3
  v_sin_f32 v36, v3
  v_cvt_pk_bf16_f32 v42, v4, v10
  s_waitcnt vmcnt(9) lgkmcnt(6)
  v_mfma_f32_32x32x16_bf16 v[20:35], a[204:207], a[44:47], v[20:35]
  ds_read_b64_tr_b16 a[220:221], v11 offset:6144
  ds_read_b64_tr_b16 a[222:223], v11 offset:7168
  ds_read_b64_tr_b16 a[224:225], v12 offset:6144
  ds_read_b64_tr_b16 a[226:227], v12 offset:7168
  v_perm_b32 v78, v42, v42, v16
  v_xor_b32 v78, v78, v19
  v_fmamk_f32 v3, v2, 0x41000000, v7
  s_waitcnt lgkmcnt(8)
  v_mfma_f32_32x32x16_bf16 a[12:27], a[208:211], a[44:47], a[12:27]
  v_cos_f32 v4, v3
  v_sin_f32 v10, v3
  v_cvt_pk_bf16_f32 v43, v18, v36
  v_perm_b32 v79, v43, v43, v16
  v_xor_b32 v79, v79, v19
  s_waitcnt vmcnt(7) lgkmcnt(6)
  v_mfma_f32_32x32x16_bf16 v[20:35], a[212:215], a[156:159], v[20:35]
  ds_read_b64_tr_b16 a[44:45], v8 offset:0
  ds_read_b64_tr_b16 a[46:47], v8 offset:1024
  v_cmp_ne_u32 vcc, s46, v37
  s_nop 0
  s_cbranch_vccnz L_poll17
L_back17:
  s_add_u32 s38, s41, s45
  buffer_load_dwordx4 a[228:231], v1, s[32:35], s38 offen offset:0 sc1
  s_waitcnt lgkmcnt(6)
  v_mfma_f32_32x32x16_bf16 a[12:27], a[216:219], a[156:159], a[12:27]
  ds_read_b64_tr_b16 a[156:157], v5 offset:0
  ds_read_b64_tr_b16 a[158:159], v5 offset:1024
  buffer_load_dwordx4 a[232:235], v1, s[32:35], s38 offen offset:1024 sc1
  v_add_u32 v3, s65, v1
  v_add_u32 v3, 0x10000, v3
  v_add_u32 v11, 0x10000, v3
  v_xor_b32 v12, 0x2000, v3
  s_waitcnt vmcnt(8) lgkmcnt(6)
  v_mfma_f32_32x32x16_bf16 v[20:35], a[220:223], a[0:3], v[20:35]
  ds_read_b64_tr_b16 a[236:237], v8 offset:2048
  ds_read_b64_tr_b16 a[238:239], v8 offset:3072
  ds_read_b64_tr_b16 a[240:241], v5 offset:2048
  ds_read_b64_tr_b16 a[242:243], v5 offset:3072
  v_xor_b32 v15, 0x4000, v3
  v_xor_b32 v18, 0x6000, v3
  v_xor_b32 v36, 0x2000, v11
  s_waitcnt lgkmcnt(8)
  v_mfma_f32_32x32x16_bf16 a[12:27], a[224:227], a[0:3], a[12:27]
  s_add_u32 s38, s42, s45
  buffer_load_dwordx4 a[0:3], v1, s[32:35], s38 offen offset:0 sc1
  v_xor_b32 v37, 0x4000, v11
  v_xor_b32 v38, 0x6000, v11
  s_mov_b32 s39, 0x49000000
  v_fmamk_f32 v39, v2, 0x41100000, v7
  v_cos_f32 v80, v39
  s_waitcnt vmcnt(8) lgkmcnt(6)
  v_mfma_f32_32x32x16_bf16 v[20:35], a[44:47], a[4:7], v[20:35]
  ds_read_b64_tr_b16 a[244:245], v8 offset:4096
  ds_read_b64_tr_b16 a[246:247], v8 offset:5120
  ds_read_b64_tr_b16 a[248:249], v5 offset:4096
  ds_read_b64_tr_b16 a[250:251], v5 offset:5120
  v_bfe_u32 v81, v6, 4, 1
  s_waitcnt lgkmcnt(8)
  v_mfma_f32_32x32x16_bf16 a[12:27], a[156:159], a[4:7], a[12:27]
  buffer_load_dwordx4 a[4:7], v1, s[32:35], s38 offen offset:1024 sc1
  v_lshlrev_b32 v81, 13, v81
  v_and_b32 v82, 15, v6
  v_lshl_add_u32 v81, v82, 7, v81
  s_lshr_b32 s38, s36, 3
  v_and_b32 v82, 7, v6
  v_xor_b32 v82, s38, v82
  s_waitcnt vmcnt(8) lgkmcnt(6)
  v_mfma_f32_32x32x16_bf16 v[20:35], a[236:239], a[8:11], v[20:35]
  ds_read_b64_tr_b16 a[252:253], v8 offset:6144
  ds_read_b64_tr_b16 a[254:255], v8 offset:7168
  ds_read_b64_tr_b16 v[84:85], v5 offset:6144
  ds_read_b64_tr_b16 v[86:87], v5 offset:7168
  v_lshl_add_u32 v81, v82, 4, v81
  v_lshrrev_b32 v82, 5, v6
  v_lshl_add_u32 v81, v82, 3, v81
  s_waitcnt lgkmcnt(8)
  v_mfma_f32_32x32x16_bf16 a[12:27], a[240:243], a[8:11], a[12:27]
  s_add_u32 s38, s43, s45
  buffer_load_dwordx4 a[8:11], v1, s[32:35], s38 offen offset:0 sc1
  v_add_u32 v82, 0x19800, v81
  v_xor_b32 v81, 16, v82
  v_sin_f32 v83, v39
  v_cvt_pk_bf16_f32 v88, v4, v10
  s_waitcnt vmcnt(8) lgkmcnt(6)
  v_mfma_f32_32x32x16_bf16 v[20:35], a[244:247], a[28:31], v[20:35]
  ds_read_b64_tr_b16 v[92:93], v8 offset:32768
  ds_read_b64_tr_b16 v[94:95], v8 offset:33792
  ds_read_b64_tr_b16 v[96:97], v5 offset:32768
  ds_read_b64_tr_b16 v[98:99], v5 offset:33792
  v_lshrrev_b32 v4, 3, v6
  v_mul_u32_u24 v4, 0x1080, v4
  s_waitcnt lgkmcnt(8)
  v_mfma_f32_32x32x16_bf16 a[12:27], a[248:251], a[28:31], a[12:27]
  buffer_load_dwordx4 a[28:31], v1, s[32:35], s38 offen offset:1024 sc1
  v_add_u32 v10, v4, v17
  v_add_u32 v4, 0x8000, v10
  v_add_u32 v17, 0x10000, v10
  v_add_u32 v39, 0x18000, v10
  s_mul_i32 s38, s56, 0x42000
  s_lshl_b32 s40, s52, 7
  s_waitcnt vmcnt(8) lgkmcnt(6)
  v_mfma_f32_32x32x16_bf16 v[20:35], a[252:255], a[128:131], v[20:35]
  ds_read_b64_tr_b16 v[100:101], v8 offset:34816
  ds_read_b64_tr_b16 v[102:103], v8 offset:35840
  ds_read_b64_tr_b16 v[104:105], v5 offset:34816
  v_lshrrev_b32 v8, 3, v6
  v_xor_b32 v108, v8, v6
  v_and_b32 v108, 7, v108
  v_lshlrev_b32 v108, 4, v108
  s_waitcnt lgkmcnt(7)
  v_mfma_f32_32x32x16_bf16 a[12:27], v[84:87], a[128:131], a[12:27]
  v_lshl_add_u32 v109, v8, 10, v108
  v_add_u32 v8, 0x1c00, v109
  s_lshl_b32 s41, s52, 16
  s_add_u32 s41, s41, s37
  s_lshl_b32 s37, s56, 14
  s_add_u32 s37, s37, s41
  s_add_u32 m0, s65, 0x19800
  s_nop 0
  buffer_load_dwordx4 v109, s[4:7], s37 offen offset:0 lds
  buffer_load_dwordx4 v8, s[4:7], s37 offen offset:1024 lds
  ds_read_b64_tr_b16 v[106:107], v5 offset:35840
  s_waitcnt vmcnt(9) lgkmcnt(6)
  v_mfma_f32_32x32x16_bf16 v[20:35], v[92:95], a[132:135], v[20:35]
  s_add_u32 s37, s44, s45
  buffer_load_dwordx4 a[128:131], v1, s[32:35], s37 offen offset:0 sc1
  s_add_u32 s38, s38, s40
  v_lshrrev_b32 v5, 5, v6
  v_bfe_u32 v8, v6, 2, 2
  s_waitcnt lgkmcnt(4)
  v_mfma_f32_32x32x16_bf16 a[12:27], v[96:99], a[132:135], a[12:27]
  buffer_load_dwordx4 a[132:135], v1, s[32:35], s37 offen offset:1024 sc1
  v_lshl_add_u32 v5, v5, 2, v8
  v_lshlrev_b32 v5, 7, v5
  v_bfe_u32 v8, v6, 4, 1
  v_lshlrev_b32 v8, 5, v8
  v_and_b32 v108, 3, v6
  v_lshl_add_u32 v8, v108, 3, v8
  s_waitcnt vmcnt(10) lgkmcnt(2)
  v_mfma_f32_32x32x16_bf16 v[20:35], v[100:103], a[136:139], v[20:35]
  v_bfe_u32 v108, v6, 3, 1
  v_lshlrev_b32 v108, 6, v108
  v_xor_b32 v8, v8, v108
  v_add3_u32 v108, v5, v8, s65
  v_xor_b32 v5, 64, v108
  v_and_b32 v8, 31, v6
  v_lshrrev_b32 v109, 5, v6
  s_waitcnt lgkmcnt(0)
  v_mfma_f32_32x32x16_bf16 a[12:27], v[104:107], a[136:139], a[12:27]
  s_add_u32 s37, s48, s45
  buffer_load_dwordx4 a[136:139], v1, s[32:35], s37 offen offset:0 sc1
  v_lshlrev_b32 v109, 4, v109
  v_lshl_add_u32 v6, v8, 10, v109
  s_lshl_b32 s40, s36, 1
  s_add_u32 s40, s40, s41
  s_add_u32 s36, s40, 0x8000
  s_waitcnt vmcnt(10)
  v_mfma_f32_32x32x16_bf16 v[112:127], a[48:51], a[228:231], 0
  v_perm_b32 v128, v88, v88, v16
  v_xor_b32 v128, v128, v19
  v_fmamk_f32 v8, v2, 0x41400000, v7
  v_cos_f32 v109, v8
  v_sin_f32 v110, v8
  v_mfma_f32_32x32x16_bf16 v[132:147], a[52:55], a[228:231], 0
  buffer_load_dwordx4 a[48:51], v1, s[32:35], s37 offen offset:1024 sc1
  v_cvt_pk_bf16_f32 v89, v80, v83
  v_perm_b32 v129, v89, v89, v16
  v_xor_b32 v129, v129, v19
  v_fmamk_f32 v8, v2, 0x41500000, v7
  s_waitcnt vmcnt(10)
  v_mfma_f32_32x32x16_bf16 v[112:127], a[56:59], a[232:235], v[112:127]
  v_cos_f32 v80, v8
  v_sin_f32 v83, v8
  v_cvt_pk_bf16_f32 v90, v109, v110
  v_perm_b32 v130, v90, v90, v16
  v_mfma_f32_32x32x16_bf16 v[132:147], a[60:63], a[232:235], v[132:147]
  s_add_u32 s37, s49, s45
  buffer_load_dwordx4 a[52:55], v1, s[32:35], s37 offen offset:0 sc1
  ds_write_b128 v3, a[12:15] offset:0
  v_xor_b32 v130, v130, v19
  v_fmamk_f32 v8, v2, 0x41800000, v7
  v_cos_f32 v109, v8
  s_waitcnt vmcnt(10)
  v_mfma_f32_32x32x16_bf16 v[112:127], a[64:67], a[0:3], v[112:127]
  s_lshr_b32 s41, s52, 3
  s_lshl_b32 s41, s41, 3
  s_add_u32 s41, s41, s56
  s_lshl_b32 s41, s41, 7
  s_add_u32 s41, s41, 0xa0000
  v_mfma_f32_32x32x16_bf16 v[132:147], a[68:71], a[0:3], v[132:147]
  v_and_b32 v110, 0x80, v14
  v_mul_u32_u24 v110, 3, v110
  v_add_u32 v110, v110, v14
  buffer_load_dword v14, v110, s[32:35], s41 offen sc1
  buffer_load_dwordx4 a[0:3], v1, s[32:35], s37 offen offset:1024 sc1
  ds_write_b128 v3, a[16:19] offset:1024
  s_waitcnt vmcnt(11)
  v_mfma_f32_32x32x16_bf16 v[112:127], a[72:75], a[4:7], v[112:127]
  v_sin_f32 v111, v8
  v_cvt_pk_bf16_f32 v91, v80, v83
  v_perm_b32 v131, v91, v91, v16
  v_xor_b32 v131, v131, v19
  v_fmamk_f32 v8, v2, 0x41880000, v7
  v_mfma_f32_32x32x16_bf16 v[132:147], a[76:79], a[4:7], v[132:147]
  s_add_u32 s37, s50, s45
  buffer_load_dwordx4 a[4:7], v1, s[32:35], s37 offen offset:0 sc1
  ds_write_b128 v3, v[28:31] offset:2048
  v_cos_f32 v80, v8
  v_sin_f32 v83, v8
  s_waitcnt vmcnt(11)
  v_mfma_f32_32x32x16_bf16 v[112:127], a[80:83], a[8:11], v[112:127]
  v_cvt_pk_bf16_f32 v148, v109, v111
  v_perm_b32 v152, v148, v148, v16
  v_xor_b32 v152, v152, v19
  v_fmamk_f32 v8, v2, 0x41a00000, v7
  v_cos_f32 v109, v8
  v_mfma_f32_32x32x16_bf16 v[132:147], a[84:87], a[8:11], v[132:147]
  buffer_load_dwordx4 a[8:11], v1, s[32:35], s37 offen offset:1024 sc1
  ds_write_b128 v3, v[32:35] offset:3072
  v_sin_f32 v111, v8
  v_cvt_pk_bf16_f32 v149, v80, v83
  s_waitcnt vmcnt(11)
  v_mfma_f32_32x32x16_bf16 v[112:127], a[88:91], a[28:31], v[112:127]
  v_perm_b32 v153, v149, v149, v16
  v_xor_b32 v153, v153, v19
  v_fmamk_f32 v8, v2, 0x41a80000, v7
  v_cos_f32 v80, v8
  v_sin_f32 v83, v8
  v_mfma_f32_32x32x16_bf16 v[132:147], a[92:95], a[28:31], v[132:147]
  s_add_u32 s37, s51, s45
  buffer_load_dwordx4 a[28:31], v1, s[32:35], s37 offen offset:0 sc1
  ds_write_b128 v3, a[20:23] offset:4096
  v_cvt_pk_bf16_f32 v150, v109, v111
  v_perm_b32 v154, v150, v150, v16
  s_waitcnt vmcnt(9)
  v_mfma_f32_32x32x16_bf16 v[112:127], a[96:99], a[128:131], v[112:127]
  v_xor_b32 v154, v154, v19
  v_fmamk_f32 v8, v2, 0x41c00000, v7
  v_cos_f32 v109, v8
  v_sin_f32 v111, v8
  v_mfma_f32_32x32x16_bf16 v[132:147], a[100:103], a[128:131], v[132:147]
  buffer_load_dwordx4 a[56:59], v1, s[32:35], s37 offen offset:1024 sc1
  ds_write_b128 v3, a[24:27] offset:5120
  v_cvt_pk_bf16_f32 v151, v80, v83
  v_perm_b32 v155, v151, v151, v16
  v_xor_b32 v155, v155, v19
  v_fmamk_f32 v8, v2, 0x41c80000, v7
  s_waitcnt vmcnt(9)
  v_mfma_f32_32x32x16_bf16 v[112:127], a[104:107], a[132:135], v[112:127]
  v_cos_f32 v80, v8
  v_sin_f32 v83, v8
  v_cvt_pk_bf16_f32 v156, v109, v111
  v_perm_b32 v160, v156, v156, v16
  v_mfma_f32_32x32x16_bf16 v[132:147], a[108:111], a[132:135], v[132:147]
  s_add_u32 s37, s53, s45
  buffer_load_dwordx4 a[12:15], v1, s[32:35], s37 offen offset:0 sc1
  v_xor_b32 v160, v160, v19
  v_fmamk_f32 v8, v2, 0x41e00000, v7
  v_cos_f32 v109, v8
  s_waitcnt vmcnt(9)
  v_mfma_f32_32x32x16_bf16 v[112:127], a[112:115], a[136:139], v[112:127]
  s_waitcnt lgkmcnt(0)
  s_barrier
  v_sin_f32 v111, v8
  v_cvt_pk_bf16_f32 v157, v80, v83
  v_mfma_f32_32x32x16_bf16 v[132:147], a[116:119], a[136:139], v[132:147]
  buffer_load_dwordx4 a[16:19], v1, s[32:35], s37 offen offset:1024 sc1
  ds_read_b128 v[164:167], v12 offset:0
  ds_read_b128 v[168:171], v12 offset:1024
  ds_read_b128 v[172:175], v15 offset:2048
  ds_read_b128 v[176:179], v15 offset:3072
  ds_read_b128 v[180:183], v18 offset:4096
  s_waitcnt vmcnt(9)
  v_mfma_f32_32x32x16_bf16 v[112:127], a[120:123], a[48:51], v[112:127]
  ds_read_b128 v[184:187], v18 offset:5120
  ds_read_b64 v[188:189], v82 offset:0
  ds_read_b64 v[190:191], v81 offset:0
  ds_read_b64 v[192:193], v82 offset:16384
  ds_read_b64 v[82:83], v81 offset:16384
  v_perm_b32 v161, v157, v157, v16
  v_mfma_f32_32x32x16_bf16 v[132:147], a[124:127], a[48:51], v[132:147]
  s_add_u32 s37, s54, s45
  buffer_load_dwordx4 a[20:23], v1, s[32:35], s37 offen offset:0 sc1
  v_xor_b32 v161, v161, v19
  v_fmamk_f32 v8, v2, 0x41e80000, v7
  v_cos_f32 v2, v8
  s_waitcnt vmcnt(9)
  v_mfma_f32_32x32x16_bf16 v[112:127], a[32:35], a[52:55], v[112:127]
  v_sin_f32 v7, v8
  v_cvt_pk_bf16_f32 v158, v109, v111
  v_perm_b32 v162, v158, v158, v16
  v_xor_b32 v162, v162, v19
  v_cvt_pk_bf16_f32 v159, v2, v7
  v_mfma_f32_32x32x16_bf16 v[132:147], a[40:43], a[52:55], v[132:147]
  buffer_load_dwordx4 a[24:27], v1, s[32:35], s37 offen offset:1024 sc1
  s_waitcnt lgkmcnt(9)
  v_add_f32 v20, v20, v164
  v_add_f32 v21, v21, v165
  v_add_f32 v22, v22, v166
  v_add_f32 v23, v23, v167
  s_waitcnt lgkmcnt(8)
  v_add_f32 v24, v24, v168
  s_waitcnt vmcnt(8)
  v_mfma_f32_32x32x16_bf16 v[112:127], a[36:39], a[0:3], v[112:127]
  v_cmp_ne_u32 vcc, s46, v14
  s_nop 0
  s_cbranch_vccnz L_poll18
L_back18:
  s_add_u32 s37, s38, 0x800000
  s_add_u32 m0, s65, 0
  s_nop 0
  buffer_load_dwordx4 v10, s[32:35], s37 offen offset:0 sc1 lds
  v_add_f32 v25, v25, v169
  v_mfma_f32_32x32x16_bf16 v[132:147], a[140:143], a[0:3], v[132:147]
  buffer_load_dwordx4 v4, s[32:35], s37 offen offset:1024 sc1 lds
  buffer_load_dwordx4 v17, s[32:35], s37 offen offset:2048 sc1 lds
  buffer_load_dwordx4 v39, s[32:35], s37 offen offset:3072 sc1 lds
  s_add_u32 s37, s38, 0x821000
  s_add_u32 m0, s65, 0x1000
  s_nop 0
  buffer_load_dwordx4 v10, s[32:35], s37 offen offset:0 sc1 lds
  s_waitcnt vmcnt(12)
  v_mfma_f32_32x32x16_bf16 v[112:127], a[144:147], a[4:7], v[112:127]
  buffer_load_dwordx4 v4, s[32:35], s37 offen offset:1024 sc1 lds
  buffer_load_dwordx4 v17, s[32:35], s37 offen offset:2048 sc1 lds
  buffer_load_dwordx4 v39, s[32:35], s37 offen offset:3072 sc1 lds
  s_add_u32 s37, s38, 0x908000
  s_add_u32 m0, s65, 0x8000
  s_nop 0
  buffer_load_dwordx4 v10, s[32:35], s37 offen offset:0 sc1 lds
  v_mfma_f32_32x32x16_bf16 v[132:147], a[148:151], a[4:7], v[132:147]
  buffer_load_dwordx4 v4, s[32:35], s37 offen offset:1024 sc1 lds
  buffer_load_dwordx4 v17, s[32:35], s37 offen offset:2048 sc1 lds
  buffer_load_dwordx4 v39, s[32:35], s37 offen offset:3072 sc1 lds
  s_add_u32 s37, s38, 0x929000
  s_add_u32 m0, s65, 0x9000
  s_nop 0
  buffer_load_dwordx4 v10, s[32:35], s37 offen offset:0 sc1 lds
  s_waitcnt vmcnt(19)
  v_mfma_f32_32x32x16_bf16 v[112:127], a[152:155], a[8:11], v[112:127]
  v_add_f32 v26, v26, v170
  v_add_f32 v27, v27, v171
  s_waitcnt lgkmcnt(7)
  v_add_f32 v20, v20, v172
  v_add_f32 v21, v21, v173
  v_add_f32 v22, v22, v174
  v_add_f32 v23, v23, v175
  v_mfma_f32_32x32x16_bf16 v[132:147], a[160:163], a[8:11], v[132:147]
  buffer_load_dwordx4 v4, s[32:35], s37 offen offset:1024 sc1 lds
  s_waitcnt lgkmcnt(6)
  v_add_f32 v24, v24, v176
  v_add_f32 v25, v25, v177
  v_add_f32 v26, v26, v178
  v_add_f32 v27, v27, v179
  s_waitcnt lgkmcnt(5)
  v_add_f32 v20, v20, v180
  s_waitcnt vmcnt(19)
  v_mfma_f32_32x32x16_bf16 v[112:127], a[164:167], a[28:31], v[112:127]
  buffer_load_dwordx4 v17, s[32:35], s37 offen offset:2048 sc1 lds
  buffer_load_dwordx4 v39, s[32:35], s37 offen offset:3072 sc1 lds
  v_add_f32 v21, v21, v181
  v_add_f32 v22, v22, v182
  v_add_f32 v23, v23, v183
  s_waitcnt lgkmcnt(4)
  v_add_f32 v24, v24, v184
  v_mfma_f32_32x32x16_bf16 v[132:147], a[168:171], a[28:31], v[132:147]
  s_add_u32 s37, s55, s45
  buffer_load_dwordx4 a[0:3], v1, s[32:35], s37 offen offset:0 sc1
  v_add_f32 v25, v25, v185
  v_add_f32 v26, v26, v186
  v_add_f32 v27, v27, v187
  v_mul_f32 v164, 0xbfb8aa3b, v20
  s_waitcnt vmcnt(21)
  v_mfma_f32_32x32x16_bf16 v[112:127], a[172:175], a[56:59], v[112:127]
  v_mul_f32 v165, 0xbfb8aa3b, v21
  v_exp_f32 v164, v164
  v_exp_f32 v165, v165
  v_fma_f32 v164, v164, s39, s39
  v_mfma_f32_32x32x16_bf16 v[132:147], a[176:179], a[56:59], v[132:147]
  buffer_load_dwordx4 a[4:7], v1, s[32:35], s37 offen offset:1024 sc1
  v_fma_f32 v165, v165, s39, s39
  v_rcp_f32 v164, v164
  v_rcp_f32 v165, v165
  s_waitcnt vmcnt(21)
  v_mfma_f32_32x32x16_bf16 v[112:127], a[180:183], a[12:15], v[112:127]
  v_mul_f32 v164, v164, v20
  v_mul_f32 v165, v165, v21
  v_mul_f32 v166, 0xbfb8aa3b, v22
  v_mul_f32 v167, 0xbfb8aa3b, v23
  v_exp_f32 v166, v166
  v_mfma_f32_32x32x16_bf16 v[132:147], a[184:187], a[12:15], v[132:147]
  s_add_u32 s37, s57, s45
  buffer_load_dwordx4 a[8:11], v1, s[32:35], s37 offen offset:0 sc1
  v_exp_f32 v167, v167
  v_fma_f32 v166, v166, s39, s39
  v_fma_f32 v167, v167, s39, s39
  s_waitcnt vmcnt(21)
  v_mfma_f32_32x32x16_bf16 v[112:127], a[188:191], a[16:19], v[112:127]
  v_rcp_f32 v166, v166
  v_rcp_f32 v167, v167
  v_mul_f32 v166, v166, v22
  v_mul_f32 v167, v167, v23
  v_mfma_f32_32x32x16_bf16 v[132:147], a[192:195], a[16:19], v[132:147]
  buffer_load_dwordx4 a[12:15], v1, s[32:35], s37 offen offset:1024 sc1
  v_mul_f32 v168, 0xbfb8aa3b, v24
  v_mul_f32 v169, 0xbfb8aa3b, v25
  v_exp_f32 v168, v168
  v_exp_f32 v169, v169
  s_waitcnt vmcnt(21)
  v_mfma_f32_32x32x16_bf16 v[112:127], a[196:199], a[20:23], v[112:127]
  s_waitcnt vmcnt(16)
  ds_read_b64_tr_b16 a[16:17], v108 offset:0
  ds_read_b64_tr_b16 a[18:19], v108 offset:1024
  ds_read_b64_tr_b16 a[28:29], v5 offset:0
  ds_read_b64_tr_b16 a[30:31], v5 offset:1024
  v_mfma_f32_32x32x16_bf16 v[132:147], a[200:203], a[20:23], v[132:147]
  v_perm_b32 v163, v159, v159, v16
  v_xor_b32 v163, v163, v19
  s_add_u32 s37, s58, s45
  buffer_load_dwordx4 a[20:23], v1, s[32:35], s37 offen offset:0 sc1
  v_fma_f32 v168, v168, s39, s39
  v_fma_f32 v169, v169, s39, s39
  v_mfma_f32_32x32x16_bf16 v[112:127], a[204:207], a[24:27], v[112:127]
  ds_read_b64_tr_b16 a[32:33], v108 offset:2048
  ds_read_b64_tr_b16 a[34:35], v108 offset:3072
  ds_read_b64_tr_b16 a[36:37], v5 offset:2048
  ds_read_b64_tr_b16 a[38:39], v5 offset:3072
  v_rcp_f32 v168, v168
  v_mfma_f32_32x32x16_bf16 v[132:147], a[208:211], a[24:27], v[132:147]
  buffer_load_dwordx4 a[24:27], v1, s[32:35], s37 offen offset:1024 sc1
  v_rcp_f32 v169, v169
  v_mul_f32 v168, v168, v24
  v_mul_f32 v169, v169, v25
  v_mul_f32 v170, 0xbfb8aa3b, v26
  s_waitcnt lgkmcnt(6)
  v_mfma_f32_32x32x16_bf16 v[172:187], v[44:47], a[16:19], 0
  s_waitcnt vmcnt(14)
  ds_read_b64_tr_b16 a[40:41], v108 offset:4096
  ds_read_b64_tr_b16 a[42:43], v108 offset:5120
  ds_read_b64_tr_b16 a[48:49], v5 offset:4096
  ds_read_b64_tr_b16 a[50:51], v5 offset:5120
  v_mul_f32 v171, 0xbfb8aa3b, v27
  v_mfma_f32_32x32x16_bf16 a[52:67], v[40:43], a[16:19], 0
  s_add_u32 s37, s59, s45
  buffer_load_dwordx4 a[16:19], v1, s[32:35], s37 offen offset:0 sc1
  v_exp_f32 v170, v170
  v_exp_f32 v171, v171
  s_waitcnt lgkmcnt(6)
  v_mfma_f32_32x32x16_bf16 v[172:187], v[52:55], a[32:35], v[172:187]
  ds_read_b64_tr_b16 a[68:69], v108 offset:6144
  ds_read_b64_tr_b16 a[70:71], v108 offset:7168
  ds_read_b64_tr_b16 a[72:73], v5 offset:6144
  ds_read_b64_tr_b16 a[74:75], v5 offset:7168
  v_fma_f32 v170, v170, s39, s39
  v_fma_f32 v171, v171, s39, s39
  v_mfma_f32_32x32x16_bf16 a[52:67], v[88:91], a[32:35], a[52:67]
  buffer_load_dwordx4 a[32:35], v1, s[32:35], s37 offen offset:1024 sc1
  v_rcp_f32 v170, v170
  v_rcp_f32 v171, v171
  v_mul_f32 v170, v170, v26
  s_waitcnt lgkmcnt(6)
  v_mfma_f32_32x32x16_bf16 v[172:187], v[60:63], a[40:43], v[172:187]
  s_waitcnt vmcnt(12)
  ds_read_b64_tr_b16 a[76:77], v108 offset:32768
  ds_read_b64_tr_b16 a[78:79], v108 offset:33792
  ds_read_b64_tr_b16 a[80:81], v5 offset:32768
  ds_read_b64_tr_b16 a[82:83], v5 offset:33792
  v_mul_f32 v171, v171, v27
  v_mfma_f32_32x32x16_bf16 a[52:67], v[148:151], a[40:43], a[52:67]
  v_lshlrev_b32 v20, 16, v188
  v_and_b32 v21, 0xffff0000, v188
  v_lshlrev_b32 v22, 16, v189
  v_and_b32 v23, 0xffff0000, v189
  v_lshlrev_b32 v24, 16, v190
  v_and_b32 v25, 0xffff0000, v190
  s_waitcnt lgkmcnt(6)
  v_mfma_f32_32x32x16_bf16 v[172:187], v[68:71], a[68:71], v[172:187]
  ds_read_b64_tr_b16 a[40:41], v108 offset:34816
  ds_read_b64_tr_b16 a[42:43], v108 offset:35840
  ds_read_b64_tr_b16 a[84:85], v5 offset:34816
  ds_read_b64_tr_b16 a[86:87], v5 offset:35840
  v_lshlrev_b32 v26, 16, v191
  v_and_b32 v27, 0xffff0000, v191
  v_mfma_f32_32x32x16_bf16 a[52:67], v[156:159], a[68:71], a[52:67]
  v_lshlrev_b32 v28, 16, v192
  v_and_b32 v29, 0xffff0000, v192
  v_lshlrev_b32 v30, 16, v193
  v_and_b32 v31, 0xffff0000, v193
  v_lshlrev_b32 v32, 16, v82
  v_and_b32 v33, 0xffff0000, v82
  s_waitcnt lgkmcnt(6)
  v_mfma_f32_32x32x16_bf16 v[172:187], v[48:51], a[76:79], v[172:187]
  s_waitcnt vmcnt(8)
  ds_read_b64_tr_b16 a[68:69], v108 offset:36864
  ds_read_b64_tr_b16 a[70:71], v108 offset:37888
  ds_read_b64_tr_b16 a[88:89], v5 offset:36864
  ds_read_b64_tr_b16 a[90:91], v5 offset:37888
  v_lshlrev_b32 v34, 16, v83
  v_mfma_f32_32x32x16_bf16 a[52:67], v[76:79], a[76:79], a[52:67]
  v_and_b32 v35, 0xffff0000, v83
  s_waitcnt lgkmcnt(6)
  v_mfma_f32_32x32x16_bf16 v[172:187], v[56:59], a[40:43], v[172:187]
  ds_read_b64_tr_b16 a[76:77], v108 offset:38912
  ds_read_b64_tr_b16 a[78:79], v108 offset:39936
  ds_read_b64_tr_b16 a[92:93], v5 offset:38912
  ds_read_b64_tr_b16 a[94:95], v5 offset:39936
  v_mfma_f32_32x32x16_bf16 a[52:67], v[128:131], a[40:43], a[52:67]
  s_waitcnt lgkmcnt(6)
  v_mfma_f32_32x32x16_bf16 v[172:187], v[64:67], a[68:71], v[172:187]
  v_mfma_f32_32x32x16_bf16 a[52:67], v[152:155], a[68:71], a[52:67]
  s_waitcnt lgkmcnt(2)
  v_mfma_f32_32x32x16_bf16 v[172:187], v[72:75], a[76:79], v[172:187]
  v_mfma_f32_32x32x16_bf16 a[52:67], v[160:163], a[76:79], a[52:67]
  v_mfma_f32_32x32x16_bf16 v[188:203], v[44:47], a[28:31], 0
  v_mfma_f32_32x32x16_bf16 a[96:111], v[40:43], a[28:31], 0
  v_mfma_f32_32x32x16_bf16 v[188:203], v[52:55], a[36:39], v[188:203]
  s_nop 8
  ds_write_b128 v11, a[52:55] offset:0
  v_mfma_f32_32x32x16_bf16 a[96:111], v[88:91], a[36:39], a[96:111]
  ds_write_b128 v11, a[56:59] offset:1024
  v_mfma_f32_32x32x16_bf16 v[188:203], v[60:63], a[48:51], v[188:203]
  v_fmac_f32 v20, v172, v164
  v_fmac_f32 v21, v173, v165
  v_fmac_f32 v22, v174, v166
  v_fmac_f32 v23, v175, v167
  v_fmac_f32 v24, v176, v168
  v_fmac_f32 v25, v177, v169
  v_mfma_f32_32x32x16_bf16 a[96:111], v[148:151], a[48:51], a[96:111]
  ds_write_b128 v11, v[180:183] offset:2048
  v_fmac_f32 v26, v178, v170
  v_fmac_f32 v27, v179, v171
  v_mfma_f32_32x32x16_bf16 v[188:203], v[68:71], a[72:75], v[188:203]
  ds_write_b128 v11, v[184:187] offset:3072
  v_mfma_f32_32x32x16_bf16 a[96:111], v[156:159], a[72:75], a[96:111]
  v_mfma_f32_32x32x16_bf16 v[188:203], v[48:51], a[80:83], v[188:203]
  ds_write_b128 v11, a[60:63] offset:4096
  v_mfma_f32_32x32x16_bf16 a[96:111], v[76:79], a[80:83], a[96:111]
  ds_write_b128 v11, a[64:67] offset:5120
  v_mfma_f32_32x32x16_bf16 v[188:203], v[56:59], a[84:87], v[188:203]
  v_mfma_f32_32x32x16_bf16 a[96:111], v[128:131], a[84:87], a[96:111]
  s_waitcnt lgkmcnt(0)
  s_barrier
  ds_read_b128 v[40:43], v36 offset:0
  ds_read_b128 v[44:47], v36 offset:1024
  ds_read_b128 v[48:51], v37 offset:2048
  ds_read_b128 v[52:55], v37 offset:3072
  v_mfma_f32_32x32x16_bf16 v[188:203], v[64:67], a[88:91], v[188:203]
  ds_read_b128 v[56:59], v38 offset:4096
  ds_read_b128 v[60:63], v38 offset:5120
  v_mfma_f32_32x32x16_bf16 a[96:111], v[152:155], a[88:91], a[96:111]
  v_mfma_f32_32x32x16_bf16 v[188:203], v[72:75], a[92:95], v[188:203]
  v_mfma_f32_32x32x16_bf16 a[96:111], v[160:163], a[92:95], a[96:111]
  s_waitcnt lgkmcnt(5)
  v_fmac_f32 v20, v40, v164
  v_fmac_f32 v21, v41, v165
  v_fmac_f32 v22, v42, v166
  v_fmac_f32 v23, v43, v167
  s_waitcnt lgkmcnt(4)
  v_fmac_f32 v24, v44, v168
  v_fmac_f32 v25, v45, v169
  s_waitcnt vmcnt(7)
  v_mfma_f32_32x32x16_bf16 v[112:127], a[212:215], a[0:3], v[112:127]
  v_fmac_f32 v26, v46, v170
  v_fmac_f32 v27, v47, v171
  s_waitcnt lgkmcnt(3)
  v_fmac_f32 v20, v48, v164
  v_mfma_f32_32x32x16_bf16 v[132:147], a[216:219], a[0:3], v[132:147]
  v_fmac_f32 v21, v49, v165
  v_fmac_f32 v22, v50, v166
  v_fmac_f32 v23, v51, v167
  s_waitcnt vmcnt(6)
  v_mfma_f32_32x32x16_bf16 v[112:127], a[220:223], a[4:7], v[112:127]
  ds_write_b128 v3, a[96:99] offset:32768
  s_waitcnt lgkmcnt(3)
  v_fmac_f32 v24, v52, v168
  v_fmac_f32 v25, v53, v169
  v_mfma_f32_32x32x16_bf16 v[132:147], a[224:227], a[4:7], v[132:147]
  ds_write_b128 v3, a[100:103] offset:33792
  v_fmac_f32 v26, v54, v170
  v_fmac_f32 v27, v55, v171
  s_waitcnt vmcnt(5)
  v_mfma_f32_32x32x16_bf16 v[132:147], a[156:159], a[8:11], v[132:147]
  s_waitcnt lgkmcnt(3)
  v_fmac_f32 v20, v56, v164
  v_fmac_f32 v21, v57, v165
  v_fmac_f32 v22, v58, v166
  s_waitcnt vmcnt(4)
  v_mfma_f32_32x32x16_bf16 v[132:147], a[240:243], a[12:15], v[132:147]
  ds_write_b128 v3, v[196:199] offset:34816
  v_fmac_f32 v23, v59, v167
  s_waitcnt lgkmcnt(3)
  v_fmac_f32 v24, v60, v168
  s_waitcnt vmcnt(3)
  v_mfma_f32_32x32x16_bf16 v[132:147], a[248:251], a[20:23], v[132:147]
  ds_write_b128 v3, v[200:203] offset:35840
  v_fmac_f32 v25, v61, v169
  v_fmac_f32 v26, v62, v170
  s_waitcnt vmcnt(2)
  v_mfma_f32_32x32x16_bf16 v[132:147], v[84:87], a[24:27], v[132:147]
  v_fmac_f32 v27, v63, v171
  v_cvt_pk_bf16_f32 v36, v20, v21
  v_cvt_pk_bf16_f32 v37, v22, v23
  s_waitcnt vmcnt(1)
  v_mfma_f32_32x32x16_bf16 v[132:147], v[96:99], a[16:19], v[132:147]
  ds_write_b128 v3, a[104:107] offset:36864
  v_cvt_pk_bf16_f32 v38, v24, v25
  v_cvt_pk_bf16_f32 v39, v26, v27
  s_waitcnt vmcnt(0)
  v_mfma_f32_32x32x16_bf16 v[132:147], v[104:107], a[32:35], v[132:147]
  ds_write_b128 v3, a[108:111] offset:37888
  v_permlane32_swap_b32 v36, v38
  v_permlane32_swap_b32 v37, v39
  v_mfma_f32_32x32x16_bf16 v[112:127], a[44:47], a[8:11], v[112:127]
  buffer_store_dwordx4 v[36:39], v6, s[28:31], s40 offen
  v_mfma_f32_32x32x16_bf16 v[112:127], a[236:239], a[12:15], v[112:127]
  s_waitcnt lgkmcnt(0)
  s_barrier
  ds_read_b128 v[20:23], v12 offset:32768
  v_mfma_f32_32x32x16_bf16 v[112:127], a[244:247], a[20:23], v[112:127]
  ds_read_b128 v[24:27], v12 offset:33792
  ds_read_b128 v[36:39], v15 offset:34816
  ds_read_b128 v[40:43], v15 offset:35840
  v_mfma_f32_32x32x16_bf16 v[112:127], a[252:255], a[24:27], v[112:127]
  ds_read_b128 v[44:47], v18 offset:36864
  ds_read_b128 v[48:51], v18 offset:37888
  ds_write_b128 v3, v[132:135] offset:0
  v_mfma_f32_32x32x16_bf16 v[112:127], v[92:95], a[16:19], v[112:127]
  ds_write_b128 v3, v[136:139] offset:1024
  ds_write_b128 v3, v[140:143] offset:4096
  ds_write_b128 v3, v[144:147] offset:5120
  v_mfma_f32_32x32x16_bf16 v[112:127], v[100:103], a[32:35], v[112:127]
  s_waitcnt lgkmcnt(9)
  v_add_f32 v188, v188, v20
  v_add_f32 v189, v189, v21
  v_add_f32 v190, v190, v22
  s_nop 7
  ds_write_b128 v3, v[120:123] offset:2048
  ds_write_b128 v3, v[124:127] offset:3072
  s_mov_b32 s38, 0xbfb8aa3b
  s_mov_b32 s39, 0x49000000
  v_add_f32 v191, v191, v23
  s_waitcnt lgkmcnt(10)
  v_add_f32 v192, v192, v24
  v_add_f32 v193, v193, v25
  v_add_f32 v194, v194, v26
  v_add_f32 v195, v195, v27
  s_waitcnt lgkmcnt(9)
  v_add_f32 v188, v188, v36
  v_add_f32 v189, v189, v37
  v_add_f32 v190, v190, v38
  v_add_f32 v191, v191, v39
  s_waitcnt lgkmcnt(8)
  v_add_f32 v192, v192, v40
  v_add_f32 v193, v193, v41
  v_add_f32 v194, v194, v42
  v_add_f32 v195, v195, v43
  s_waitcnt lgkmcnt(7)
  v_add_f32 v188, v188, v44
  v_add_f32 v189, v189, v45
  v_add_f32 v190, v190, v46
  v_add_f32 v191, v191, v47
  s_waitcnt lgkmcnt(6)
  v_add_f32 v192, v192, v48
  v_add_f32 v193, v193, v49
  v_add_f32 v194, v194, v50
  v_add_f32 v195, v195, v51
  s_waitcnt lgkmcnt(0)
  s_barrier
  ds_read_b128 v[20:23], v12 offset:0
  ds_read_b128 v[24:27], v12 offset:1024
  ds_read_b128 v[36:39], v15 offset:2048
  ds_read_b128 v[40:43], v15 offset:3072
  ds_read_b128 v[44:47], v18 offset:4096
  ds_read_b128 v[48:51], v18 offset:5120
  s_waitcnt lgkmcnt(5)
  v_pk_add_f32 v[112:113], v[112:113], v[20:21]
  v_pk_add_f32 v[114:115], v[114:115], v[22:23]
  s_waitcnt lgkmcnt(4)
  v_pk_add_f32 v[116:117], v[116:117], v[24:25]
  v_pk_add_f32 v[118:119], v[118:119], v[26:27]
  s_waitcnt lgkmcnt(3)
  v_pk_add_f32 v[112:113], v[112:113], v[36:37]
  v_pk_add_f32 v[114:115], v[114:115], v[38:39]
  s_waitcnt lgkmcnt(2)
  v_pk_add_f32 v[116:117], v[116:117], v[40:41]
  v_pk_add_f32 v[118:119], v[118:119], v[42:43]
  s_waitcnt lgkmcnt(1)
  v_pk_add_f32 v[112:113], v[112:113], v[44:45]
  v_pk_add_f32 v[114:115], v[114:115], v[46:47]
  s_waitcnt lgkmcnt(0)
  v_pk_add_f32 v[116:117], v[116:117], v[48:49]
  v_pk_add_f32 v[118:119], v[118:119], v[50:51]
  v_pk_mul_f32 v[16:17], v[112:113], s[38:39] op_sel_hi:[1,0]
  v_pk_mul_f32 v[18:19], v[114:115], s[38:39] op_sel_hi:[1,0]
  v_pk_mul_f32 v[20:21], v[116:117], s[38:39] op_sel_hi:[1,0]
  v_pk_mul_f32 v[22:23], v[118:119], s[38:39] op_sel_hi:[1,0]
  v_exp_f32 v16, v16
  v_exp_f32 v17, v17
  v_exp_f32 v18, v18
  v_exp_f32 v19, v19
  v_exp_f32 v20, v20
  v_exp_f32 v21, v21
  v_exp_f32 v22, v22
  v_exp_f32 v23, v23
  v_pk_fma_f32 v[16:17], v[16:17], s[38:39], s[38:39] op_sel:[0,1,1] op_sel_hi:[1,1,1]
  v_pk_fma_f32 v[18:19], v[18:19], s[38:39], s[38:39] op_sel:[0,1,1] op_sel_hi:[1,1,1]
  v_pk_fma_f32 v[20:21], v[20:21], s[38:39], s[38:39] op_sel:[0,1,1] op_sel_hi:[1,1,1]
  v_pk_fma_f32 v[22:23], v[22:23], s[38:39], s[38:39] op_sel:[0,1,1] op_sel_hi:[1,1,1]
  v_rcp_f32 v16, v16
  v_rcp_f32 v17, v17
  v_rcp_f32 v18, v18
  v_rcp_f32 v19, v19
  v_rcp_f32 v20, v20
  v_rcp_f32 v21, v21
  v_rcp_f32 v22, v22
  v_rcp_f32 v23, v23
  v_pk_mul_f32 v[112:113], v[112:113], v[188:189]
  v_pk_mul_f32 v[114:115], v[114:115], v[190:191]
  v_pk_mul_f32 v[116:117], v[116:117], v[192:193]
  v_pk_mul_f32 v[118:119], v[118:119], v[194:195]
  v_pk_fma_f32 v[28:29], v[112:113], v[16:17], v[28:29]
  v_pk_fma_f32 v[30:31], v[114:115], v[18:19], v[30:31]
  v_pk_fma_f32 v[32:33], v[116:117], v[20:21], v[32:33]
  v_pk_fma_f32 v[34:35], v[118:119], v[22:23], v[34:35]
  v_cvt_pk_bf16_f32 v16, v28, v29
  v_cvt_pk_bf16_f32 v17, v30, v31
  v_cvt_pk_bf16_f32 v18, v32, v33
  v_cvt_pk_bf16_f32 v19, v34, v35
  s_nop 0
  v_permlane32_swap_b32 v16, v18
  v_permlane32_swap_b32 v17, v19
  buffer_store_dwordx4 v[16:19], v6, s[28:31], s36 offen
  s_or_b32 s36, s2, s56
  s_cmp_eq_u32 s36, 0
  s_cselect_b32 s36, 0, 0x40000000
  buffer_store_dword v9, v13, s[32:35], s36 offen sc1
  s_endpgm
L_poll14:
  s_mov_b32 s66, 1
L_poll14x:
  s_sleep 8
  buffer_load_dword v52, v14, s[32:35], s40 offen sc1
  s_waitcnt vmcnt(0)
  v_cmp_ne_u32 vcc, s46, v52
  s_nop 4
  s_cbranch_vccz L_back14
  s_add_u32 s66, s66, 1
  s_cmp_lt_u32 s66, 0x80000
  s_cbranch_scc1 L_poll14x
  s_branch L_back14
L_poll15:
  s_mov_b32 s66, 1
L_poll15x:
  s_sleep 8
  buffer_load_dword v53, v15, s[32:35], s39 offen sc1
  s_waitcnt vmcnt(0)
  v_cmp_ne_u32 vcc, s46, v53
  s_nop 4
  s_cbranch_vccz L_back15
  s_add_u32 s66, s66, 1
  s_cmp_lt_u32 s66, 0x80000
  s_cbranch_scc1 L_poll15x
  s_branch L_back15
L_poll16:
  s_mov_b32 s66, 1
L_poll16x:
  s_sleep 8
  buffer_load_dword v60, v15, s[32:35], s39 offen sc1
  s_waitcnt vmcnt(0)
  v_cmp_ne_u32 vcc, s46, v60
  s_nop 4
  s_cbranch_vccz L_back16
  s_add_u32 s66, s66, 1
  s_cmp_lt_u32 s66, 0x80000
  s_cbranch_scc1 L_poll16x
  s_branch L_back16
L_poll17:
  s_mov_b32 s66, 1
L_poll17x:
  s_sleep 8
  buffer_load_dword v37, v15, s[32:35], s62 offen sc1
  s_waitcnt vmcnt(0)
  v_cmp_ne_u32 vcc, s46, v37
  s_nop 4
  s_cbranch_vccz L_back17
  s_add_u32 s66, s66, 1
  s_cmp_lt_u32 s66, 0x80000
  s_cbranch_scc1 L_poll17x
  s_branch L_back17
L_poll18:
  s_mov_b32 s66, 1
L_poll18x:
  s_sleep 8
  buffer_load_dword v14, v110, s[32:35], s41 offen sc1
  s_waitcnt vmcnt(0)
  v_cmp_ne_u32 vcc, s46, v14
  s_nop 4
  s_cbranch_vccz L_back18
  s_add_u32 s66, s66, 1
  s_cmp_lt_u32 s66, 0x80000
  s_cbranch_scc1 L_poll18x
  s_branch L_back18
L_end:
  s_endpgm
L_codeend:
.section .rodata,"a"
.p2align 6
.amdhsa_kernel recurrent_scan__spectral_gfnet__glu_gated_glu__prompt_kernel
  .amdhsa_next_free_vgpr 512
  .amdhsa_next_free_sgpr 102
  .amdhsa_accum_offset 256
  .amdhsa_group_segment_fixed_size 0
  .amdhsa_kernarg_size 80
  .amdhsa_user_sgpr_count 2
  .amdhsa_user_sgpr_kernarg_segment_ptr 1
  .amdhsa_system_sgpr_workgroup_id_x 1
.end_amdhsa_kernel
```
